```python
import torch

def _softmax(x, axis=-1):
    return torch.softmax(x, dim=axis)
def _gelu(x):
    return torch.nn.functional.gelu(x, approximate="tanh")
def _silu(x):
    return torch.nn.functional.silu(x)
def _sigmoid(x):
    return torch.sigmoid(x)
def _layernorm(x, axis=-1, eps=1e-5):
    m = x.mean(dim=axis, keepdim=True)
    v = x.var(dim=axis, keepdim=True, unbiased=False)
    return (x - m) / torch.sqrt(v + eps)
def _scatter_add(tgt, idx, src, axis=0):
    return tgt.clone().index_add_(axis, idx, src)
def _segment_sum(src, seg, n):
    out = torch.zeros((n,) + src.shape[1:], dtype=src.dtype)
    return out.index_add_(0, seg, src)
def _pad(x, pw):
    flat = tuple(v for pair in reversed(pw) for v in pair)
    return torch.nn.functional.pad(x, flat)

kernel_name = 'gated_mix__sliding_block__dense_activation_silu__prompt'

def setup_inputs():

    _w = (lambda a: (lambda t: t.to(torch.bfloat16) if t.is_floating_point() else t)(torch.as_tensor(a)))
    def _A_setup():
        B, S, D = 1, 2048, 512
        return {
            "x": _w((lambda *s: torch.randn(*s, dtype=torch.bfloat16) * 0.2)(B, S, D)),
            "wqkv": _w((lambda *s: torch.randn(*s, dtype=torch.bfloat16) * 0.2)(D, 3 * D)),
            "wo": _w((lambda *s: torch.randn(*s, dtype=torch.bfloat16) * 0.2)(D, D)),
        }
    _A_in = _A_setup()

    def _B_setup():
        B, S, D, F = 1, 2048, 512, 1376
        return {
            "x": _w((lambda *s: torch.randn(*s, dtype=torch.bfloat16) * 0.2)(B, S, D)),
            "w1": _w((lambda *s: torch.randn(*s, dtype=torch.bfloat16) * 3.2)(D, F) * (D ** -0.5)),
            "w2": _w((lambda *s: torch.randn(*s, dtype=torch.bfloat16) * 3.2)(F, D) * (F ** -0.5)),
        }
    _B_in = _B_setup()

    return {
        "A_x": _A_in["x"],
        "A_wqkv": _A_in["wqkv"],
        "A_wo": _A_in["wo"],
        "B_x": _B_in["x"],
        "B_w1": _B_in["w1"],
        "B_w2": _B_in["w2"],
        "gate_w": _w((lambda *s: torch.randn(*s, dtype=torch.bfloat16) * 0.2)(512) * 16.0),
    }

def reference(A_x, A_wqkv, A_wo, B_x, B_w1, B_w2, gate_w):
    def _A_ref(x, wqkv, wo):
        B, S, D = x.shape
        H = 32; Dh = D // H; W = 256
        qkv = (lambda x, *d: x.permute(*d))((x @ wqkv).reshape(B, S, 3, H, Dh), 2, 0, 3, 1, 4)
        q, k, v = qkv[0], qkv[1], qkv[2]
        scores = torch.einsum("bhqd,bhkd->bhqk", q, k) * (Dh ** -0.5)
        idx = torch.arange(S)
        mask = (idx[:, None] - idx[None, :] >= 0) & (idx[:, None] - idx[None, :] < W)
        scores = torch.where(mask[None, None], scores, -1e9)
        p = _softmax(scores, axis=-1)
        o = torch.einsum("bhqk,bhkd->bhqd", p, v)
        return (lambda x, *d: x.permute(*d))(o, 0, 2, 1, 3).reshape(B, S, D) @ wo

    def _B_ref(x, w1, w2):
        h = torch.einsum("bsd,df->bsf", x, w1)
        h = _silu(h)
        out = torch.einsum("bsf,fd->bsd", h, w2)
        return out

    x = A_x
    g = _sigmoid((x * gate_w).sum(-1, keepdims=True))
    a = _A_ref(x, A_wqkv, A_wo)
    b = _B_ref(x, B_w1, B_w2)
    return g * a + (1 - g) * b
```

```asm
; @launch grid=(256,1,1) block=(256,1,1) lds=163840
.amdgcn_target "amdgcn-amd-amdhsa--gfx950"
.text
.globl gated_mix__sliding_block__dense_activation_silu__prompt_kernel
.p2align 8
.type gated_mix__sliding_block__dense_activation_silu__prompt_kernel,@function
gated_mix__sliding_block__dense_activation_silu__prompt_kernel:
    s_cmpk_ge_u32 s2, 0x100
    s_cbranch_scc1 L_end
    s_load_dwordx2 s[4:5], s[0:1], 0
    s_load_dwordx2 s[8:9], s[0:1], 8
    s_load_dwordx2 s[12:13], s[0:1], 32
    s_branch L_det
L_det_back:
    v_lshrrev_b32 v4, 6, v0
    s_lshr_b32 s48, s2, 3
    v_readfirstlane_b32 s46, v4
    v_and_b32 v1, 63, v0
    s_getpc_b64 s[40:41]
L_pc:
    v_lshrrev_b32 v7, 3, v0
    s_lshl_b32 s52, s48, 5
    v_add_lshl_u32 v7, v7, s52, 7
    v_min_u32 v7, L_last-L_pc, v7
    global_load_dword v76, v7, s[40:41]
    s_lshr_b32 s52, s48, 3
    s_and_b32 s49, s2, 6
    s_lshl1_add_u32 s49, s49, s52
    s_lshl1_add_u32 s52, s52, s48
    s_and_b32 s55, s52, 7
    s_cselect_b32 s56, 0, 1
    s_lshl_b32 s58, s46, 12
    s_lshl2_add_u32 s52, s49, s46
    s_lshl_b32 s52, s52, 15
    v_lshrrev_b32 v4, 3, v1
    v_lshrrev_b32 v5, 4, v1
    v_lshl_add_u32 v4, v4, 10, s52
    v_xor_b32 v6, v5, v1
    v_and_b32 v6, 7, v6
    v_lshl_add_u32 v12, v6, 4, v4
    s_movk_i32 s52, 7168
    v_xor_b32 v13, 64, v12
    v_add_u32 v13, s52, v13
    s_movk_i32 s52, 14336
    v_add_u32 v14, s52, v12
    v_add_u32 v15, s52, v13
    s_lshl_b32 s6, 1, 21
    s_lshl_b32 s7, 1, 17
    s_lshl_b32 s62, s56, 7
    s_mov_b32 m0, s58
    s_and_b32 s47, s2, 1
    s_and_b32 s50, s48, 3
    v_lshlrev_b32 v6, 2, v5
    v_xor_b32 v6, v6, v1
    s_waitcnt lgkmcnt(0)
    buffer_load_dwordx4 v12, s[4:7], s62 offen offset:0  lds
    buffer_load_dwordx4 v13, s[4:7], s62 offen offset:1024  lds
    buffer_load_dwordx4 v14, s[4:7], s62 offen offset:2048  lds
    buffer_load_dwordx4 v15, s[4:7], s62 offen offset:3072  lds
    s_branch L_det_skip
    .fill (gated_mix__sliding_block__dense_activation_silu__prompt_kernel + 252 - .) / 4, 4, 0xbf800000
L_det:
    s_branch L_det_back
L_det_skip:
    s_load_dwordx4 s[32:35], s[0:1], 64
    s_add_u32 m0, s58, 49152
    v_and_b32 v6, 15, v6
    s_lshl_b32 s54, s46, 4
    v_add_u32 v5, s54, v5
    s_movk_i32 s53, 320
    s_movk_i32 s54, 2752
    s_mov_b32 s11, s7
    s_bfe_u32 s52, s48, 0x10002
    s_lshl1_add_u32 s51, s47, s52
    s_lshl2_add_u32 s52, s50, s51
    s_lshl_b32 s52, s52, 8
    s_mul_i32 s53, s51, s53
    s_mul_i32 s63, s47, 768
    s_addk_i32 s53, 768
    s_add_u32 s53, s53, s63
    s_cmp_eq_u32 s50, 3
    s_cselect_b32 s52, s53, s52
    s_movk_i32 s53, 3072
    s_cselect_b32 s53, s54, s53
    s_cselect_b32 s8, s12, s8
    s_cselect_b32 s9, s13, s9
    v_lshl_add_u32 v6, v6, 4, s52
    s_lshl_b32 s54, s53, 2
    s_addk_i32 s54, -1024
    v_mad_u32_u24 v16, v5, s53, v6
    s_lshl_b32 s61, s53, 6
    s_lshl_b32 s10, s53, 9
    s_mul_i32 s63, s56, s61
    v_add_u32 v17, s54, v16
    v_add_u32 v18, s54, v17
    v_add_u32 v19, s54, v18
    buffer_load_dwordx4 v16, s[8:11], s63 offen offset:0  lds
    buffer_load_dwordx4 v17, s[8:11], s63 offen offset:1024  lds
    buffer_load_dwordx4 v18, s[8:11], s63 offen offset:2048  lds
    buffer_load_dwordx4 v19, s[8:11], s63 offen offset:3072  lds
    s_load_dwordx2 s[36:37], s[0:1], 48
    s_load_dwordx2 s[16:17], s[0:1], 40
    s_load_dwordx2 s[20:21], s[0:1], 16
    s_load_dwordx2 s[28:29], s[0:1], 56
    s_movk_i32 s53, 0x1ef
    s_cmp_eq_u32 s55, 6
    s_cselect_b32 s53, 15, s53
    s_cmp_eq_u32 s55, 7
    s_cselect_b32 s53, 0, s53
    s_lshl_b32 s55, s55, 2
    s_lshl_b32 s53, s53, s55
    s_sub_u32 s57, 0x76543210, s53
    s_or_b32 s52, s2, s46
    s_cselect_b32 s90, 0x40000000, 0
    s_add_u32 s91, s90, 0xf00000
    s_mov_b32 s26, 0x1400000
    s_mov_b32 s27, s7
    s_waitcnt lgkmcnt(0)
    s_mov_b64 s[24:25], s[34:35]
    buffer_load_dwordx2 v[70:71], off, s[24:27], s91 sc1
    s_lshr_b32 s52, s49, 2
    s_lshl_b32 s54, s52, 5
    s_add_u32 s54, s54, s48
    s_lshl2_add_u32 s54, s54, s46
    s_mul_i32 s55, s47, 720896
    s_add_u32 s16, s16, s55
    s_addc_u32 s17, s17, 0
    s_sub_u32 s18, 0x158000, s55
    s_mov_b32 s19, s7
    s_mul_i32 s53, s54, 1536
    v_mad_u32_u24 v78, v1, 24, s53
    s_lshl_b32 s22, 1, 19
    s_mov_b32 s23, s7
    s_lshl_b32 s53, s47, 9
    s_add_u32 s53, s53, s54
    s_lshl_b32 s53, s53, 9
    v_lshl_add_u32 v79, v1, 3, s53
    buffer_load_dword v55, v79, s[20:23], 0 offen
    s_lshl_b32 s53, s54, 7
    s_add_u32 s53, s53, 0xe40000
    v_mov_b32 v97, s53
    buffer_load_dword v55, v97, s[24:27], 0 offen sc1
    s_cmp_eq_u32 s50, 2
    s_cbranch_scc1 VAR_V
    s_lshl2_add_u32 s56, s50, s51
    s_cmp_eq_u32 s56, 15
    s_cbranch_scc1 VAR_G
    s_cmp_eq_u32 s50, 3
    s_cbranch_scc1 VAR_C
    .p2align 3
VAR_QK:
    v_lshlrev_b32 v2, 4, v1
    v_and_b32 v4, 31, v1
    v_lshrrev_b32 v5, 5, v1
    v_bfe_u32 v6, v1, 1, 3
    v_xor_b32 v6, v6, v5
    v_lshlrev_b32 v6, 4, v6
    v_lshl_add_u32 v6, v4, 7, v6
    v_add_u32 v22, s58, v6
    v_xor_b32 v23, 32, v22
    v_xor_b32 v24, 64, v22
    v_xor_b32 v25, 96, v22
    v_add_u32 v26, 114688, v22
    v_add_u32 v27, 114688, v23
    v_add_u32 v28, 114688, v24
    v_add_u32 v29, 114688, v25
    v_bfe_u32 v6, v1, 2, 2
    v_bfe_u32 v7, v1, 4, 1
    v_and_b32 v8, 3, v1
    v_lshlrev_b32 v8, 3, v8
    v_lshl_add_u32 v8, v7, 5, v8
    v_lshl_add_u32 v9, v5, 3, v6
    v_lshl_add_u32 v10, v9, 2, v6
    v_lshl_add_u32 v10, v10, 6, v8
    v_add_u32 v30, 49152, v10
    v_xor_b32 v31, 64, v30
    v_xor_b32 v32, 128, v30
    v_xor_b32 v33, 192, v30
    s_lshl_b32 s59, s46, 11
    s_lshl_b32 s60, s46, 10
    v_mov_b32 v9, 0x40000000
    v_cmp_eq_u32 vcc, 63, v1
    s_getreg_b32 s83, hwreg(HW_REG_XCC_ID)
    s_mov_b32 s81, 0
    v_cndmask_b32 v41, v9, 0, vcc
    v_lshl_add_u32 v9, v5, 3, v6
    s_and_b32 s84, s2, 7
    s_lshl_b32 s84, s84, 5
    s_add_u32 s84, s84, s48
    s_lshl3_add_u32 s84, s84, 0xe4c000
    s_mov_b32 s34, 0x100
    s_mov_b32 s35, s7
    s_mov_b32 s38, 0x400
    s_mov_b32 s39, s7
    s_mov_b32 s14, 0x158000
    s_mov_b32 s15, s7
    s_mov_b32 s30, 0x200000
    s_mov_b32 s31, s7
    v_lshrrev_b32 v10, 1, v6
    v_lshl_add_u32 v10, v9, 1, v10
    v_lshl_add_u32 v10, v10, 6, v8
    v_add_u32 v34, 49152, v10
    v_xor_b32 v35, 64, v34
    v_lshl_add_u32 v10, v9, 6, v8
    v_add_u32 v40, 131072, v10
    v_lshlrev_b32 v10, 2, v7
    v_xor_b32 v10, v10, v1
    v_and_b32 v10, 7, v10
    v_lshlrev_b32 v10, 4, v10
    v_lshrrev_b32 v11, 3, v1
    v_lshl_add_u32 v50, v11, 10, v10
    s_lshl_b32 s52, s46, 4
    v_add_u32 v11, s52, v11
    s_mul_i32 s53, s51, 3
    s_add_u32 s53, s53, s50
    s_mul_i32 s54, s47, 5
    s_add_u32 s53, s53, s54
    s_lshl_b32 s54, s53, 7
    v_add_u32 v10, s54, v10
    s_movk_i32 s55, 2752
    v_mad_u32_u24 v20, v11, s55, v10
    v_lshrrev_b32 v11, 2, v1
    v_add_u32 v11, s52, v11
    v_and_b32 v10, 3, v1
    s_mul_i32 s54, s51, 320
    s_mul_i32 s52, s47, 768
    s_addk_i32 s54, 1024
    s_add_u32 s54, s54, s52
    v_lshl_add_u32 v10, v10, 4, s54
    v_mad_u32_u24 v21, v11, s55, v10
    v_add_u32 v21, 20992, v20
    v_add_u32 v36, 81920, v34
    v_add_u32 v37, 81920, v35
    s_lshl_b32 s53, s53, 1
    s_mul_i32 s54, s51, 5
    s_mul_i32 s55, s47, 12
    s_add_u32 s54, s54, s55
    s_add_u32 s54, s54, 12
    s_cmp_eq_u32 s50, 3
    s_cselect_b32 s53, s54, s53
    s_lshl2_add_u32 s40, s49, s46
    s_mul_i32 s54, s40, 44
    s_add_u32 s53, s53, s54
    s_lshl_b32 s53, s53, 11
    s_add_u32 s66, s53, 0x600000
    s_lshl_b32 s67, s40, 9
    s_add_u32 s67, s67, 0xe00000
    s_lshl_b32 s54, s50, 21
    s_lshl_b32 s55, s51, 19
    s_add_u32 s54, s54, s55
    s_lshl_b32 s55, s40, 10
    s_add_u32 s65, s54, s55
    s_mov_b32 s42, 0x3eb8aa3b
    s_cmp_eq_u32 s50, 0
    s_cselect_b32 s42, s42, 1.0
    s_mov_b32 s43, s42
    s_mov_b32 s44, 0xbfb8aa3b
    s_mov_b32 s45, s44
    s_and_b32 s54, s49, 3
    s_lshr_b32 s54, s54, 1
    s_add_u32 s55, s50, 1
    s_bfe_u32 s55, s55, 0x10001
    s_and_b32 s54, s54, s55
    s_cmp_lt_u32 s49, 12
    s_cselect_b32 s82, s54, 0
    s_and_b32 s54, s48, 7
    s_lshl_b32 s55, s54, 7
    v_add_u32 v50, s55, v50
    s_lshl_b32 s55, s49, 1
    s_xor_b32 s55, s55, s54
    s_and_b32 s76, s55, 7
    s_and_b32 s55, s76, 0
    s_lshl_b32 s75, s55, 12
    s_lshl_b32 s55, s55, 1
    s_xor_b32 s55, s55, s46
    s_lshl_b32 s77, s55, 15
    s_and_b32 s76, s76, 0
    v_add_u32 v51, 7168, v50
    v_add_u32 v52, 7168, v51
    v_add_u32 v53, 7168, v52
    s_lshl2_add_u32 s52, s49, s51
    s_lshl_b32 s52, s52, 4
    s_add_u32 s52, s52, s46
    s_lshl_b32 s53, s50, 2
    s_add_u32 s53, s53, 1020
    s_cmp_eq_u32 s50, 0
    s_cselect_b32 s53, 0, s53
    s_add_u32 s52, s52, s53
    s_lshl3_add_u32 s68, s52, 0xe40000
    s_lshl1_add_u32 s52, s40, s47
    s_lshl_b32 s52, s52, 7
    s_bfe_u32 s56, s57, 0x30004
    s_lshl_b32 s62, s56, 7
    s_mul_i32 s63, s56, s61
    s_add_u32 m0, s58, 65536
    s_nop 0
    buffer_load_dwordx4 v16, s[8:11], s63 offen offset:0  lds
    buffer_load_dwordx4 v17, s[8:11], s63 offen offset:1024  lds
    buffer_load_dwordx4 v18, s[8:11], s63 offen offset:2048  lds
    buffer_load_dwordx4 v19, s[8:11], s63 offen offset:3072  lds
    s_add_u32 m0, s58, 16384
    s_nop 0
    buffer_load_dwordx4 v12, s[4:7], s62 offen offset:0  lds
    buffer_load_dwordx4 v13, s[4:7], s62 offen offset:1024  lds
    buffer_load_dwordx4 v14, s[4:7], s62 offen offset:2048  lds
    buffer_load_dwordx4 v15, s[4:7], s62 offen offset:3072  lds
    s_waitcnt vmcnt(11)
    s_waitcnt lgkmcnt(0)
    s_barrier
    ds_read_b128 a[0:3], v22 offset:0
    ds_read_b64_tr_b16 v[220:221], v30 offset:0
    ds_read_b64_tr_b16 v[222:223], v30 offset:1024
    ds_read_b64_tr_b16 v[224:225], v31 offset:0
    ds_read_b64_tr_b16 v[226:227], v31 offset:1024
    ds_read_b64_tr_b16 v[228:229], v32 offset:0
    ds_read_b64_tr_b16 v[230:231], v32 offset:1024
    ds_read_b64_tr_b16 v[232:233], v33 offset:0
    ds_read_b64_tr_b16 v[234:235], v33 offset:1024
    ds_read_b128 a[4:7], v23 offset:0
    ds_read_b64_tr_b16 v[236:237], v30 offset:4096
    ds_read_b64_tr_b16 v[238:239], v30 offset:5120
    ds_read_b64_tr_b16 v[240:241], v31 offset:4096
    ds_read_b64_tr_b16 v[242:243], v31 offset:5120
    .p2align 3
    s_waitcnt lgkmcnt(9)
    v_mfma_f32_32x32x16_bf16 v[124:139], v[220:223], a[0:3], 0
    ds_read_b64_tr_b16 v[244:245], v32 offset:4096
    ds_read_b64_tr_b16 v[246:247], v32 offset:5120
    s_bfe_u32 s56, s57, 0x30008
    s_lshl_b32 s62, s56, 7
    s_mul_i32 s63, s56, s61
    s_add_u32 m0, s58, 81920
    s_nop 0
    buffer_load_dwordx4 v16, s[8:11], s63 offen offset:0  lds
    s_add_u32 s52, s52, 0xe44000
    v_mfma_f32_32x32x16_bf16 v[140:155], v[224:227], a[0:3], 0
    ds_read_b64_tr_b16 v[248:249], v33 offset:4096
    ds_read_b64_tr_b16 v[250:251], v33 offset:5120
    buffer_load_dwordx4 v17, s[8:11], s63 offen offset:1024  lds
    s_lshl2_add_u32 s80, s54, s52
    s_waitcnt lgkmcnt(9)
    v_mfma_f32_32x32x16_bf16 v[156:171], v[228:231], a[0:3], 0
    ds_read_b128 a[8:11], v24 offset:0
    ds_read_b64_tr_b16 v[220:221], v30 offset:8192
    ds_read_b64_tr_b16 v[222:223], v30 offset:9216
    buffer_load_dwordx4 v18, s[8:11], s63 offen offset:2048  lds
    v_and_b32 v9, 7, v1
    v_mfma_f32_32x32x16_bf16 v[172:187], v[232:235], a[0:3], 0
    ds_read_b64_tr_b16 v[224:225], v31 offset:8192
    ds_read_b64_tr_b16 v[226:227], v31 offset:9216
    buffer_load_dwordx4 v19, s[8:11], s63 offen offset:3072  lds
    v_lshl_add_u32 v44, v9, 2, s52
    s_waitcnt lgkmcnt(9)
    v_mfma_f32_32x32x16_bf16 v[124:139], v[236:239], a[4:7], v[124:139]
    ds_read_b64_tr_b16 v[228:229], v32 offset:8192
    ds_read_b64_tr_b16 v[230:231], v32 offset:9216
    s_and_b32 s52, s40, -8
    s_lshl1_add_u32 s52, s46, s52
    v_mfma_f32_32x32x16_bf16 v[140:155], v[240:243], a[4:7], v[140:155]
    ds_read_b64_tr_b16 v[232:233], v33 offset:8192
    ds_read_b64_tr_b16 v[234:235], v33 offset:9216
    s_add_u32 m0, s58, 114688
    s_nop 0
    buffer_load_dwordx4 v12, s[4:7], s62 offen offset:0  lds
    s_add_u32 s52, s52, s47
    s_waitcnt lgkmcnt(9)
    v_mfma_f32_32x32x16_bf16 v[156:171], v[244:247], a[4:7], v[156:171]
    ds_read_b128 a[12:15], v25 offset:0
    ds_read_b64_tr_b16 v[236:237], v30 offset:12288
    ds_read_b64_tr_b16 v[238:239], v30 offset:13312
    buffer_load_dwordx4 v13, s[4:7], s62 offen offset:1024  lds
    s_lshl_b32 s52, s52, 7
    v_mfma_f32_32x32x16_bf16 v[172:187], v[248:251], a[4:7], v[172:187]
    ds_read_b64_tr_b16 v[240:241], v31 offset:12288
    ds_read_b64_tr_b16 v[242:243], v31 offset:13312
    buffer_load_dwordx4 v14, s[4:7], s62 offen offset:2048  lds
    s_add_u32 s52, s52, 0xe48000
    s_waitcnt lgkmcnt(9)
    v_mfma_f32_32x32x16_bf16 v[124:139], v[220:223], a[8:11], v[124:139]
    ds_read_b64_tr_b16 v[244:245], v32 offset:12288
    ds_read_b64_tr_b16 v[246:247], v32 offset:13312
    buffer_load_dwordx4 v15, s[4:7], s62 offen offset:3072  lds
    v_and_b32 v10, 15, v1
    v_mfma_f32_32x32x16_bf16 v[140:155], v[224:227], a[8:11], v[140:155]
    ds_read_b64_tr_b16 v[248:249], v33 offset:12288
    ds_read_b64_tr_b16 v[250:251], v33 offset:13312
    v_lshl_add_u32 v45, v10, 2, s52
    s_lshl1_add_u32 s52, s40, s47
    s_waitcnt lgkmcnt(9)
    v_mfma_f32_32x32x16_bf16 v[156:171], v[228:231], a[8:11], v[156:171]
    s_waitcnt vmcnt(8)
    s_barrier
    ds_read_b128 a[16:19], v22 offset:16384
    ds_read_b64_tr_b16 v[220:221], v30 offset:16384
    ds_read_b64_tr_b16 v[222:223], v30 offset:17408
    s_bfe_u32 s56, s57, 0x3000c
    s_lshl_b32 s62, s56, 7
    s_mul_i32 s63, s56, s61
    s_add_u32 m0, s58, 98304
    s_nop 0
    buffer_load_dwordx4 v16, s[8:11], s63 offen offset:0  lds
    s_mul_i32 s53, s52, 45056
    v_mfma_f32_32x32x16_bf16 v[172:187], v[232:235], a[8:11], v[172:187]
    ds_read_b64_tr_b16 v[224:225], v31 offset:16384
    ds_read_b64_tr_b16 v[226:227], v31 offset:17408
    v_add_u32 v72, 1, v70
    v_mov_b32 v73, v71
    v_mov_b32 v74, 1
    v_mov_b32 v75, 0
    buffer_store_dwordx4 v[72:75], v41, s[32:35], s90 offen sc1
    buffer_store_dwordx2 v[72:73], v41, s[24:27], s91 offen sc1
    s_add_u32 s53, s53, 0x600000
    s_waitcnt lgkmcnt(9)
    v_mfma_f32_32x32x16_bf16 v[124:139], v[236:239], a[12:15], v[124:139]
    ds_read_b64_tr_b16 v[228:229], v32 offset:16384
    ds_read_b64_tr_b16 v[230:231], v32 offset:17408
    buffer_load_dwordx4 v17, s[8:11], s63 offen offset:1024  lds
    v_add_u32 v64, s53, v2
    v_mfma_f32_32x32x16_bf16 v[140:155], v[240:243], a[12:15], v[140:155]
    ds_read_b64_tr_b16 v[232:233], v33 offset:16384
    ds_read_b64_tr_b16 v[234:235], v33 offset:17408
    s_lshl3_add_u32 s52, s52, s76
    s_lshl_b32 s52, s52, 11
    s_waitcnt lgkmcnt(9)
    v_mfma_f32_32x32x16_bf16 v[156:171], v[244:247], a[12:15], v[156:171]
    ds_read_b128 a[20:23], v23 offset:16384
    ds_read_b64_tr_b16 v[236:237], v30 offset:20480
    ds_read_b64_tr_b16 v[238:239], v30 offset:21504
    buffer_load_dwordx4 v18, s[8:11], s63 offen offset:2048  lds
    buffer_load_dword v55, v78, s[16:19], 0 offen
    s_add_u32 s78, s52, 0xc00000
    v_mfma_f32_32x32x16_bf16 v[172:187], v[248:251], a[12:15], v[172:187]
    ds_read_b64_tr_b16 v[240:241], v31 offset:20480
    ds_read_b64_tr_b16 v[242:243], v31 offset:21504
    v_lshl_add_u32 v62, v4, 4, s67
    s_lshl_b32 s52, s40, 8
    s_waitcnt lgkmcnt(9)
    v_mfma_f32_32x32x16_bf16 v[124:139], v[220:223], a[16:19], v[124:139]
    ds_read_b64_tr_b16 v[244:245], v32 offset:20480
    ds_read_b64_tr_b16 v[246:247], v32 offset:21504
    buffer_load_dwordx4 v19, s[8:11], s63 offen offset:3072  lds
    s_lshl1_add_u32 s53, s54, s47
    v_mfma_f32_32x32x16_bf16 v[140:155], v[224:227], a[16:19], v[140:155]
    ds_read_b64_tr_b16 v[248:249], v33 offset:20480
    ds_read_b64_tr_b16 v[250:251], v33 offset:21504
    s_add_u32 s52, s52, s54
    s_lshl1_add_u32 s52, s52, s47
    s_waitcnt lgkmcnt(9)
    v_mfma_f32_32x32x16_bf16 v[156:171], v[228:231], a[16:19], v[156:171]
    ds_read_b128 a[24:27], v24 offset:16384
    ds_read_b64_tr_b16 v[220:221], v30 offset:24576
    ds_read_b64_tr_b16 v[222:223], v30 offset:25600
    s_add_u32 m0, s58, 32768
    s_nop 0
    buffer_load_dwordx4 v12, s[4:7], s62 offen offset:0  lds
    s_lshl_b32 s52, s52, 6
    v_mfma_f32_32x32x16_bf16 v[172:187], v[232:235], a[16:19], v[172:187]
    ds_read_b64_tr_b16 v[224:225], v31 offset:24576
    ds_read_b64_tr_b16 v[226:227], v31 offset:25600
    v_and_b32 v63, 3, v1
    v_lshl_add_u32 v63, v63, 4, s52
    s_waitcnt lgkmcnt(9)
    v_mfma_f32_32x32x16_bf16 v[124:139], v[236:239], a[20:23], v[124:139]
    ds_read_b64_tr_b16 v[228:229], v32 offset:24576
    ds_read_b64_tr_b16 v[230:231], v32 offset:25600
    buffer_load_dwordx4 v13, s[4:7], s62 offen offset:1024  lds
    v_lshrrev_b32 v9, 2, v1
    v_mfma_f32_32x32x16_bf16 v[140:155], v[240:243], a[20:23], v[140:155]
    ds_read_b64_tr_b16 v[232:233], v33 offset:24576
    ds_read_b64_tr_b16 v[234:235], v33 offset:25600
    v_lshl_add_u32 v63, v9, 10, v63
    v_lshrrev_b32 v66, 4, v1
    s_waitcnt lgkmcnt(9)
    v_mfma_f32_32x32x16_bf16 v[156:171], v[244:247], a[20:23], v[156:171]
    ds_read_b128 a[28:31], v25 offset:16384
    ds_read_b64_tr_b16 v[236:237], v30 offset:28672
    ds_read_b64_tr_b16 v[238:239], v30 offset:29696
    buffer_load_dwordx4 v14, s[4:7], s62 offen offset:2048  lds
    v_xor_b32 v66, v66, v1
    v_mfma_f32_32x32x16_bf16 v[172:187], v[248:251], a[20:23], v[172:187]
    ds_read_b64_tr_b16 v[240:241], v31 offset:28672
    ds_read_b64_tr_b16 v[242:243], v31 offset:29696
    v_and_b32 v66, 3, v66
    v_lshlrev_b32 v66, 4, v66
    s_waitcnt lgkmcnt(9)
    v_mfma_f32_32x32x16_bf16 v[124:139], v[220:223], a[24:27], v[124:139]
    ds_read_b64_tr_b16 v[244:245], v32 offset:28672
    ds_read_b64_tr_b16 v[246:247], v32 offset:29696
    buffer_load_dwordx4 v15, s[4:7], s62 offen offset:3072  lds
    v_lshl_add_u32 v66, v9, 6, v66
    v_mfma_f32_32x32x16_bf16 v[140:155], v[224:227], a[24:27], v[140:155]
    ds_read_b64_tr_b16 v[248:249], v33 offset:28672
    ds_read_b64_tr_b16 v[250:251], v33 offset:29696
    v_lshl_add_u32 v66, s46, 11, v66
    v_lshrrev_b32 v65, 2, v4
    s_waitcnt lgkmcnt(9)
    v_mfma_f32_32x32x16_bf16 v[156:171], v[228:231], a[24:27], v[156:171]
    s_waitcnt vmcnt(11)
    s_barrier
    ds_read_b128 a[32:35], v26
    ds_read_b64_tr_b16 v[220:221], v30 offset:32768
    ds_read_b64_tr_b16 v[222:223], v30 offset:33792
    s_bfe_u32 s56, s57, 0x30010
    s_lshl_b32 s62, s56, 7
    s_mul_i32 s63, s56, s61
    s_add_u32 m0, s58, 49152
    s_nop 0
    buffer_load_dwordx4 v16, s[8:11], s63 offen offset:0  lds
    v_and_b32 v65, 3, v65
    v_mfma_f32_32x32x16_bf16 v[172:187], v[232:235], a[24:27], v[172:187]
    ds_read_b64_tr_b16 v[224:225], v31 offset:32768
    ds_read_b64_tr_b16 v[226:227], v31 offset:33792
    v_lshlrev_b32 v65, 4, v65
    v_lshl_add_u32 v65, v5, 3, v65
    s_waitcnt lgkmcnt(9)
    v_mfma_f32_32x32x16_bf16 v[124:139], v[236:239], a[28:31], v[124:139]
    ds_read_b64_tr_b16 v[228:229], v32 offset:32768
    ds_read_b64_tr_b16 v[230:231], v32 offset:33792
    buffer_load_dwordx4 v17, s[8:11], s63 offen offset:1024  lds
    v_lshl_add_u32 v65, v4, 6, v65
    v_mfma_f32_32x32x16_bf16 v[140:155], v[240:243], a[28:31], v[140:155]
    ds_read_b64_tr_b16 v[232:233], v33 offset:32768
    ds_read_b64_tr_b16 v[234:235], v33 offset:33792
    v_lshl_add_u32 v65, s46, 11, v65
    s_lshl4_add_u32 s53, s49, s53
    s_waitcnt lgkmcnt(9)
    v_mfma_f32_32x32x16_bf16 v[156:171], v[244:247], a[28:31], v[156:171]
    ds_read_b128 a[36:39], v27
    ds_read_b64_tr_b16 v[236:237], v30 offset:36864
    ds_read_b64_tr_b16 v[238:239], v30 offset:37888
    buffer_load_dwordx4 v18, s[8:11], s63 offen offset:2048  lds
    s_lshl2_add_u32 s53, s53, s46
    v_mfma_f32_32x32x16_bf16 v[172:187], v[248:251], a[28:31], v[172:187]
    ds_read_b64_tr_b16 v[240:241], v31 offset:36864
    ds_read_b64_tr_b16 v[242:243], v31 offset:37888
    s_lshl_b32 s53, s53, 12
    s_add_u32 s53, s53, 0x1000000
    s_waitcnt lgkmcnt(9)
    v_mfma_f32_32x32x16_bf16 v[124:139], v[220:223], a[32:35], v[124:139]
    ds_read_b64_tr_b16 v[244:245], v32 offset:36864
    ds_read_b64_tr_b16 v[246:247], v32 offset:37888
    buffer_load_dwordx4 v19, s[8:11], s63 offen offset:3072  lds
    s_xor_b32 s79, s53, 0x4000
    v_mfma_f32_32x32x16_bf16 v[140:155], v[224:227], a[32:35], v[140:155]
    ds_read_b64_tr_b16 v[248:249], v33 offset:36864
    ds_read_b64_tr_b16 v[250:251], v33 offset:37888
    v_cmp_gt_u32 vcc, 32, v1
    s_addk_i32 s53, 2048
    v_mov_b32 v9, s53
    v_cndmask_b32 v45, v9, v45, vcc
    v_lshl_add_u32 v9, v5, 2, v6
    s_waitcnt lgkmcnt(9)
    v_mfma_f32_32x32x16_bf16 v[156:171], v[228:231], a[32:35], v[156:171]
    ds_read_b128 a[40:43], v28
    ds_read_b64_tr_b16 v[220:221], v30 offset:40960
    ds_read_b64_tr_b16 v[222:223], v30 offset:41984
    s_mov_b32 m0, s58
    s_nop 0
    buffer_load_dwordx4 v12, s[4:7], s62 offen offset:0  lds
    v_lshrrev_b32 v11, 1, v6
    v_mfma_f32_32x32x16_bf16 v[172:187], v[232:235], a[32:35], v[172:187]
    ds_read_b64_tr_b16 v[224:225], v31 offset:40960
    ds_read_b64_tr_b16 v[226:227], v31 offset:41984
    v_xor_b32 v11, s47, v11
    v_lshl_add_u32 v9, v9, 1, v11
    s_waitcnt lgkmcnt(9)
    v_mfma_f32_32x32x16_bf16 v[124:139], v[236:239], a[36:39], v[124:139]
    ds_read_b64_tr_b16 v[228:229], v32 offset:40960
    ds_read_b64_tr_b16 v[230:231], v32 offset:41984
    buffer_load_dwordx4 v13, s[4:7], s62 offen offset:1024  lds
    v_lshl_add_u32 v56, v9, 6, v8
    v_mfma_f32_32x32x16_bf16 v[140:155], v[240:243], a[36:39], v[140:155]
    ds_read_b64_tr_b16 v[232:233], v33 offset:40960
    ds_read_b64_tr_b16 v[234:235], v33 offset:41984
    v_add_u32 v57, 0x10000, v56
    v_add_u32 v58, 0x20000, v56
    s_waitcnt lgkmcnt(9)
    v_mfma_f32_32x32x16_bf16 v[156:171], v[244:247], a[36:39], v[156:171]
    ds_read_b128 a[44:47], v29
    ds_read_b64_tr_b16 v[236:237], v30 offset:45056
    ds_read_b64_tr_b16 v[238:239], v30 offset:46080
    buffer_load_dwordx4 v14, s[4:7], s62 offen offset:2048  lds
    v_xor_b32 v59, 64, v56
    v_mfma_f32_32x32x16_bf16 v[172:187], v[248:251], a[36:39], v[172:187]
    ds_read_b64_tr_b16 v[240:241], v31 offset:45056
    ds_read_b64_tr_b16 v[242:243], v31 offset:46080
    v_xor_b32 v60, 64, v57
    v_xor_b32 v61, 64, v58
    s_waitcnt lgkmcnt(9)
    v_mfma_f32_32x32x16_bf16 v[124:139], v[220:223], a[40:43], v[124:139]
    ds_read_b64_tr_b16 v[244:245], v32 offset:45056
    ds_read_b64_tr_b16 v[246:247], v32 offset:46080
    buffer_load_dwordx4 v15, s[4:7], s62 offen offset:3072  lds
    s_and_b32 s54, s48, 15
    v_mfma_f32_32x32x16_bf16 v[140:155], v[224:227], a[40:43], v[140:155]
    ds_read_b64_tr_b16 v[248:249], v33 offset:45056
    ds_read_b64_tr_b16 v[250:251], v33 offset:46080
    s_lshl4_add_u32 s54, s47, s54
    s_lshr_b32 s41, s49, 1
    s_waitcnt lgkmcnt(9)
    v_mfma_f32_32x32x16_bf16 v[156:171], v[228:231], a[40:43], v[156:171]
    s_waitcnt vmcnt(8)
    s_barrier
    ds_read_b128 a[48:51], v22 offset:32768
    ds_read_b64_tr_b16 v[220:221], v30 offset:49152
    ds_read_b64_tr_b16 v[222:223], v30 offset:50176
    s_bfe_u32 s56, s57, 0x30014
    s_lshl_b32 s62, s56, 7
    s_mul_i32 s63, s56, s61
    s_add_u32 m0, s58, 65536
    s_nop 0
    buffer_load_dwordx4 v16, s[8:11], s63 offen offset:0  lds
    s_sub_u32 s52, 7, s46
    v_mfma_f32_32x32x16_bf16 v[172:187], v[232:235], a[40:43], v[172:187]
    ds_read_b64_tr_b16 v[224:225], v31 offset:49152
    ds_read_b64_tr_b16 v[226:227], v31 offset:50176
    buffer_load_dwordx4 v17, s[8:11], s63 offen offset:1024  lds
    buffer_load_dwordx4 v[72:75], off, s[32:35], 0 sc1
    s_movk_i32 s53, -1024
    s_waitcnt lgkmcnt(9)
    v_mfma_f32_32x32x16_bf16 v[124:139], v[236:239], a[44:47], v[124:139]
    ds_read_b64_tr_b16 v[228:229], v32 offset:49152
    ds_read_b64_tr_b16 v[230:231], v32 offset:50176
    buffer_load_dwordx4 v18, s[8:11], s63 offen offset:2048  lds
    s_cmp_eq_u32 s41, 0
    s_cselect_b32 s85, s52, 12
    s_cselect_b32 s86, 0, 0x3f803f80
    s_cselect_b32 s87, 0, -1
    v_mfma_f32_32x32x16_bf16 v[140:155], v[240:243], a[44:47], v[140:155]
    ds_read_b64_tr_b16 v[232:233], v33 offset:49152
    ds_read_b64_tr_b16 v[234:235], v33 offset:50176
    buffer_load_dwordx4 v19, s[8:11], s63 offen offset:3072  lds
    s_bitcmp1_b32 s41, 0
    s_cselect_b32 s52, s46, s52
    s_cselect_b32 s67, 0x400, s53
    s_waitcnt lgkmcnt(9)
    v_mfma_f32_32x32x16_bf16 v[156:171], v[244:247], a[44:47], v[156:171]
    ds_read_b128 a[52:55], v23 offset:32768
    ds_read_b64_tr_b16 v[236:237], v30 offset:53248
    ds_read_b64_tr_b16 v[238:239], v30 offset:54272
    s_add_u32 m0, s58, 16384
    s_nop 0
    buffer_load_dwordx4 v12, s[4:7], s62 offen offset:0  lds
    s_and_b32 s87, s87, s67
    v_mfma_f32_32x32x16_bf16 v[172:187], v[248:251], a[44:47], v[172:187]
    ds_read_b64_tr_b16 v[240:241], v31 offset:53248
    ds_read_b64_tr_b16 v[242:243], v31 offset:54272
    buffer_load_dwordx4 v13, s[4:7], s62 offen offset:1024  lds
    s_lshl3_add_u32 s55, s41, s52
    s_waitcnt lgkmcnt(9)
    v_mfma_f32_32x32x16_bf16 v[124:139], v[220:223], a[48:51], v[124:139]
    ds_read_b64_tr_b16 v[244:245], v32 offset:53248
    ds_read_b64_tr_b16 v[246:247], v32 offset:54272
    buffer_load_dwordx4 v14, s[4:7], s62 offen offset:2048  lds
    s_lshl_b32 s40, s54, 6
    v_mfma_f32_32x32x16_bf16 v[140:155], v[224:227], a[48:51], v[140:155]
    ds_read_b64_tr_b16 v[248:249], v33 offset:53248
    ds_read_b64_tr_b16 v[250:251], v33 offset:54272
    buffer_load_dwordx4 v15, s[4:7], s62 offen offset:3072  lds
    s_add_u32 s72, s40, s55
    s_waitcnt lgkmcnt(9)
    v_mfma_f32_32x32x16_bf16 v[156:171], v[228:231], a[48:51], v[156:171]
    ds_read_b128 a[56:59], v24 offset:32768
    ds_read_b64_tr_b16 v[220:221], v30 offset:57344
    ds_read_b64_tr_b16 v[222:223], v30 offset:58368
    s_bfe_u32 s56, s57, 0x30018
    s_lshl_b32 s62, s56, 7
    s_mul_i32 s63, s56, s61
    s_add_u32 m0, s58, 114688
    s_nop 0
    buffer_load_dwordx4 v12, s[4:7], s62 offen offset:0  lds
    s_lshl_b32 s72, s72, 10
    v_mfma_f32_32x32x16_bf16 v[172:187], v[232:235], a[48:51], v[172:187]
    ds_read_b64_tr_b16 v[224:225], v31 offset:57344
    ds_read_b64_tr_b16 v[226:227], v31 offset:58368
    buffer_load_dwordx4 v13, s[4:7], s62 offen offset:1024  lds
    s_lshl_b32 s55, s55, 5
    s_waitcnt lgkmcnt(9)
    v_mfma_f32_32x32x16_bf16 v[124:139], v[236:239], a[52:55], v[124:139]
    ds_read_b64_tr_b16 v[228:229], v32 offset:57344
    ds_read_b64_tr_b16 v[230:231], v32 offset:58368
    buffer_load_dwordx4 v14, s[4:7], s62 offen offset:2048  lds
    s_add_u32 s55, s55, s54
    v_mfma_f32_32x32x16_bf16 v[140:155], v[240:243], a[52:55], v[140:155]
    ds_read_b64_tr_b16 v[232:233], v33 offset:57344
    ds_read_b64_tr_b16 v[234:235], v33 offset:58368
    buffer_load_dwordx4 v15, s[4:7], s62 offen offset:3072  lds
    s_lshl_b32 s55, s55, 10
    s_waitcnt lgkmcnt(9)
    v_mfma_f32_32x32x16_bf16 v[156:171], v[244:247], a[52:55], v[156:171]
    ds_read_b128 a[60:63], v25 offset:32768
    ds_read_b64_tr_b16 v[236:237], v30 offset:61440
    ds_read_b64_tr_b16 v[238:239], v30 offset:62464
    s_add_u32 m0, s58, 81920
    s_nop 0
    buffer_load_dwordx4 v16, s[8:11], s63 offen offset:0  lds
    s_add_u32 s74, s55, 0xc00000
    v_mfma_f32_32x32x16_bf16 v[172:187], v[248:251], a[52:55], v[172:187]
    ds_read_b64_tr_b16 v[240:241], v31 offset:61440
    ds_read_b64_tr_b16 v[242:243], v31 offset:62464
    buffer_load_dwordx4 v17, s[8:11], s63 offen offset:1024  lds
    s_and_b32 s52, s52, 3
    s_waitcnt lgkmcnt(9)
    v_mfma_f32_32x32x16_bf16 v[124:139], v[220:223], a[56:59], v[124:139]
    ds_read_b64_tr_b16 v[244:245], v32 offset:61440
    ds_read_b64_tr_b16 v[246:247], v32 offset:62464
    buffer_load_dwordx4 v18, s[8:11], s63 offen offset:2048  lds
    s_lshl2_add_u32 s55, s41, s52
    v_mfma_f32_32x32x16_bf16 v[140:155], v[224:227], a[56:59], v[140:155]
    ds_read_b64_tr_b16 v[248:249], v33 offset:61440
    ds_read_b64_tr_b16 v[250:251], v33 offset:62464
    buffer_load_dwordx4 v19, s[8:11], s63 offen offset:3072  lds
    s_lshl1_add_u32 s55, s55, s47
    s_waitcnt lgkmcnt(9)
    v_mfma_f32_32x32x16_bf16 v[156:171], v[228:231], a[56:59], v[156:171]
    s_waitcnt vmcnt(17)
    s_barrier
    ds_read_b128 a[64:67], v22 offset:0
    ds_read_b64_tr_b16 v[220:221], v30 offset:0
    ds_read_b64_tr_b16 v[222:223], v30 offset:1024
    s_bfe_u32 s56, s57, 0x3001c
    s_lshl_b32 s62, s56, 7
    s_mul_i32 s63, s56, s61
    s_add_u32 m0, s58, 32768
    s_nop 0
    buffer_load_dwordx4 v12, s[4:7], s62 offen offset:0  lds
    s_lshl_b32 s55, s55, 5
    v_mfma_f32_32x32x16_bf16 v[172:187], v[232:235], a[56:59], v[172:187]
    ds_read_b64_tr_b16 v[224:225], v31 offset:0
    ds_read_b64_tr_b16 v[226:227], v31 offset:1024
    s_waitcnt vmcnt(15)
    v_cmp_eq_u32 vcc, 0, v74
    s_cbranch_vccnz TAGQK_slow
TAGQK_back:
    v_mov_b32 v68, v72
    v_add_u32 v69, s83, v73
    buffer_store_dwordx2 v[68:69], v41, s[24:27], s84 offen
    s_and_b32 s53, s48, 15
    s_waitcnt lgkmcnt(9)
    v_mfma_f32_32x32x16_bf16 v[124:139], v[236:239], a[60:63], v[124:139]
    ds_read_b64_tr_b16 v[228:229], v32 offset:0
    ds_read_b64_tr_b16 v[230:231], v32 offset:1024
    buffer_load_dwordx4 v13, s[4:7], s62 offen offset:1024  lds
    s_add_u32 s55, s55, s53
    v_mfma_f32_32x32x16_bf16 v[140:155], v[240:243], a[60:63], v[140:155]
    ds_read_b64_tr_b16 v[232:233], v33 offset:0
    ds_read_b64_tr_b16 v[234:235], v33 offset:1024
    s_lshl2_add_u32 s69, s55, 0xe48000
    s_lshr_b32 s54, s54, 3
    s_waitcnt lgkmcnt(9)
    v_mfma_f32_32x32x16_bf16 v[156:171], v[244:247], a[60:63], v[156:171]
    ds_read_b128 a[68:71], v23 offset:0
    ds_read_b64_tr_b16 v[236:237], v30 offset:4096
    ds_read_b64_tr_b16 v[238:239], v30 offset:5120
    buffer_load_dwordx4 v14, s[4:7], s62 offen offset:2048  lds
    s_lshl3_add_u32 s55, s41, s54
    v_mfma_f32_32x32x16_bf16 v[172:187], v[248:251], a[60:63], v[172:187]
    ds_read_b64_tr_b16 v[240:241], v31 offset:4096
    ds_read_b64_tr_b16 v[242:243], v31 offset:5120
    s_lshl4_add_u32 s55, s55, s52
    v_and_b32 v9, 1, v1
    s_waitcnt lgkmcnt(9)
    v_mfma_f32_32x32x16_bf16 v[124:139], v[220:223], a[64:67], v[124:139]
    ds_read_b64_tr_b16 v[244:245], v32 offset:4096
    ds_read_b64_tr_b16 v[246:247], v32 offset:5120
    buffer_load_dwordx4 v15, s[4:7], s62 offen offset:3072  lds
    v_lshl_add_u32 v11, v9, 6, s55
    v_mfma_f32_32x32x16_bf16 v[140:155], v[224:227], a[64:67], v[140:155]
    ds_read_b64_tr_b16 v[248:249], v33 offset:4096
    ds_read_b64_tr_b16 v[250:251], v33 offset:5120
    s_lshl_b32 s52, s46, 1
    s_sub_u32 s53, 7, s52
    s_waitcnt lgkmcnt(9)
    v_mfma_f32_32x32x16_bf16 v[156:171], v[228:231], a[64:67], v[156:171]
    ds_read_b128 a[72:75], v24 offset:0
    ds_read_b64_tr_b16 v[220:221], v30 offset:8192
    ds_read_b64_tr_b16 v[222:223], v30 offset:9216
    s_add_u32 m0, s58, 98304
    s_nop 0
    buffer_load_dwordx4 v16, s[8:11], s63 offen offset:0  lds
    s_sub_u32 s52, s52, 8
    v_mfma_f32_32x32x16_bf16 v[172:187], v[232:235], a[64:67], v[172:187]
    ds_read_b64_tr_b16 v[224:225], v31 offset:8192
    ds_read_b64_tr_b16 v[226:227], v31 offset:9216
    s_bitcmp1_b32 s41, 0
    s_cselect_b32 s52, s52, s53
    s_lshl3_add_u32 s52, s41, s52
    s_waitcnt lgkmcnt(9)
    v_mfma_f32_32x32x16_bf16 v[124:139], v[236:239], a[68:71], v[124:139]
    ds_read_b64_tr_b16 v[228:229], v32 offset:8192
    ds_read_b64_tr_b16 v[230:231], v32 offset:9216
    buffer_load_dwordx4 v17, s[8:11], s63 offen offset:1024  lds
    s_add_u32 s40, s40, s52
    v_mfma_f32_32x32x16_bf16 v[140:155], v[240:243], a[68:71], v[140:155]
    ds_read_b64_tr_b16 v[232:233], v33 offset:8192
    ds_read_b64_tr_b16 v[234:235], v33 offset:9216
    s_lshl_b32 s40, s40, 10
    s_add_u32 s70, s40, 0x200000
    s_waitcnt lgkmcnt(9)
    v_mfma_f32_32x32x16_bf16 v[156:171], v[244:247], a[68:71], v[156:171]
    ds_read_b128 a[76:79], v25 offset:0
    ds_read_b64_tr_b16 v[236:237], v30 offset:12288
    ds_read_b64_tr_b16 v[238:239], v30 offset:13312
    buffer_load_dwordx4 v18, s[8:11], s63 offen offset:2048  lds
    s_add_u32 s71, s40, 0x400000
    v_mfma_f32_32x32x16_bf16 v[172:187], v[248:251], a[68:71], v[172:187]
    ds_read_b64_tr_b16 v[240:241], v31 offset:12288
    ds_read_b64_tr_b16 v[242:243], v31 offset:13312
    s_and_b32 s53, s52, -4
    s_add_u32 s53, s53, s54
    s_waitcnt lgkmcnt(9)
    v_mfma_f32_32x32x16_bf16 v[124:139], v[220:223], a[72:75], v[124:139]
    ds_read_b64_tr_b16 v[244:245], v32 offset:12288
    ds_read_b64_tr_b16 v[246:247], v32 offset:13312
    buffer_load_dwordx4 v19, s[8:11], s63 offen offset:3072  lds
    s_and_b32 s52, s52, 2
    v_mfma_f32_32x32x16_bf16 v[140:155], v[224:227], a[72:75], v[140:155]
    ds_read_b64_tr_b16 v[248:249], v33 offset:12288
    ds_read_b64_tr_b16 v[250:251], v33 offset:13312
    s_lshl4_add_u32 s53, s53, s52
    s_addk_i32 s53, 1024
    s_waitcnt lgkmcnt(9)
    v_mfma_f32_32x32x16_bf16 v[156:171], v[228:231], a[72:75], v[156:171]
    s_waitcnt vmcnt(17)
    s_barrier
    ds_read_b128 a[80:83], v22 offset:16384
    ds_read_b64_tr_b16 v[220:221], v30 offset:16384
    ds_read_b64_tr_b16 v[222:223], v30 offset:17408
    s_bfe_u32 s56, s57, 0x30000
    s_mul_i32 s64, s56, 176128
    s_add_u32 m0, s59, 131072
    s_nop 0
    buffer_load_dwordx4 v20, s[12:15], s64 offen offset:0  lds
    v_and_b32 v42, 2, v1
    v_mfma_f32_32x32x16_bf16 v[172:187], v[232:235], a[72:75], v[172:187]
    ds_read_b64_tr_b16 v[224:225], v31 offset:16384
    ds_read_b64_tr_b16 v[226:227], v31 offset:17408
    buffer_load_dwordx4 v21, s[12:15], s64 offen offset:1024  lds
    v_lshl_add_u32 v43, v42, 1, v9
    s_waitcnt lgkmcnt(9)
    v_mfma_f32_32x32x16_bf16 v[124:139], v[236:239], a[76:79], v[124:139]
    ds_read_b64_tr_b16 v[228:229], v32 offset:16384
    ds_read_b64_tr_b16 v[230:231], v32 offset:17408
    s_bfe_u32 s56, s57, 0x30004
    s_mul_i32 s64, s56, 176128
    s_add_u32 m0, s59, 139264
    s_nop 0
    buffer_load_dwordx4 v20, s[12:15], s64 offen offset:0  lds
    v_add_u32 v43, s53, v43
    v_mfma_f32_32x32x16_bf16 v[140:155], v[240:243], a[76:79], v[140:155]
    ds_read_b64_tr_b16 v[232:233], v33 offset:16384
    ds_read_b64_tr_b16 v[234:235], v33 offset:17408
    buffer_load_dwordx4 v21, s[12:15], s64 offen offset:1024  lds
    s_mul_i32 s73, s46, 2080
    s_waitcnt lgkmcnt(9)
    v_mfma_f32_32x32x16_bf16 v[156:171], v[244:247], a[76:79], v[156:171]
    ds_read_b128 a[84:87], v23 offset:16384
    ds_read_b64_tr_b16 v[236:237], v30 offset:20480
    ds_read_b64_tr_b16 v[238:239], v30 offset:21504
    v_mul_u32_u24 v9, 1040, v9
    s_movk_i32 s55, 4160
    v_mfma_f32_32x32x16_bf16 v[172:187], v[248:251], a[76:79], v[172:187]
    ds_read_b64_tr_b16 v[240:241], v31 offset:20480
    ds_read_b64_tr_b16 v[242:243], v31 offset:21504
    s_bfe_u32 s56, s57, 0x30010
    s_mul_i32 s64, s56, 176128
    s_add_u32 m0, s59, 147456
    s_nop 0
    buffer_load_dwordx4 v20, s[12:15], s64 offen offset:0  lds
    v_mad_u32_u24 v9, v42, s55, v9
    s_waitcnt lgkmcnt(9)
    v_mfma_f32_32x32x16_bf16 v[124:139], v[220:223], a[80:83], v[124:139]
    ds_read_b64_tr_b16 v[244:245], v32 offset:20480
    ds_read_b64_tr_b16 v[246:247], v32 offset:21504
    buffer_load_dwordx4 v21, s[12:15], s64 offen offset:1024  lds
    buffer_load_dword v55, v41, s[24:27], s79 offen offset:2048 sc1
    s_add_u32 s73, s73, 16384
    v_mfma_f32_32x32x16_bf16 v[140:155], v[224:227], a[80:83], v[140:155]
    ds_read_b64_tr_b16 v[248:249], v33 offset:20480
    ds_read_b64_tr_b16 v[250:251], v33 offset:21504
    s_bfe_u32 s56, s57, 0x30014
    s_mul_i32 s64, s56, 176128
    s_add_u32 m0, s59, 155648
    s_nop 0
    buffer_load_dwordx4 v20, s[12:15], s64 offen offset:0  lds
    s_add_u32 s55, s73, 1024
    s_waitcnt lgkmcnt(9)
    v_mfma_f32_32x32x16_bf16 v[156:171], v[228:231], a[80:83], v[156:171]
    ds_read_b128 a[88:91], v24 offset:16384
    ds_read_b64_tr_b16 v[220:221], v30 offset:24576
    ds_read_b64_tr_b16 v[222:223], v30 offset:25600
    buffer_load_dwordx4 v21, s[12:15], s64 offen offset:1024  lds
    v_add_u32 v49, s55, v9
    v_mfma_f32_32x32x16_bf16 v[172:187], v[232:235], a[80:83], v[172:187]
    ds_read_b64_tr_b16 v[224:225], v31 offset:24576
    ds_read_b64_tr_b16 v[226:227], v31 offset:25600
    v_mov_b32 v9, s86
    v_cmp_eq_u32 vcc, 0, v42
    v_mov_b32 v80, 0x3f803f80
    s_mov_b32 s55, 0xe40000
    v_cndmask_b32 v80, v9, v80, vcc
    s_waitcnt lgkmcnt(9)
    v_mfma_f32_32x32x16_bf16 v[124:139], v[236:239], a[84:87], v[124:139]
    ds_read_b64_tr_b16 v[228:229], v32 offset:24576
    ds_read_b64_tr_b16 v[230:231], v32 offset:25600
    s_bfe_u32 s56, s57, 0x30008
    s_mul_i32 s64, s56, 176128
    s_add_u32 m0, s59, 49152
    s_nop 0
    buffer_load_dwordx4 v20, s[12:15], s64 offen offset:0  lds
    v_mov_b32 v81, v80
    v_mfma_f32_32x32x16_bf16 v[140:155], v[240:243], a[84:87], v[140:155]
    ds_read_b64_tr_b16 v[232:233], v33 offset:24576
    ds_read_b64_tr_b16 v[234:235], v33 offset:25600
    buffer_load_dwordx4 v21, s[12:15], s64 offen offset:1024  lds
    v_mov_b32 v82, v80
    s_waitcnt lgkmcnt(9)
    v_mfma_f32_32x32x16_bf16 v[156:171], v[244:247], a[84:87], v[156:171]
    ds_read_b128 a[92:95], v25 offset:16384
    ds_read_b64_tr_b16 v[236:237], v30 offset:28672
    ds_read_b64_tr_b16 v[238:239], v30 offset:29696
    s_bfe_u32 s56, s57, 0x3000c
    s_mul_i32 s64, s56, 176128
    s_add_u32 m0, s59, 57344
    s_nop 0
    buffer_load_dwordx4 v20, s[12:15], s64 offen offset:0  lds
    v_mov_b32 v83, v80
    v_mfma_f32_32x32x16_bf16 v[172:187], v[248:251], a[84:87], v[172:187]
    ds_read_b64_tr_b16 v[240:241], v31 offset:28672
    ds_read_b64_tr_b16 v[242:243], v31 offset:29696
    buffer_load_dwordx4 v21, s[12:15], s64 offen offset:1024  lds
    v_cmp_gt_u32 vcc, 32, v1
    v_add_u32 v46, s60, v2
    s_add_u32 s87, s87, s55
    v_cndmask_b32 v9, v11, v43, vcc
    s_waitcnt lgkmcnt(9)
    v_mfma_f32_32x32x16_bf16 v[124:139], v[220:223], a[88:91], v[124:139]
    ds_read_b64_tr_b16 v[244:245], v32 offset:28672
    ds_read_b64_tr_b16 v[246:247], v32 offset:29696
    v_lshl_add_u32 v42, v9, 3, s55
    v_lshl_add_u32 v43, v43, 3, s87
    v_mfma_f32_32x32x16_bf16 v[140:155], v[224:227], a[88:91], v[140:155]
    ds_read_b64_tr_b16 v[248:249], v33 offset:28672
    ds_read_b64_tr_b16 v[250:251], v33 offset:29696
    v_lshlrev_b32 v9, 8, v5
    v_lshl_add_u32 v9, v10, 4, v9
    s_waitcnt lgkmcnt(9)
    v_mfma_f32_32x32x16_bf16 v[156:171], v[228:231], a[88:91], v[156:171]
    s_waitcnt vmcnt(22)
    s_barrier
    ds_read_b128 a[96:99], v26
    ds_read_b64_tr_b16 v[220:221], v30 offset:32768
    ds_read_b64_tr_b16 v[222:223], v30 offset:33792
    v_and_b32 v77, 31, v1
    s_andn2_b32 s84, s84, 0xff
    v_lshlrev_b32 v77, 3, v77
    buffer_load_dwordx2 v[70:71], v77, s[24:27], s84 offen sc1
    v_add_u32 v11, 512, v9
    v_mfma_f32_32x32x16_bf16 v[172:187], v[232:235], a[88:91], v[172:187]
    ds_read_b64_tr_b16 v[224:225], v31 offset:32768
    ds_read_b64_tr_b16 v[226:227], v31 offset:33792
    v_cmp_eq_u32 vcc, 0, v7
    v_mov_b32 v48, 1024
    s_mul_i32 s55, s46, 1040
    v_cndmask_b32 v47, v48, v9, vcc
    v_cndmask_b32 v48, v48, v11, vcc
    v_add_u32 v47, s55, v47
    s_waitcnt lgkmcnt(9)
    v_mfma_f32_32x32x16_bf16 v[124:139], v[236:239], a[92:95], v[124:139]
    ds_read_b64_tr_b16 v[228:229], v32 offset:32768
    ds_read_b64_tr_b16 v[230:231], v32 offset:33792
    v_add_u32 v48, s55, v48
    v_lshl_add_u32 v84, v7, 16, v9
    v_mfma_f32_32x32x16_bf16 v[140:155], v[240:243], a[92:95], v[140:155]
    ds_read_b64_tr_b16 v[232:233], v33 offset:32768
    ds_read_b64_tr_b16 v[234:235], v33 offset:33792
    v_lshlrev_b32 v9, 2, v5
    v_sub_u32 v9, v4, v9
    s_waitcnt lgkmcnt(9)
    v_mfma_f32_32x32x16_bf16 v[156:171], v[244:247], a[92:95], v[156:171]
    ds_read_b128 a[100:103], v27
    ds_read_b64_tr_b16 v[236:237], v30 offset:36864
    ds_read_b64_tr_b16 v[238:239], v30 offset:37888
    v_cvt_f32_i32 v9, v9
    v_cvt_f32_i32 v11, s67
    v_mfma_f32_32x32x16_bf16 v[172:187], v[248:251], a[92:95], v[172:187]
    ds_read_b64_tr_b16 v[240:241], v31 offset:36864
    ds_read_b64_tr_b16 v[242:243], v31 offset:37888
    v_mul_f32 v11, 0x6cc9f2ca, v11
    v_mul_f32 v9, v9, v11
    s_waitcnt lgkmcnt(9)
    v_mfma_f32_32x32x16_bf16 v[124:139], v[220:223], a[96:99], v[124:139]
    ds_read_b64_tr_b16 v[244:245], v32 offset:36864
    ds_read_b64_tr_b16 v[246:247], v32 offset:37888
    s_bfe_u32 s56, s57, 0x30018
    s_mul_i32 s64, s56, 176128
    s_add_u32 m0, s59, 65536
    s_nop 0
    buffer_load_dwordx4 v20, s[12:15], s64 offen offset:0  lds
    v_fmamk_f32 v108, v11, 0x3f000000, v9
    v_mfma_f32_32x32x16_bf16 v[140:155], v[224:227], a[96:99], v[140:155]
    ds_read_b64_tr_b16 v[248:249], v33 offset:36864
    ds_read_b64_tr_b16 v[250:251], v33 offset:37888
    buffer_load_dwordx4 v21, s[12:15], s64 offen offset:1024  lds
    v_min_f32 v92, 0, v108
    s_waitcnt lgkmcnt(9)
    v_mfma_f32_32x32x16_bf16 v[156:171], v[228:231], a[96:99], v[156:171]
    ds_read_b128 a[104:107], v28
    ds_read_b64_tr_b16 v[220:221], v30 offset:40960
    ds_read_b64_tr_b16 v[222:223], v30 offset:41984
    s_bfe_u32 s56, s57, 0x3001c
    s_mul_i32 s64, s56, 176128
    s_add_u32 m0, s59, 73728
    s_nop 0
    buffer_load_dwordx4 v20, s[12:15], s64 offen offset:0  lds
    v_min_f32 v108, 0, -v108
    v_mfma_f32_32x32x16_bf16 v[172:187], v[232:235], a[96:99], v[172:187]
    ds_read_b64_tr_b16 v[224:225], v31 offset:40960
    ds_read_b64_tr_b16 v[226:227], v31 offset:41984
    buffer_load_dwordx4 v21, s[12:15], s64 offen offset:1024  lds
    v_fmamk_f32 v109, v11, 0xbf000000, v9
    s_waitcnt lgkmcnt(9)
    v_mfma_f32_32x32x16_bf16 v[124:139], v[236:239], a[100:103], v[124:139]
    ds_read_b64_tr_b16 v[228:229], v32 offset:40960
    ds_read_b64_tr_b16 v[230:231], v32 offset:41984
    v_min_f32 v93, 0, v109
    v_min_f32 v109, 0, -v109
    v_mfma_f32_32x32x16_bf16 v[140:155], v[240:243], a[100:103], v[140:155]
    ds_read_b64_tr_b16 v[232:233], v33 offset:40960
    ds_read_b64_tr_b16 v[234:235], v33 offset:41984
    v_fmamk_f32 v110, v11, 0xbfc00000, v9
    v_min_f32 v94, 0, v110
    s_waitcnt lgkmcnt(9)
    v_mfma_f32_32x32x16_bf16 v[156:171], v[244:247], a[100:103], v[156:171]
    ds_read_b128 a[108:111], v29
    ds_read_b64_tr_b16 v[236:237], v30 offset:45056
    ds_read_b64_tr_b16 v[238:239], v30 offset:46080
    v_min_f32 v110, 0, -v110
    v_fmamk_f32 v111, v11, 0xc0200000, v9
    v_mfma_f32_32x32x16_bf16 v[172:187], v[248:251], a[100:103], v[172:187]
    ds_read_b64_tr_b16 v[240:241], v31 offset:45056
    ds_read_b64_tr_b16 v[242:243], v31 offset:46080
    v_min_f32 v95, 0, v111
    v_min_f32 v111, 0, -v111
    s_waitcnt lgkmcnt(9)
    v_mfma_f32_32x32x16_bf16 v[124:139], v[220:223], a[104:107], v[124:139]
    ds_read_b64_tr_b16 v[244:245], v32 offset:45056
    ds_read_b64_tr_b16 v[246:247], v32 offset:46080
    v_fmamk_f32 v112, v11, 0xc0f00000, v9
    v_min_f32 v96, 0, v112
    v_mfma_f32_32x32x16_bf16 v[140:155], v[224:227], a[104:107], v[140:155]
    ds_read_b64_tr_b16 v[248:249], v33 offset:45056
    ds_read_b64_tr_b16 v[250:251], v33 offset:46080
    v_min_f32 v112, 0, -v112
    v_fmamk_f32 v113, v11, 0xc1080000, v9
    s_waitcnt lgkmcnt(9)
    v_mfma_f32_32x32x16_bf16 v[156:171], v[228:231], a[104:107], v[156:171]
    s_waitcnt vmcnt(18)
    s_barrier
    ds_read_b128 a[112:115], v22 offset:32768
    ds_read_b64_tr_b16 v[220:221], v30 offset:49152
    ds_read_b64_tr_b16 v[222:223], v30 offset:50176
    v_min_f32 v97, 0, v113
    v_min_f32 v113, 0, -v113
    v_mfma_f32_32x32x16_bf16 v[172:187], v[232:235], a[104:107], v[172:187]
    ds_read_b128 a[116:119], v23 offset:32768
    ds_read_b64_tr_b16 v[224:225], v30 offset:53248
    ds_read_b64_tr_b16 v[226:227], v30 offset:54272
    v_fmamk_f32 v114, v11, 0xc1180000, v9
    v_min_f32 v98, 0, v114
    s_waitcnt lgkmcnt(10)
    v_mfma_f32_32x32x16_bf16 v[124:139], v[236:239], a[108:111], v[124:139]
    ds_read_b128 a[120:123], v24 offset:32768
    ds_read_b64_tr_b16 v[228:229], v30 offset:57344
    ds_read_b64_tr_b16 v[230:231], v30 offset:58368
    v_min_f32 v114, 0, -v114
    v_fmamk_f32 v115, v11, 0xc1280000, v9
    v_mfma_f32_32x32x16_bf16 v[140:155], v[240:243], a[108:111], v[140:155]
    ds_read_b128 a[124:127], v25 offset:32768
    ds_read_b64_tr_b16 v[232:233], v30 offset:61440
    ds_read_b64_tr_b16 v[234:235], v30 offset:62464
    v_min_f32 v99, 0, v115
    v_min_f32 v115, 0, -v115
    s_waitcnt lgkmcnt(12)
    v_mfma_f32_32x32x16_bf16 v[156:171], v[244:247], a[108:111], v[156:171]
    ds_read_b64_tr_b16 v[236:237], v31 offset:49152
    ds_read_b64_tr_b16 v[238:239], v31 offset:50176
    v_fmamk_f32 v116, v11, 0xc1780000, v9
    v_min_f32 v100, 0, v116
    v_mfma_f32_32x32x16_bf16 v[172:187], v[248:251], a[108:111], v[172:187]
    ds_read_b64_tr_b16 v[240:241], v31 offset:53248
    ds_read_b64_tr_b16 v[242:243], v31 offset:54272
    v_min_f32 v116, 0, -v116
    v_fmamk_f32 v117, v11, 0xc1840000, v9
    s_waitcnt lgkmcnt(10)
    v_mfma_f32_32x32x16_bf16 v[124:139], v[220:223], a[112:115], v[124:139]
    ds_read_b64_tr_b16 v[244:245], v31 offset:57344
    ds_read_b64_tr_b16 v[246:247], v31 offset:58368
    v_min_f32 v101, 0, v117
    v_min_f32 v117, 0, -v117
    v_mfma_f32_32x32x16_bf16 v[124:139], v[224:227], a[116:119], v[124:139]
    ds_read_b64_tr_b16 v[248:249], v31 offset:61440
    ds_read_b64_tr_b16 v[250:251], v31 offset:62464
    v_fmamk_f32 v118, v11, 0xc18c0000, v9
    v_min_f32 v102, 0, v118
    s_waitcnt lgkmcnt(8)
    v_mfma_f32_32x32x16_bf16 v[124:139], v[228:231], a[120:123], v[124:139]
    ds_read_b64_tr_b16 v[220:221], v32 offset:49152
    ds_read_b64_tr_b16 v[222:223], v32 offset:50176
    v_min_f32 v118, 0, -v118
    v_fmamk_f32 v119, v11, 0xc1940000, v9
    v_mfma_f32_32x32x16_bf16 v[124:139], v[232:235], a[124:127], v[124:139]
    ds_read_b64_tr_b16 v[224:225], v32 offset:53248
    ds_read_b64_tr_b16 v[226:227], v32 offset:54272
    v_min_f32 v103, 0, v119
    v_min_f32 v119, 0, -v119
    s_waitcnt vmcnt(4)
    v_cmp_ne_u64 vcc, v[70:71], v[68:69]
    s_cbranch_vccnz CHKQK_slow
CHKQK_back:
    s_or_b32 s82, s82, s81
    s_cmp_lg_u32 s82, 0
    s_cbranch_scc1 DUPQK
    s_waitcnt lgkmcnt(8)
    v_mfma_f32_32x32x16_bf16 v[140:155], v[236:239], a[112:115], v[140:155]
    ds_read_b64_tr_b16 v[228:229], v32 offset:57344
    ds_read_b64_tr_b16 v[230:231], v32 offset:58368
    v_fmamk_f32 v120, v11, 0xc1bc0000, v9
    v_min_f32 v104, 0, v120
    v_mfma_f32_32x32x16_bf16 v[140:155], v[240:243], a[116:119], v[140:155]
    ds_read_b64_tr_b16 v[232:233], v32 offset:61440
    ds_read_b64_tr_b16 v[234:235], v32 offset:62464
    v_min_f32 v120, 0, -v120
    v_fmamk_f32 v121, v11, 0xc1c40000, v9
    s_waitcnt lgkmcnt(8)
    v_mfma_f32_32x32x16_bf16 v[140:155], v[244:247], a[120:123], v[140:155]
    ds_read_b64_tr_b16 v[236:237], v33 offset:49152
    ds_read_b64_tr_b16 v[238:239], v33 offset:50176
    v_mul_f32 v124, s42, v124
    v_mul_f32 v125, s42, v125
    v_mul_f32 v126, s42, v126
    v_mul_f32 v127, s42, v127
    v_mul_f32 v128, s42, v128
    v_mul_f32 v129, s42, v129
    v_mfma_f32_32x32x16_bf16 v[140:155], v[248:251], a[124:127], v[140:155]
    ds_read_b64_tr_b16 v[240:241], v33 offset:53248
    ds_read_b64_tr_b16 v[242:243], v33 offset:54272
    v_mul_f32 v130, s42, v130
    v_mul_f32 v131, s42, v131
    v_cvt_pk_bf16_f32 v124, v124, v125
    v_cvt_pk_bf16_f32 v125, v126, v127
    v_cvt_pk_bf16_f32 v126, v128, v129
    s_waitcnt lgkmcnt(8)
    v_mfma_f32_32x32x16_bf16 v[156:171], v[220:223], a[112:115], v[156:171]
    ds_read_b64_tr_b16 v[244:245], v33 offset:57344
    ds_read_b64_tr_b16 v[246:247], v33 offset:58368
    v_cvt_pk_bf16_f32 v127, v130, v131
    buffer_store_dwordx4 v[124:127], v2, s[24:27], s65 offen sc1
    v_mul_f32 v132, s42, v132
    v_mul_f32 v133, s42, v133
    v_mul_f32 v134, s42, v134
    v_mfma_f32_32x32x16_bf16 v[156:171], v[224:227], a[116:119], v[156:171]
    ds_read_b64_tr_b16 v[248:249], v33 offset:61440
    ds_read_b64_tr_b16 v[250:251], v33 offset:62464
    v_mul_f32 v135, s42, v135
    v_mul_f32 v136, s42, v136
    v_mul_f32 v137, s42, v137
    v_mul_f32 v138, s42, v138
    v_mul_f32 v139, s42, v139
    s_waitcnt lgkmcnt(8)
    v_mfma_f32_32x32x16_bf16 v[156:171], v[228:231], a[120:123], v[156:171]
    s_barrier
    ds_read_b64_tr_b16 v[220:221], v36 offset:0
    ds_read_b64_tr_b16 v[222:223], v36 offset:512
    v_cvt_pk_bf16_f32 v132, v132, v133
    v_cvt_pk_bf16_f32 v133, v134, v135
    v_cvt_pk_bf16_f32 v134, v136, v137
    v_cvt_pk_bf16_f32 v135, v138, v139
    s_add_u32 s65, s65, 65536
    v_mfma_f32_32x32x16_bf16 v[156:171], v[232:235], a[124:127], v[156:171]
    ds_read_b64_tr_b16 v[224:225], v36 offset:2048
    ds_read_b64_tr_b16 v[226:227], v36 offset:2560
    buffer_store_dwordx4 v[132:135], v2, s[24:27], s65 offen sc1
    v_mul_f32 v140, s42, v140
    v_mul_f32 v141, s42, v141
    v_mul_f32 v142, s42, v142
    s_waitcnt lgkmcnt(8)
    v_mfma_f32_32x32x16_bf16 v[172:187], v[236:239], a[112:115], v[172:187]
    ds_read_b64_tr_b16 v[228:229], v36 offset:4096
    ds_read_b64_tr_b16 v[230:231], v36 offset:4608
    v_mul_f32 v143, s42, v143
    v_mul_f32 v144, s42, v144
    v_mul_f32 v145, s42, v145
    v_mul_f32 v146, s42, v146
    v_mul_f32 v147, s42, v147
    v_cvt_pk_bf16_f32 v140, v140, v141
    v_mfma_f32_32x32x16_bf16 v[172:187], v[240:243], a[116:119], v[172:187]
    ds_read_b64_tr_b16 v[232:233], v36 offset:6144
    ds_read_b64_tr_b16 v[234:235], v36 offset:6656
    v_cvt_pk_bf16_f32 v141, v142, v143
    v_cvt_pk_bf16_f32 v142, v144, v145
    v_cvt_pk_bf16_f32 v143, v146, v147
    s_add_u32 s65, s65, 65536
    s_waitcnt lgkmcnt(8)
    v_mfma_f32_32x32x16_bf16 v[172:187], v[244:247], a[120:123], v[172:187]
    ds_read_b64_tr_b16 v[236:237], v36 offset:8192
    ds_read_b64_tr_b16 v[238:239], v36 offset:8704
    buffer_store_dwordx4 v[140:143], v2, s[24:27], s65 offen sc1
    v_mul_f32 v148, s42, v148
    v_mul_f32 v149, s42, v149
    v_mul_f32 v150, s42, v150
    v_mul_f32 v151, s42, v151
    v_mfma_f32_32x32x16_bf16 v[172:187], v[248:251], a[124:127], v[172:187]
    ds_read_b64_tr_b16 v[240:241], v36 offset:10240
    ds_read_b64_tr_b16 v[242:243], v36 offset:10752
    v_mul_f32 v152, s42, v152
    v_mul_f32 v153, s42, v153
    v_mul_f32 v154, s42, v154
    v_mul_f32 v155, s42, v155
    v_cvt_pk_bf16_f32 v148, v148, v149
    s_waitcnt lgkmcnt(8)
    v_mfma_f32_32x32x16_bf16 v[188:203], v[220:223], a[0:3], 0
    ds_read_b64_tr_b16 v[244:245], v36 offset:12288
    ds_read_b64_tr_b16 v[246:247], v36 offset:12800
    v_cvt_pk_bf16_f32 v149, v150, v151
    v_cvt_pk_bf16_f32 v150, v152, v153
    v_cvt_pk_bf16_f32 v151, v154, v155
    s_add_u32 s65, s65, 65536
    buffer_store_dwordx4 v[148:151], v2, s[24:27], s65 offen sc1
    v_mfma_f32_32x32x16_bf16 v[188:203], v[224:227], a[4:7], v[188:203]
    ds_read_b64_tr_b16 v[248:249], v36 offset:14336
    ds_read_b64_tr_b16 v[250:251], v36 offset:14848
    v_mul_f32 v156, s42, v156
    v_mul_f32 v157, s42, v157
    v_mul_f32 v158, s42, v158
    v_mul_f32 v159, s42, v159
    v_mul_f32 v160, s42, v160
    s_waitcnt lgkmcnt(8)
    v_mfma_f32_32x32x16_bf16 v[188:203], v[228:231], a[8:11], v[188:203]
    s_barrier
    ds_read_b64_tr_b16 v[220:221], v34 offset:0
    ds_read_b64_tr_b16 v[222:223], v34 offset:512
    v_mul_f32 v161, s42, v161
    v_mul_f32 v162, s42, v162
    v_mul_f32 v163, s42, v163
    v_cvt_pk_bf16_f32 v156, v156, v157
    v_cvt_pk_bf16_f32 v157, v158, v159
    v_mfma_f32_32x32x16_bf16 v[188:203], v[232:235], a[12:15], v[188:203]
    ds_read_b64_tr_b16 v[224:225], v34 offset:2048
    ds_read_b64_tr_b16 v[226:227], v34 offset:2560
    v_cvt_pk_bf16_f32 v158, v160, v161
    v_cvt_pk_bf16_f32 v159, v162, v163
    s_add_u32 s65, s65, 65536
    buffer_store_dwordx4 v[156:159], v2, s[24:27], s65 offen sc1
    s_waitcnt lgkmcnt(8)
    v_mfma_f32_32x32x16_bf16 v[188:203], v[236:239], a[16:19], v[188:203]
    ds_read_b64_tr_b16 v[228:229], v34 offset:4096
    ds_read_b64_tr_b16 v[230:231], v34 offset:4608
    v_mul_f32 v164, s42, v164
    v_mul_f32 v165, s42, v165
    v_mul_f32 v166, s42, v166
    v_mul_f32 v167, s42, v167
    v_mul_f32 v168, s42, v168
    v_mul_f32 v169, s42, v169
    v_mfma_f32_32x32x16_bf16 v[188:203], v[240:243], a[20:23], v[188:203]
    ds_read_b64_tr_b16 v[232:233], v34 offset:6144
    ds_read_b64_tr_b16 v[234:235], v34 offset:6656
    v_mul_f32 v170, s42, v170
    v_mul_f32 v171, s42, v171
    v_cvt_pk_bf16_f32 v164, v164, v165
    v_cvt_pk_bf16_f32 v165, v166, v167
    v_cvt_pk_bf16_f32 v166, v168, v169
    s_waitcnt lgkmcnt(8)
    v_mfma_f32_32x32x16_bf16 v[188:203], v[244:247], a[24:27], v[188:203]
    ds_read_b64_tr_b16 v[236:237], v34 offset:8192
    ds_read_b64_tr_b16 v[238:239], v34 offset:8704
    v_cvt_pk_bf16_f32 v167, v170, v171
    s_add_u32 s65, s65, 65536
    buffer_store_dwordx4 v[164:167], v2, s[24:27], s65 offen sc1
    v_mul_f32 v172, s42, v172
    v_mul_f32 v173, s42, v173
    v_mfma_f32_32x32x16_bf16 v[188:203], v[248:251], a[28:31], v[188:203]
    ds_read_b64_tr_b16 v[240:241], v34 offset:10240
    ds_read_b64_tr_b16 v[242:243], v34 offset:10752
    v_mul_f32 v174, s42, v174
    v_mul_f32 v175, s42, v175
    v_mul_f32 v176, s42, v176
    v_mul_f32 v177, s42, v177
    v_mul_f32 v178, s42, v178
    s_waitcnt lgkmcnt(8)
    v_mfma_f32_32x32x16_bf16 v[188:203], v[220:223], a[32:35], v[188:203]
    ds_read_b64_tr_b16 v[244:245], v34 offset:12288
    ds_read_b64_tr_b16 v[246:247], v34 offset:12800
    v_mul_f32 v179, s42, v179
    v_cvt_pk_bf16_f32 v172, v172, v173
    v_cvt_pk_bf16_f32 v173, v174, v175
    v_cvt_pk_bf16_f32 v174, v176, v177
    v_cvt_pk_bf16_f32 v175, v178, v179
    s_add_u32 s65, s65, 65536
    v_mfma_f32_32x32x16_bf16 v[188:203], v[224:227], a[36:39], v[188:203]
    ds_read_b64_tr_b16 v[248:249], v34 offset:14336
    ds_read_b64_tr_b16 v[250:251], v34 offset:14848
    buffer_store_dwordx4 v[172:175], v2, s[24:27], s65 offen sc1
    v_mul_f32 v180, s42, v180
    v_mul_f32 v181, s42, v181
    v_mul_f32 v182, s42, v182
    s_waitcnt lgkmcnt(8)
    v_mfma_f32_32x32x16_bf16 v[188:203], v[228:231], a[40:43], v[188:203]
    s_barrier
    ds_read_b64_tr_b16 v[220:221], v36 offset:16384
    ds_read_b64_tr_b16 v[222:223], v36 offset:16896
    v_mul_f32 v183, s42, v183
    v_mul_f32 v184, s42, v184
    v_mul_f32 v185, s42, v185
    v_mul_f32 v186, s42, v186
    v_mul_f32 v187, s42, v187
    v_mfma_f32_32x32x16_bf16 v[188:203], v[232:235], a[44:47], v[188:203]
    ds_read_b64_tr_b16 v[224:225], v36 offset:18432
    ds_read_b64_tr_b16 v[226:227], v36 offset:18944
    v_cvt_pk_bf16_f32 v180, v180, v181
    v_cvt_pk_bf16_f32 v181, v182, v183
    v_cvt_pk_bf16_f32 v182, v184, v185
    v_cvt_pk_bf16_f32 v183, v186, v187
    s_add_u32 s65, s65, 65536
    s_waitcnt lgkmcnt(8)
    v_mfma_f32_32x32x16_bf16 v[188:203], v[236:239], a[48:51], v[188:203]
    ds_read_b64_tr_b16 v[228:229], v36 offset:20480
    ds_read_b64_tr_b16 v[230:231], v36 offset:20992
    buffer_store_dwordx4 v[180:183], v2, s[24:27], s65 offen sc1
    v_mfma_f32_32x32x16_bf16 v[188:203], v[240:243], a[52:55], v[188:203]
    ds_read_b64_tr_b16 v[232:233], v36 offset:22528
    ds_read_b64_tr_b16 v[234:235], v36 offset:23040
    v_min_f32 v105, 0, v121
    v_min_f32 v121, 0, -v121
    s_waitcnt lgkmcnt(8)
    v_mfma_f32_32x32x16_bf16 v[188:203], v[244:247], a[56:59], v[188:203]
    ds_read_b64_tr_b16 v[236:237], v36 offset:24576
    ds_read_b64_tr_b16 v[238:239], v36 offset:25088
    v_fmamk_f32 v122, v11, 0xc1cc0000, v9
    v_min_f32 v106, 0, v122
    v_mfma_f32_32x32x16_bf16 v[188:203], v[248:251], a[60:63], v[188:203]
    ds_read_b64_tr_b16 v[240:241], v36 offset:26624
    ds_read_b64_tr_b16 v[242:243], v36 offset:27136
    v_min_f32 v122, 0, -v122
    v_fmamk_f32 v123, v11, 0xc1d40000, v9
    s_waitcnt lgkmcnt(8)
    v_mfma_f32_32x32x16_bf16 v[188:203], v[220:223], a[64:67], v[188:203]
    ds_read_b64_tr_b16 v[244:245], v36 offset:28672
    ds_read_b64_tr_b16 v[246:247], v36 offset:29184
    v_min_f32 v107, 0, v123
    v_min_f32 v123, 0, -v123
    v_mfma_f32_32x32x16_bf16 v[188:203], v[224:227], a[68:71], v[188:203]
    ds_read_b64_tr_b16 v[248:249], v36 offset:30720
    ds_read_b64_tr_b16 v[250:251], v36 offset:31232
    s_mov_b32 s86, 0x21800000
    s_mov_b32 s87, 0x5d800000
    s_waitcnt lgkmcnt(8)
    v_mfma_f32_32x32x16_bf16 v[188:203], v[228:231], a[72:75], v[188:203]
    s_waitcnt vmcnt(8)
    s_barrier
    ds_read_b64_tr_b16 v[220:221], v34 offset:16384
    ds_read_b64_tr_b16 v[222:223], v34 offset:16896
    v_mfma_f32_32x32x16_bf16 v[188:203], v[232:235], a[76:79], v[188:203]
    ds_read_b64_tr_b16 v[224:225], v34 offset:18432
    ds_read_b64_tr_b16 v[226:227], v34 offset:18944
    s_waitcnt lgkmcnt(8)
    v_mfma_f32_32x32x16_bf16 v[188:203], v[236:239], a[80:83], v[188:203]
    ds_read_b64_tr_b16 v[228:229], v34 offset:20480
    ds_read_b64_tr_b16 v[230:231], v34 offset:20992
    v_mfma_f32_32x32x16_bf16 v[188:203], v[240:243], a[84:87], v[188:203]
    ds_read_b64_tr_b16 v[232:233], v34 offset:22528
    ds_read_b64_tr_b16 v[234:235], v34 offset:23040
    s_waitcnt lgkmcnt(8)
    v_mfma_f32_32x32x16_bf16 v[188:203], v[244:247], a[88:91], v[188:203]
    ds_read_b64_tr_b16 v[236:237], v34 offset:24576
    ds_read_b64_tr_b16 v[238:239], v34 offset:25088
    s_waitcnt vmcnt(0)
    buffer_store_dwordx2 v[72:73], v41, s[24:27], s68 offen
DUPQK_back:
    v_mfma_f32_32x32x16_bf16 v[188:203], v[248:251], a[92:95], v[188:203]
    ds_read_b64_tr_b16 v[240:241], v34 offset:26624
    ds_read_b64_tr_b16 v[242:243], v34 offset:27136
    s_waitcnt lgkmcnt(8)
    v_mfma_f32_32x32x16_bf16 v[188:203], v[220:223], a[96:99], v[188:203]
    ds_read_b64_tr_b16 v[244:245], v34 offset:28672
    ds_read_b64_tr_b16 v[246:247], v34 offset:29184
    s_add_u32 m0, s58, 114688
    s_nop 0
    buffer_load_dwordx4 v50, s[16:19], s77 offen offset:0  lds
    v_mfma_f32_32x32x16_bf16 v[188:203], v[224:227], a[100:103], v[188:203]
    ds_read_b64_tr_b16 v[248:249], v34 offset:30720
    ds_read_b64_tr_b16 v[250:251], v34 offset:31232
    buffer_load_dwordx4 v51, s[16:19], s77 offen offset:1024  lds
    s_waitcnt lgkmcnt(8)
    v_mfma_f32_32x32x16_bf16 v[188:203], v[228:231], a[104:107], v[188:203]
    ds_read_b64_tr_b16 v[220:221], v37 offset:0
    ds_read_b64_tr_b16 v[222:223], v37 offset:512
    buffer_load_dwordx4 v52, s[16:19], s77 offen offset:2048  lds
    v_mfma_f32_32x32x16_bf16 v[188:203], v[232:235], a[108:111], v[188:203]
    ds_read_b64_tr_b16 v[224:225], v37 offset:2048
    ds_read_b64_tr_b16 v[226:227], v37 offset:2560
    buffer_load_dwordx4 v53, s[16:19], s77 offen offset:3072  lds
    s_waitcnt lgkmcnt(8)
    v_mfma_f32_32x32x16_bf16 v[188:203], v[236:239], a[112:115], v[188:203]
    ds_read_b64_tr_b16 v[228:229], v37 offset:4096
    ds_read_b64_tr_b16 v[230:231], v37 offset:4608
    s_xor_b32 s77, s77, 0x20000
    s_add_u32 m0, s58, 81920
    s_nop 0
    buffer_load_dwordx4 v50, s[16:19], s77 offen offset:0  lds
    v_mfma_f32_32x32x16_bf16 v[188:203], v[240:243], a[116:119], v[188:203]
    ds_read_b64_tr_b16 v[232:233], v37 offset:6144
    ds_read_b64_tr_b16 v[234:235], v37 offset:6656
    buffer_load_dwordx4 v51, s[16:19], s77 offen offset:1024  lds
    s_waitcnt lgkmcnt(8)
    v_mfma_f32_32x32x16_bf16 v[188:203], v[244:247], a[120:123], v[188:203]
    ds_read_b64_tr_b16 v[236:237], v37 offset:8192
    ds_read_b64_tr_b16 v[238:239], v37 offset:8704
    buffer_load_dwordx4 v52, s[16:19], s77 offen offset:2048  lds
    v_mfma_f32_32x32x16_bf16 v[188:203], v[248:251], a[124:127], v[188:203]
    ds_read_b64_tr_b16 v[240:241], v37 offset:10240
    ds_read_b64_tr_b16 v[242:243], v37 offset:10752
    buffer_load_dwordx4 v53, s[16:19], s77 offen offset:3072  lds
    s_waitcnt lgkmcnt(8)
    v_mfma_f32_32x32x16_bf16 v[204:219], v[220:223], a[0:3], 0
    ds_read_b64_tr_b16 v[244:245], v37 offset:12288
    ds_read_b64_tr_b16 v[246:247], v37 offset:12800
    s_xor_b32 s77, s77, 0x60000
    s_add_u32 m0, s58, 98304
    s_nop 0
    buffer_load_dwordx4 v50, s[16:19], s77 offen offset:0  lds
    v_mfma_f32_32x32x16_bf16 v[204:219], v[224:227], a[4:7], v[204:219]
    ds_read_b64_tr_b16 v[248:249], v37 offset:14336
    ds_read_b64_tr_b16 v[250:251], v37 offset:14848
    buffer_load_dwordx4 v51, s[16:19], s77 offen offset:1024  lds
    s_waitcnt lgkmcnt(8)
    v_mfma_f32_32x32x16_bf16 v[204:219], v[228:231], a[8:11], v[204:219]
    ds_read_b64_tr_b16 v[220:221], v35 offset:0
    ds_read_b64_tr_b16 v[222:223], v35 offset:512
    buffer_load_dwordx4 v52, s[16:19], s77 offen offset:2048  lds
    v_mul_f32 v124, s44, v188
    v_mul_f32 v125, s44, v189
    v_mfma_f32_32x32x16_bf16 v[204:219], v[232:235], a[12:15], v[204:219]
    ds_read_b64_tr_b16 v[224:225], v35 offset:2048
    ds_read_b64_tr_b16 v[226:227], v35 offset:2560
    buffer_load_dwordx4 v53, s[16:19], s77 offen offset:3072  lds
    v_exp_f32 v124, v124
    s_waitcnt lgkmcnt(8)
    v_mfma_f32_32x32x16_bf16 v[204:219], v[236:239], a[16:19], v[204:219]
    ds_read_b64_tr_b16 v[228:229], v35 offset:4096
    ds_read_b64_tr_b16 v[230:231], v35 offset:4608
    v_mul_f32 v126, s44, v190
    v_exp_f32 v125, v125
    v_add_f32 v124, 1.0, v124
    v_mfma_f32_32x32x16_bf16 v[204:219], v[240:243], a[20:23], v[204:219]
    ds_read_b64_tr_b16 v[232:233], v35 offset:6144
    ds_read_b64_tr_b16 v[234:235], v35 offset:6656
    v_mul_f32 v127, s44, v191
    v_exp_f32 v126, v126
    s_waitcnt lgkmcnt(8)
    v_mfma_f32_32x32x16_bf16 v[204:219], v[244:247], a[24:27], v[204:219]
    ds_read_b64_tr_b16 v[236:237], v35 offset:8192
    ds_read_b64_tr_b16 v[238:239], v35 offset:8704
    v_add_f32 v125, 1.0, v125
    v_rcp_f32 v124, v124
    v_mul_f32 v128, s44, v192
    v_mfma_f32_32x32x16_bf16 v[204:219], v[248:251], a[28:31], v[204:219]
    ds_read_b64_tr_b16 v[240:241], v35 offset:10240
    ds_read_b64_tr_b16 v[242:243], v35 offset:10752
    v_exp_f32 v127, v127
    v_add_f32 v126, 1.0, v126
    s_waitcnt lgkmcnt(8)
    v_mfma_f32_32x32x16_bf16 v[204:219], v[220:223], a[32:35], v[204:219]
    ds_read_b64_tr_b16 v[244:245], v35 offset:12288
    ds_read_b64_tr_b16 v[246:247], v35 offset:12800
    v_rcp_f32 v125, v125
    v_mul_f32 v188, v188, v124
    v_mul_f32 v129, s44, v193
    v_mfma_f32_32x32x16_bf16 v[204:219], v[224:227], a[36:39], v[204:219]
    ds_read_b64_tr_b16 v[248:249], v35 offset:14336
    ds_read_b64_tr_b16 v[250:251], v35 offset:14848
    v_exp_f32 v128, v128
    v_add_f32 v127, 1.0, v127
    s_waitcnt lgkmcnt(8)
    v_mfma_f32_32x32x16_bf16 v[204:219], v[228:231], a[40:43], v[204:219]
    ds_read_b64_tr_b16 v[220:221], v37 offset:16384
    ds_read_b64_tr_b16 v[222:223], v37 offset:16896
    v_rcp_f32 v126, v126
    v_mul_f32 v189, v189, v125
    v_mul_f32 v130, s44, v194
    v_mfma_f32_32x32x16_bf16 v[204:219], v[232:235], a[44:47], v[204:219]
    ds_read_b64_tr_b16 v[224:225], v37 offset:18432
    ds_read_b64_tr_b16 v[226:227], v37 offset:18944
    v_exp_f32 v129, v129
    v_add_f32 v128, 1.0, v128
    s_waitcnt lgkmcnt(8)
    v_mfma_f32_32x32x16_bf16 v[204:219], v[236:239], a[48:51], v[204:219]
    ds_read_b64_tr_b16 v[228:229], v37 offset:20480
    ds_read_b64_tr_b16 v[230:231], v37 offset:20992
    buffer_load_dwordx2 v[70:71], v42, s[24:27], 0 offen sc1
    v_rcp_f32 v127, v127
    v_mul_f32 v190, v190, v126
    v_mfma_f32_32x32x16_bf16 v[204:219], v[240:243], a[52:55], v[204:219]
    ds_read_b64_tr_b16 v[232:233], v37 offset:22528
    ds_read_b64_tr_b16 v[234:235], v37 offset:23040
    v_cvt_pk_bf16_f32 v188, v188, v189
    v_mul_f32 v131, s44, v195
    s_waitcnt lgkmcnt(8)
    v_mfma_f32_32x32x16_bf16 v[204:219], v[244:247], a[56:59], v[204:219]
    ds_read_b64_tr_b16 v[236:237], v37 offset:24576
    ds_read_b64_tr_b16 v[238:239], v37 offset:25088
    v_exp_f32 v130, v130
    v_add_f32 v129, 1.0, v129
    v_mfma_f32_32x32x16_bf16 v[204:219], v[248:251], a[60:63], v[204:219]
    ds_read_b64_tr_b16 v[240:241], v37 offset:26624
    ds_read_b64_tr_b16 v[242:243], v37 offset:27136
    v_rcp_f32 v128, v128
    v_mul_f32 v191, v191, v127
    s_waitcnt lgkmcnt(8)
    v_mfma_f32_32x32x16_bf16 v[204:219], v[220:223], a[64:67], v[204:219]
    ds_read_b64_tr_b16 v[244:245], v37 offset:28672
    ds_read_b64_tr_b16 v[246:247], v37 offset:29184
    v_mul_f32 v132, s44, v196
    v_exp_f32 v131, v131
    v_add_f32 v130, 1.0, v130
    v_mfma_f32_32x32x16_bf16 v[204:219], v[224:227], a[68:71], v[204:219]
    ds_read_b64_tr_b16 v[248:249], v37 offset:30720
    ds_read_b64_tr_b16 v[250:251], v37 offset:31232
    v_rcp_f32 v129, v129
    v_mul_f32 v192, v192, v128
    s_waitcnt lgkmcnt(8)
    v_mfma_f32_32x32x16_bf16 v[204:219], v[228:231], a[72:75], v[204:219]
    ds_read_b64_tr_b16 v[220:221], v35 offset:16384
    ds_read_b64_tr_b16 v[222:223], v35 offset:16896
    v_cvt_pk_bf16_f32 v189, v190, v191
    v_mul_f32 v133, s44, v197
    v_exp_f32 v132, v132
    v_mfma_f32_32x32x16_bf16 v[204:219], v[232:235], a[76:79], v[204:219]
    ds_read_b64_tr_b16 v[224:225], v35 offset:18432
    ds_read_b64_tr_b16 v[226:227], v35 offset:18944
    v_add_f32 v131, 1.0, v131
    v_rcp_f32 v130, v130
    s_waitcnt lgkmcnt(8)
    v_mfma_f32_32x32x16_bf16 v[204:219], v[236:239], a[80:83], v[204:219]
    ds_read_b64_tr_b16 v[228:229], v35 offset:20480
    ds_read_b64_tr_b16 v[230:231], v35 offset:20992
    v_mul_f32 v193, v193, v129
    v_mul_f32 v134, s44, v198
    v_exp_f32 v133, v133
    v_mfma_f32_32x32x16_bf16 v[204:219], v[240:243], a[84:87], v[204:219]
    ds_read_b64_tr_b16 v[232:233], v35 offset:22528
    ds_read_b64_tr_b16 v[234:235], v35 offset:23040
    v_add_f32 v132, 1.0, v132
    v_rcp_f32 v131, v131
    s_waitcnt lgkmcnt(8)
    v_mfma_f32_32x32x16_bf16 v[204:219], v[244:247], a[88:91], v[204:219]
    ds_read_b64_tr_b16 v[236:237], v35 offset:24576
    ds_read_b64_tr_b16 v[238:239], v35 offset:25088
    v_mul_f32 v194, v194, v130
    v_cvt_pk_bf16_f32 v190, v192, v193
    v_mul_f32 v135, s44, v199
    v_mfma_f32_32x32x16_bf16 v[204:219], v[248:251], a[92:95], v[204:219]
    ds_read_b64_tr_b16 v[240:241], v35 offset:26624
    ds_read_b64_tr_b16 v[242:243], v35 offset:27136
    v_exp_f32 v134, v134
    v_add_f32 v133, 1.0, v133
    s_waitcnt lgkmcnt(8)
    v_mfma_f32_32x32x16_bf16 v[204:219], v[220:223], a[96:99], v[204:219]
    ds_read_b64_tr_b16 v[244:245], v35 offset:28672
    ds_read_b64_tr_b16 v[246:247], v35 offset:29184
    s_waitcnt vmcnt(0)
    v_cmp_ne_u64 vcc, v[70:71], v[72:73]
    s_cbranch_vccnz P1QK_slow
P1QK_back:
    ds_write_b128 v49, v[80:83]
    s_mov_b32 m0, s59
    s_nop 0
    buffer_load_dwordx4 v2, s[24:27], s70 offen sc1 lds
    v_mfma_f32_32x32x16_bf16 v[204:219], v[224:227], a[100:103], v[204:219]
    ds_read_b64_tr_b16 v[248:249], v35 offset:30720
    ds_read_b64_tr_b16 v[250:251], v35 offset:31232
    s_add_u32 s70, s70, s67
    s_add_u32 m0, s59, 1024
    s_nop 0
    buffer_load_dwordx4 v2, s[24:27], s70 offen sc1 lds
    s_waitcnt lgkmcnt(9)
    v_mfma_f32_32x32x16_bf16 v[204:219], v[228:231], a[104:107], v[204:219]
    buffer_load_dwordx4 v[84:87], v2, s[24:27], s72 offen sc1
    v_rcp_f32 v132, v132
    v_mul_f32 v195, v195, v131
    v_mul_f32 v136, s44, v200
    v_mfma_f32_32x32x16_bf16 v[204:219], v[232:235], a[108:111], v[204:219]
    s_lshl2_add_u32 s72, s67, s72
    buffer_load_dwordx4 v[88:91], v2, s[24:27], s72 offen sc1
    v_exp_f32 v135, v135
    v_add_f32 v134, 1.0, v134
    s_waitcnt lgkmcnt(5)
    v_mfma_f32_32x32x16_bf16 v[204:219], v[236:239], a[112:115], v[204:219]
    s_mov_b32 m0, s73
    s_nop 0
    buffer_load_dwordx4 v2, s[24:27], s71 offen sc1 lds
    v_rcp_f32 v133, v133
    v_mul_f32 v196, v196, v132
    v_mfma_f32_32x32x16_bf16 v[204:219], v[240:243], a[116:119], v[204:219]
    s_add_u32 s71, s71, s67
    s_add_u32 m0, s73, 1040
    s_nop 0
    buffer_load_dwordx4 v2, s[24:27], s71 offen sc1 lds
    v_cvt_pk_bf16_f32 v191, v194, v195
    s_waitcnt lgkmcnt(0)
    v_mfma_f32_32x32x16_bf16 v[204:219], v[244:247], a[120:123], v[204:219]
    v_mul_f32 v137, s44, v201
    v_exp_f32 v136, v136
    v_add_f32 v135, 1.0, v135
    v_rcp_f32 v134, v134
    v_mfma_f32_32x32x16_bf16 v[204:219], v[248:251], a[124:127], v[204:219]
    v_mul_f32 v197, v197, v133
    v_mul_f32 v138, s44, v202
    v_exp_f32 v137, v137
    v_add_f32 v136, 1.0, v136
    v_rcp_f32 v135, v135
    v_mul_f32 v198, v198, v134
    v_cvt_pk_bf16_f32 v196, v196, v197
    v_mul_f32 v139, s44, v203
    v_exp_f32 v138, v138
    v_add_f32 v137, 1.0, v137
    v_rcp_f32 v136, v136
    v_mul_f32 v199, v199, v135
    v_exp_f32 v139, v139
    v_add_f32 v138, 1.0, v138
    v_rcp_f32 v137, v137
    v_mul_f32 v200, v200, v136
    v_cvt_pk_bf16_f32 v197, v198, v199
    v_add_f32 v139, 1.0, v139
    v_rcp_f32 v138, v138
    v_mul_f32 v201, v201, v137
    v_rcp_f32 v139, v139
    v_mul_f32 v202, v202, v138
    v_cvt_pk_bf16_f32 v198, v200, v201
    v_mul_f32 v203, v203, v139
    v_cvt_pk_bf16_f32 v199, v202, v203
    s_cmp_lg_u32 s81, 0
    s_cbranch_scc1 ALT0
    buffer_store_dwordx4 v[188:191], v2, s[24:27], s66 offen offset:0 sc1
    buffer_store_dwordx4 v[196:199], v2, s[24:27], s66 offen offset:1024 sc1
ALT0_back:
    v_pk_mul_f32 v[124:125], v[204:205], s[44:45]
    v_pk_mul_f32 v[126:127], v[206:207], s[44:45]
    v_pk_mul_f32 v[128:129], v[208:209], s[44:45]
    v_pk_mul_f32 v[130:131], v[210:211], s[44:45]
    v_pk_mul_f32 v[132:133], v[212:213], s[44:45]
    v_pk_mul_f32 v[134:135], v[214:215], s[44:45]
    v_pk_mul_f32 v[136:137], v[216:217], s[44:45]
    v_pk_mul_f32 v[138:139], v[218:219], s[44:45]
    v_exp_f32 v124, v124
    v_exp_f32 v125, v125
    v_exp_f32 v126, v126
    v_exp_f32 v127, v127
    v_exp_f32 v128, v128
    v_exp_f32 v129, v129
    v_exp_f32 v130, v130
    v_exp_f32 v131, v131
    v_exp_f32 v132, v132
    v_exp_f32 v133, v133
    v_exp_f32 v134, v134
    v_exp_f32 v135, v135
    v_exp_f32 v136, v136
    v_exp_f32 v137, v137
    v_exp_f32 v138, v138
    v_exp_f32 v139, v139
    v_pk_add_f32 v[124:125], v[124:125], 1.0 op_sel_hi:[1,0]
    v_pk_add_f32 v[126:127], v[126:127], 1.0 op_sel_hi:[1,0]
    v_pk_add_f32 v[128:129], v[128:129], 1.0 op_sel_hi:[1,0]
    v_pk_add_f32 v[130:131], v[130:131], 1.0 op_sel_hi:[1,0]
    v_pk_add_f32 v[132:133], v[132:133], 1.0 op_sel_hi:[1,0]
    v_pk_add_f32 v[134:135], v[134:135], 1.0 op_sel_hi:[1,0]
    v_pk_add_f32 v[136:137], v[136:137], 1.0 op_sel_hi:[1,0]
    v_pk_add_f32 v[138:139], v[138:139], 1.0 op_sel_hi:[1,0]
    v_rcp_f32 v124, v124
    v_rcp_f32 v125, v125
    v_rcp_f32 v126, v126
    v_rcp_f32 v127, v127
    v_rcp_f32 v128, v128
    v_rcp_f32 v129, v129
    v_rcp_f32 v130, v130
    v_rcp_f32 v131, v131
    v_rcp_f32 v132, v132
    v_rcp_f32 v133, v133
    v_rcp_f32 v134, v134
    v_rcp_f32 v135, v135
    v_rcp_f32 v136, v136
    v_rcp_f32 v137, v137
    v_rcp_f32 v138, v138
    v_rcp_f32 v139, v139
    v_pk_mul_f32 v[204:205], v[204:205], v[124:125]
    v_pk_mul_f32 v[206:207], v[206:207], v[126:127]
    v_pk_mul_f32 v[208:209], v[208:209], v[128:129]
    v_pk_mul_f32 v[210:211], v[210:211], v[130:131]
    v_pk_mul_f32 v[212:213], v[212:213], v[132:133]
    v_pk_mul_f32 v[214:215], v[214:215], v[134:135]
    v_pk_mul_f32 v[216:217], v[216:217], v[136:137]
    v_pk_mul_f32 v[218:219], v[218:219], v[138:139]
    v_cvt_pk_bf16_f32 v204, v204, v205
    v_cvt_pk_bf16_f32 v205, v206, v207
    v_cvt_pk_bf16_f32 v206, v208, v209
    v_cvt_pk_bf16_f32 v207, v210, v211
    v_cvt_pk_bf16_f32 v212, v212, v213
    v_cvt_pk_bf16_f32 v213, v214, v215
    v_cvt_pk_bf16_f32 v214, v216, v217
    v_cvt_pk_bf16_f32 v215, v218, v219
    s_cmp_lg_u32 s81, 0
    s_cbranch_scc1 ALT1
    buffer_store_dwordx4 v[204:207], v2, s[24:27], s66 offen offset:2048 sc1
    buffer_store_dwordx4 v[212:215], v2, s[24:27], s66 offen offset:3072 sc1
ALT1_back:
    buffer_load_dwordx2 v[70:71], v43, s[24:27], 0 offen sc1
    s_waitcnt vmcnt(5)
    s_waitcnt lgkmcnt(0)
    s_branch JOIN
    .p2align 3
VAR_V:
    v_lshlrev_b32 v2, 4, v1
    v_and_b32 v4, 31, v1
    v_lshrrev_b32 v5, 5, v1
    v_bfe_u32 v6, v1, 1, 3
    v_xor_b32 v6, v6, v5
    v_lshlrev_b32 v6, 4, v6
    v_lshl_add_u32 v6, v4, 7, v6
    v_add_u32 v22, s58, v6
    v_xor_b32 v23, 32, v22
    v_xor_b32 v24, 64, v22
    v_xor_b32 v25, 96, v22
    v_add_u32 v26, 114688, v22
    v_add_u32 v27, 114688, v23
    v_add_u32 v28, 114688, v24
    v_add_u32 v29, 114688, v25
    v_bfe_u32 v6, v1, 2, 2
    v_bfe_u32 v7, v1, 4, 1
    v_and_b32 v8, 3, v1
    v_lshlrev_b32 v8, 3, v8
    v_lshl_add_u32 v8, v7, 5, v8
    v_lshl_add_u32 v9, v5, 3, v6
    v_lshl_add_u32 v10, v9, 2, v6
    v_lshl_add_u32 v10, v10, 6, v8
    v_add_u32 v30, 49152, v10
    v_xor_b32 v31, 64, v30
    v_xor_b32 v32, 128, v30
    v_xor_b32 v33, 192, v30
    s_lshl_b32 s59, s46, 11
    s_lshl_b32 s60, s46, 10
    v_mov_b32 v9, 0x40000000
    v_cmp_eq_u32 vcc, 63, v1
    s_getreg_b32 s83, hwreg(HW_REG_XCC_ID)
    s_mov_b32 s81, 0
    v_cndmask_b32 v41, v9, 0, vcc
    v_lshl_add_u32 v9, v5, 3, v6
    s_and_b32 s84, s2, 7
    s_lshl_b32 s84, s84, 5
    s_add_u32 s84, s84, s48
    s_lshl3_add_u32 s84, s84, 0xe4c000
    s_mov_b32 s34, 0x100
    s_mov_b32 s35, s7
    s_mov_b32 s38, 0x400
    s_mov_b32 s39, s7
    s_mov_b32 s14, 0x158000
    s_mov_b32 s15, s7
    s_mov_b32 s30, 0x200000
    s_mov_b32 s31, s7
    v_lshrrev_b32 v10, 1, v6
    v_lshl_add_u32 v10, v9, 1, v10
    v_lshl_add_u32 v10, v10, 6, v8
    v_add_u32 v34, 49152, v10
    v_xor_b32 v35, 64, v34
    v_lshl_add_u32 v10, v9, 6, v8
    v_add_u32 v40, 131072, v10
    v_lshlrev_b32 v10, 2, v7
    v_xor_b32 v10, v10, v1
    v_and_b32 v10, 7, v10
    v_lshlrev_b32 v10, 4, v10
    v_lshrrev_b32 v11, 3, v1
    v_lshl_add_u32 v50, v11, 10, v10
    s_lshl_b32 s52, s46, 4
    v_add_u32 v11, s52, v11
    s_mul_i32 s53, s51, 3
    s_add_u32 s53, s53, s50
    s_mul_i32 s54, s47, 5
    s_add_u32 s53, s53, s54
    s_lshl_b32 s54, s53, 7
    v_add_u32 v10, s54, v10
    s_movk_i32 s55, 2752
    v_mad_u32_u24 v20, v11, s55, v10
    v_lshrrev_b32 v11, 2, v1
    v_add_u32 v11, s52, v11
    v_and_b32 v10, 3, v1
    s_bfe_u32 s56, s57, 0x30004
    s_lshl_b32 s62, s56, 7
    s_mul_i32 s63, s56, s61
    s_add_u32 m0, s58, 65536
    s_nop 0
    buffer_load_dwordx4 v16, s[8:11], s63 offen offset:0  lds
    buffer_load_dwordx4 v17, s[8:11], s63 offen offset:1024  lds
    buffer_load_dwordx4 v18, s[8:11], s63 offen offset:2048  lds
    buffer_load_dwordx4 v19, s[8:11], s63 offen offset:3072  lds
    s_add_u32 m0, s58, 16384
    s_nop 0
    buffer_load_dwordx4 v12, s[4:7], s62 offen offset:0  lds
    buffer_load_dwordx4 v13, s[4:7], s62 offen offset:1024  lds
    buffer_load_dwordx4 v14, s[4:7], s62 offen offset:2048  lds
    buffer_load_dwordx4 v15, s[4:7], s62 offen offset:3072  lds
    s_waitcnt vmcnt(11)
    s_waitcnt lgkmcnt(0)
    s_barrier
    ds_read_b128 a[0:3], v22 offset:0
    ds_read_b64_tr_b16 v[220:221], v30 offset:0
    ds_read_b64_tr_b16 v[222:223], v30 offset:1024
    ds_read_b64_tr_b16 v[224:225], v31 offset:0
    ds_read_b64_tr_b16 v[226:227], v31 offset:1024
    ds_read_b64_tr_b16 v[228:229], v32 offset:0
    ds_read_b64_tr_b16 v[230:231], v32 offset:1024
    ds_read_b64_tr_b16 v[232:233], v33 offset:0
    ds_read_b64_tr_b16 v[234:235], v33 offset:1024
    ds_read_b128 a[4:7], v23 offset:0
    ds_read_b64_tr_b16 v[236:237], v30 offset:4096
    ds_read_b64_tr_b16 v[238:239], v30 offset:5120
    ds_read_b64_tr_b16 v[240:241], v31 offset:4096
    ds_read_b64_tr_b16 v[242:243], v31 offset:5120
    .p2align 3
    s_waitcnt lgkmcnt(9)
    v_mfma_f32_32x32x16_bf16 v[124:139], a[0:3], v[220:223], 0
    ds_read_b64_tr_b16 v[244:245], v32 offset:4096
    ds_read_b64_tr_b16 v[246:247], v32 offset:5120
    s_bfe_u32 s56, s57, 0x30008
    s_lshl_b32 s62, s56, 7
    s_mul_i32 s63, s56, s61
    s_add_u32 m0, s58, 81920
    s_nop 0
    buffer_load_dwordx4 v16, s[8:11], s63 offen offset:0  lds
    s_mul_i32 s54, s51, 320
    v_mfma_f32_32x32x16_bf16 v[140:155], a[0:3], v[224:227], 0
    ds_read_b64_tr_b16 v[248:249], v33 offset:4096
    ds_read_b64_tr_b16 v[250:251], v33 offset:5120
    buffer_load_dwordx4 v17, s[8:11], s63 offen offset:1024  lds
    s_mul_i32 s52, s47, 768
    s_waitcnt lgkmcnt(9)
    v_mfma_f32_32x32x16_bf16 v[156:171], a[0:3], v[228:231], 0
    ds_read_b128 a[8:11], v24 offset:0
    ds_read_b64_tr_b16 v[220:221], v30 offset:8192
    ds_read_b64_tr_b16 v[222:223], v30 offset:9216
    buffer_load_dwordx4 v18, s[8:11], s63 offen offset:2048  lds
    s_addk_i32 s54, 1024
    v_mfma_f32_32x32x16_bf16 v[172:187], a[0:3], v[232:235], 0
    ds_read_b64_tr_b16 v[224:225], v31 offset:8192
    ds_read_b64_tr_b16 v[226:227], v31 offset:9216
    buffer_load_dwordx4 v19, s[8:11], s63 offen offset:3072  lds
    s_add_u32 s54, s54, s52
    s_waitcnt lgkmcnt(9)
    v_mfma_f32_32x32x16_bf16 v[124:139], a[4:7], v[236:239], v[124:139]
    ds_read_b64_tr_b16 v[228:229], v32 offset:8192
    ds_read_b64_tr_b16 v[230:231], v32 offset:9216
    v_lshl_add_u32 v10, v10, 4, s54
    v_mad_u32_u24 v21, v11, s55, v10
    v_add_u32 v21, 20992, v20
    v_add_u32 v36, 81920, v34
    v_add_u32 v37, 81920, v35
    v_mfma_f32_32x32x16_bf16 v[140:155], a[4:7], v[240:243], v[140:155]
    ds_read_b64_tr_b16 v[232:233], v33 offset:8192
    ds_read_b64_tr_b16 v[234:235], v33 offset:9216
    s_add_u32 m0, s58, 114688
    s_nop 0
    buffer_load_dwordx4 v12, s[4:7], s62 offen offset:0  lds
    s_lshl_b32 s53, s53, 1
    s_waitcnt lgkmcnt(9)
    v_mfma_f32_32x32x16_bf16 v[156:171], a[4:7], v[244:247], v[156:171]
    ds_read_b128 a[12:15], v25 offset:0
    ds_read_b64_tr_b16 v[236:237], v30 offset:12288
    ds_read_b64_tr_b16 v[238:239], v30 offset:13312
    buffer_load_dwordx4 v13, s[4:7], s62 offen offset:1024  lds
    s_mul_i32 s54, s51, 5
    v_mfma_f32_32x32x16_bf16 v[172:187], a[4:7], v[248:251], v[172:187]
    ds_read_b64_tr_b16 v[240:241], v31 offset:12288
    ds_read_b64_tr_b16 v[242:243], v31 offset:13312
    buffer_load_dwordx4 v14, s[4:7], s62 offen offset:2048  lds
    s_mul_i32 s55, s47, 12
    s_waitcnt lgkmcnt(9)
    v_mfma_f32_32x32x16_bf16 v[124:139], a[8:11], v[220:223], v[124:139]
    ds_read_b64_tr_b16 v[244:245], v32 offset:12288
    ds_read_b64_tr_b16 v[246:247], v32 offset:13312
    buffer_load_dwordx4 v15, s[4:7], s62 offen offset:3072  lds
    s_add_u32 s54, s54, s55
    v_mfma_f32_32x32x16_bf16 v[140:155], a[8:11], v[224:227], v[140:155]
    ds_read_b64_tr_b16 v[248:249], v33 offset:12288
    ds_read_b64_tr_b16 v[250:251], v33 offset:13312
    s_add_u32 s54, s54, 12
    s_cmp_eq_u32 s50, 3
    s_cselect_b32 s53, s54, s53
    s_waitcnt lgkmcnt(9)
    v_mfma_f32_32x32x16_bf16 v[156:171], a[8:11], v[228:231], v[156:171]
    s_waitcnt vmcnt(8)
    s_barrier
    ds_read_b128 a[16:19], v22 offset:16384
    ds_read_b64_tr_b16 v[220:221], v30 offset:16384
    ds_read_b64_tr_b16 v[222:223], v30 offset:17408
    s_bfe_u32 s56, s57, 0x3000c
    s_lshl_b32 s62, s56, 7
    s_mul_i32 s63, s56, s61
    s_add_u32 m0, s58, 98304
    s_nop 0
    buffer_load_dwordx4 v16, s[8:11], s63 offen offset:0  lds
    s_lshl2_add_u32 s40, s49, s46
    v_mfma_f32_32x32x16_bf16 v[172:187], a[8:11], v[232:235], v[172:187]
    ds_read_b64_tr_b16 v[224:225], v31 offset:16384
    ds_read_b64_tr_b16 v[226:227], v31 offset:17408
    v_add_u32 v72, 1, v70
    v_mov_b32 v73, v71
    v_mov_b32 v74, 1
    v_mov_b32 v75, 0
    buffer_store_dwordx4 v[72:75], v41, s[32:35], s90 offen sc1
    buffer_store_dwordx2 v[72:73], v41, s[24:27], s91 offen sc1
    s_mul_i32 s54, s40, 44
    s_waitcnt lgkmcnt(9)
    v_mfma_f32_32x32x16_bf16 v[124:139], a[12:15], v[236:239], v[124:139]
    ds_read_b64_tr_b16 v[228:229], v32 offset:16384
    ds_read_b64_tr_b16 v[230:231], v32 offset:17408
    buffer_load_dwordx4 v17, s[8:11], s63 offen offset:1024  lds
    s_add_u32 s53, s53, s54
    v_mfma_f32_32x32x16_bf16 v[140:155], a[12:15], v[240:243], v[140:155]
    ds_read_b64_tr_b16 v[232:233], v33 offset:16384
    ds_read_b64_tr_b16 v[234:235], v33 offset:17408
    s_lshl_b32 s53, s53, 11
    s_add_u32 s66, s53, 0x600000
    s_waitcnt lgkmcnt(9)
    v_mfma_f32_32x32x16_bf16 v[156:171], a[12:15], v[244:247], v[156:171]
    ds_read_b128 a[20:23], v23 offset:16384
    ds_read_b64_tr_b16 v[236:237], v30 offset:20480
    ds_read_b64_tr_b16 v[238:239], v30 offset:21504
    buffer_load_dwordx4 v18, s[8:11], s63 offen offset:2048  lds
    buffer_load_dword v55, v78, s[16:19], 0 offen
    s_lshl_b32 s67, s40, 9
    v_mfma_f32_32x32x16_bf16 v[172:187], a[12:15], v[248:251], v[172:187]
    ds_read_b64_tr_b16 v[240:241], v31 offset:20480
    ds_read_b64_tr_b16 v[242:243], v31 offset:21504
    s_add_u32 s67, s67, 0xe00000
    s_lshl_b32 s54, s50, 21
    s_waitcnt lgkmcnt(9)
    v_mfma_f32_32x32x16_bf16 v[124:139], a[16:19], v[220:223], v[124:139]
    ds_read_b64_tr_b16 v[244:245], v32 offset:20480
    ds_read_b64_tr_b16 v[246:247], v32 offset:21504
    buffer_load_dwordx4 v19, s[8:11], s63 offen offset:3072  lds
    s_lshl_b32 s55, s51, 19
    v_mfma_f32_32x32x16_bf16 v[140:155], a[16:19], v[224:227], v[140:155]
    ds_read_b64_tr_b16 v[248:249], v33 offset:20480
    ds_read_b64_tr_b16 v[250:251], v33 offset:21504
    s_add_u32 s54, s54, s55
    s_lshl_b32 s55, s40, 10
    s_waitcnt lgkmcnt(9)
    v_mfma_f32_32x32x16_bf16 v[156:171], a[16:19], v[228:231], v[156:171]
    ds_read_b128 a[24:27], v24 offset:16384
    ds_read_b64_tr_b16 v[220:221], v30 offset:24576
    ds_read_b64_tr_b16 v[222:223], v30 offset:25600
    s_add_u32 m0, s58, 32768
    s_nop 0
    buffer_load_dwordx4 v12, s[4:7], s62 offen offset:0  lds
    s_add_u32 s65, s54, s55
    v_mfma_f32_32x32x16_bf16 v[172:187], a[16:19], v[232:235], v[172:187]
    ds_read_b64_tr_b16 v[224:225], v31 offset:24576
    ds_read_b64_tr_b16 v[226:227], v31 offset:25600
    s_mov_b32 s42, 0x3eb8aa3b
    s_cmp_eq_u32 s50, 0
    s_cselect_b32 s42, s42, 1.0
    s_waitcnt lgkmcnt(9)
    v_mfma_f32_32x32x16_bf16 v[124:139], a[20:23], v[236:239], v[124:139]
    ds_read_b64_tr_b16 v[228:229], v32 offset:24576
    ds_read_b64_tr_b16 v[230:231], v32 offset:25600
    buffer_load_dwordx4 v13, s[4:7], s62 offen offset:1024  lds
    s_mov_b32 s43, s42
    v_mfma_f32_32x32x16_bf16 v[140:155], a[20:23], v[240:243], v[140:155]
    ds_read_b64_tr_b16 v[232:233], v33 offset:24576
    ds_read_b64_tr_b16 v[234:235], v33 offset:25600
    s_mov_b32 s44, 0xbfb8aa3b
    s_mov_b32 s45, s44
    s_waitcnt lgkmcnt(9)
    v_mfma_f32_32x32x16_bf16 v[156:171], a[20:23], v[244:247], v[156:171]
    ds_read_b128 a[28:31], v25 offset:16384
    ds_read_b64_tr_b16 v[236:237], v30 offset:28672
    ds_read_b64_tr_b16 v[238:239], v30 offset:29696
    buffer_load_dwordx4 v14, s[4:7], s62 offen offset:2048  lds
    s_and_b32 s54, s49, 3
    v_mfma_f32_32x32x16_bf16 v[172:187], a[20:23], v[248:251], v[172:187]
    ds_read_b64_tr_b16 v[240:241], v31 offset:28672
    ds_read_b64_tr_b16 v[242:243], v31 offset:29696
    s_lshr_b32 s54, s54, 1
    s_add_u32 s55, s50, 1
    s_waitcnt lgkmcnt(9)
    v_mfma_f32_32x32x16_bf16 v[124:139], a[24:27], v[220:223], v[124:139]
    ds_read_b64_tr_b16 v[244:245], v32 offset:28672
    ds_read_b64_tr_b16 v[246:247], v32 offset:29696
    buffer_load_dwordx4 v15, s[4:7], s62 offen offset:3072  lds
    s_bfe_u32 s55, s55, 0x10001
    v_mfma_f32_32x32x16_bf16 v[140:155], a[24:27], v[224:227], v[140:155]
    ds_read_b64_tr_b16 v[248:249], v33 offset:28672
    ds_read_b64_tr_b16 v[250:251], v33 offset:29696
    s_and_b32 s54, s54, s55
    s_cmp_lt_u32 s49, 12
    s_cselect_b32 s82, s54, 0
    s_waitcnt lgkmcnt(9)
    v_mfma_f32_32x32x16_bf16 v[156:171], a[24:27], v[228:231], v[156:171]
    s_waitcnt vmcnt(11)
    s_barrier
    ds_read_b128 a[32:35], v26
    ds_read_b64_tr_b16 v[220:221], v30 offset:32768
    ds_read_b64_tr_b16 v[222:223], v30 offset:33792
    s_bfe_u32 s56, s57, 0x30010
    s_lshl_b32 s62, s56, 7
    s_mul_i32 s63, s56, s61
    s_add_u32 m0, s58, 49152
    s_nop 0
    buffer_load_dwordx4 v16, s[8:11], s63 offen offset:0  lds
    s_and_b32 s54, s48, 7
    v_mfma_f32_32x32x16_bf16 v[172:187], a[24:27], v[232:235], v[172:187]
    ds_read_b64_tr_b16 v[224:225], v31 offset:32768
    ds_read_b64_tr_b16 v[226:227], v31 offset:33792
    s_lshl_b32 s55, s54, 7
    v_add_u32 v50, s55, v50
    s_waitcnt lgkmcnt(9)
    v_mfma_f32_32x32x16_bf16 v[124:139], a[28:31], v[236:239], v[124:139]
    ds_read_b64_tr_b16 v[228:229], v32 offset:32768
    ds_read_b64_tr_b16 v[230:231], v32 offset:33792
    buffer_load_dwordx4 v17, s[8:11], s63 offen offset:1024  lds
    s_lshl_b32 s55, s49, 1
    v_mfma_f32_32x32x16_bf16 v[140:155], a[28:31], v[240:243], v[140:155]
    ds_read_b64_tr_b16 v[232:233], v33 offset:32768
    ds_read_b64_tr_b16 v[234:235], v33 offset:33792
    s_xor_b32 s55, s55, s54
    s_and_b32 s76, s55, 7
    s_waitcnt lgkmcnt(9)
    v_mfma_f32_32x32x16_bf16 v[156:171], a[28:31], v[244:247], v[156:171]
    ds_read_b128 a[36:39], v27
    ds_read_b64_tr_b16 v[236:237], v30 offset:36864
    ds_read_b64_tr_b16 v[238:239], v30 offset:37888
    buffer_load_dwordx4 v18, s[8:11], s63 offen offset:2048  lds
    s_and_b32 s55, s76, 0
    v_mfma_f32_32x32x16_bf16 v[172:187], a[28:31], v[248:251], v[172:187]
    ds_read_b64_tr_b16 v[240:241], v31 offset:36864
    ds_read_b64_tr_b16 v[242:243], v31 offset:37888
    s_lshl_b32 s75, s55, 12
    s_lshl_b32 s55, s55, 1
    s_waitcnt lgkmcnt(9)
    v_mfma_f32_32x32x16_bf16 v[124:139], a[32:35], v[220:223], v[124:139]
    ds_read_b64_tr_b16 v[244:245], v32 offset:36864
    ds_read_b64_tr_b16 v[246:247], v32 offset:37888
    buffer_load_dwordx4 v19, s[8:11], s63 offen offset:3072  lds
    s_xor_b32 s55, s55, s46
    v_mfma_f32_32x32x16_bf16 v[140:155], a[32:35], v[224:227], v[140:155]
    ds_read_b64_tr_b16 v[248:249], v33 offset:36864
    ds_read_b64_tr_b16 v[250:251], v33 offset:37888
    s_lshl_b32 s77, s55, 15
    s_and_b32 s76, s76, 0
    s_waitcnt lgkmcnt(9)
    v_mfma_f32_32x32x16_bf16 v[156:171], a[32:35], v[228:231], v[156:171]
    ds_read_b128 a[40:43], v28
    ds_read_b64_tr_b16 v[220:221], v30 offset:40960
    ds_read_b64_tr_b16 v[222:223], v30 offset:41984
    s_mov_b32 m0, s58
    s_nop 0
    buffer_load_dwordx4 v12, s[4:7], s62 offen offset:0  lds
    v_add_u32 v51, 7168, v50
    v_mfma_f32_32x32x16_bf16 v[172:187], a[32:35], v[232:235], v[172:187]
    ds_read_b64_tr_b16 v[224:225], v31 offset:40960
    ds_read_b64_tr_b16 v[226:227], v31 offset:41984
    v_add_u32 v52, 7168, v51
    v_add_u32 v53, 7168, v52
    s_waitcnt lgkmcnt(9)
    v_mfma_f32_32x32x16_bf16 v[124:139], a[36:39], v[236:239], v[124:139]
    ds_read_b64_tr_b16 v[228:229], v32 offset:40960
    ds_read_b64_tr_b16 v[230:231], v32 offset:41984
    buffer_load_dwordx4 v13, s[4:7], s62 offen offset:1024  lds
    s_lshl2_add_u32 s52, s49, s51
    v_mfma_f32_32x32x16_bf16 v[140:155], a[36:39], v[240:243], v[140:155]
    ds_read_b64_tr_b16 v[232:233], v33 offset:40960
    ds_read_b64_tr_b16 v[234:235], v33 offset:41984
    s_lshl_b32 s52, s52, 4
    s_add_u32 s52, s52, s46
    s_waitcnt lgkmcnt(9)
    v_mfma_f32_32x32x16_bf16 v[156:171], a[36:39], v[244:247], v[156:171]
    ds_read_b128 a[44:47], v29
    ds_read_b64_tr_b16 v[236:237], v30 offset:45056
    ds_read_b64_tr_b16 v[238:239], v30 offset:46080
    buffer_load_dwordx4 v14, s[4:7], s62 offen offset:2048  lds
    s_lshl_b32 s53, s50, 2
    v_mfma_f32_32x32x16_bf16 v[172:187], a[36:39], v[248:251], v[172:187]
    ds_read_b64_tr_b16 v[240:241], v31 offset:45056
    ds_read_b64_tr_b16 v[242:243], v31 offset:46080
    s_add_u32 s53, s53, 1020
    s_cmp_eq_u32 s50, 0
    s_cselect_b32 s53, 0, s53
    s_waitcnt lgkmcnt(9)
    v_mfma_f32_32x32x16_bf16 v[124:139], a[40:43], v[220:223], v[124:139]
    ds_read_b64_tr_b16 v[244:245], v32 offset:45056
    ds_read_b64_tr_b16 v[246:247], v32 offset:46080
    buffer_load_dwordx4 v15, s[4:7], s62 offen offset:3072  lds
    s_add_u32 s52, s52, s53
    v_mfma_f32_32x32x16_bf16 v[140:155], a[40:43], v[224:227], v[140:155]
    ds_read_b64_tr_b16 v[248:249], v33 offset:45056
    ds_read_b64_tr_b16 v[250:251], v33 offset:46080
    s_lshl3_add_u32 s68, s52, 0xe40000
    s_lshl1_add_u32 s52, s40, s47
    s_waitcnt lgkmcnt(9)
    v_mfma_f32_32x32x16_bf16 v[156:171], a[40:43], v[228:231], v[156:171]
    s_waitcnt vmcnt(8)
    s_barrier
    ds_read_b128 a[48:51], v22 offset:32768
    ds_read_b64_tr_b16 v[220:221], v30 offset:49152
    ds_read_b64_tr_b16 v[222:223], v30 offset:50176
    s_bfe_u32 s56, s57, 0x30014
    s_lshl_b32 s62, s56, 7
    s_mul_i32 s63, s56, s61
    s_add_u32 m0, s58, 65536
    s_nop 0
    buffer_load_dwordx4 v16, s[8:11], s63 offen offset:0  lds
    s_lshl_b32 s52, s52, 7
    v_mfma_f32_32x32x16_bf16 v[172:187], a[40:43], v[232:235], v[172:187]
    ds_read_b64_tr_b16 v[224:225], v31 offset:49152
    ds_read_b64_tr_b16 v[226:227], v31 offset:50176
    buffer_load_dwordx4 v17, s[8:11], s63 offen offset:1024  lds
    buffer_load_dwordx4 v[72:75], off, s[32:35], 0 sc1
    s_add_u32 s52, s52, 0xe44000
    s_waitcnt lgkmcnt(9)
    v_mfma_f32_32x32x16_bf16 v[124:139], a[44:47], v[236:239], v[124:139]
    ds_read_b64_tr_b16 v[228:229], v32 offset:49152
    ds_read_b64_tr_b16 v[230:231], v32 offset:50176
    buffer_load_dwordx4 v18, s[8:11], s63 offen offset:2048  lds
    s_lshl2_add_u32 s80, s54, s52
    v_mfma_f32_32x32x16_bf16 v[140:155], a[44:47], v[240:243], v[140:155]
    ds_read_b64_tr_b16 v[232:233], v33 offset:49152
    ds_read_b64_tr_b16 v[234:235], v33 offset:50176
    buffer_load_dwordx4 v19, s[8:11], s63 offen offset:3072  lds
    v_and_b32 v9, 7, v1
    s_waitcnt lgkmcnt(9)
    v_mfma_f32_32x32x16_bf16 v[156:171], a[44:47], v[244:247], v[156:171]
    ds_read_b128 a[52:55], v23 offset:32768
    ds_read_b64_tr_b16 v[236:237], v30 offset:53248
    ds_read_b64_tr_b16 v[238:239], v30 offset:54272
    s_add_u32 m0, s58, 16384
    s_nop 0
    buffer_load_dwordx4 v12, s[4:7], s62 offen offset:0  lds
    v_lshl_add_u32 v44, v9, 2, s52
    v_mfma_f32_32x32x16_bf16 v[172:187], a[44:47], v[248:251], v[172:187]
    ds_read_b64_tr_b16 v[240:241], v31 offset:53248
    ds_read_b64_tr_b16 v[242:243], v31 offset:54272
    buffer_load_dwordx4 v13, s[4:7], s62 offen offset:1024  lds
    s_and_b32 s52, s40, -8
    s_waitcnt lgkmcnt(9)
    v_mfma_f32_32x32x16_bf16 v[124:139], a[48:51], v[220:223], v[124:139]
    ds_read_b64_tr_b16 v[244:245], v32 offset:53248
    ds_read_b64_tr_b16 v[246:247], v32 offset:54272
    buffer_load_dwordx4 v14, s[4:7], s62 offen offset:2048  lds
    s_lshl1_add_u32 s52, s46, s52
    v_mfma_f32_32x32x16_bf16 v[140:155], a[48:51], v[224:227], v[140:155]
    ds_read_b64_tr_b16 v[248:249], v33 offset:53248
    ds_read_b64_tr_b16 v[250:251], v33 offset:54272
    buffer_load_dwordx4 v15, s[4:7], s62 offen offset:3072  lds
    s_add_u32 s52, s52, s47
    s_waitcnt lgkmcnt(9)
    v_mfma_f32_32x32x16_bf16 v[156:171], a[48:51], v[228:231], v[156:171]
    ds_read_b128 a[56:59], v24 offset:32768
    ds_read_b64_tr_b16 v[220:221], v30 offset:57344
    ds_read_b64_tr_b16 v[222:223], v30 offset:58368
    s_bfe_u32 s56, s57, 0x30018
    s_lshl_b32 s62, s56, 7
    s_mul_i32 s63, s56, s61
    s_add_u32 m0, s58, 114688
    s_nop 0
    buffer_load_dwordx4 v12, s[4:7], s62 offen offset:0  lds
    s_lshl_b32 s52, s52, 7
    v_mfma_f32_32x32x16_bf16 v[172:187], a[48:51], v[232:235], v[172:187]
    ds_read_b64_tr_b16 v[224:225], v31 offset:57344
    ds_read_b64_tr_b16 v[226:227], v31 offset:58368
    buffer_load_dwordx4 v13, s[4:7], s62 offen offset:1024  lds
    s_add_u32 s52, s52, 0xe48000
    s_waitcnt lgkmcnt(9)
    v_mfma_f32_32x32x16_bf16 v[124:139], a[52:55], v[236:239], v[124:139]
    ds_read_b64_tr_b16 v[228:229], v32 offset:57344
    ds_read_b64_tr_b16 v[230:231], v32 offset:58368
    buffer_load_dwordx4 v14, s[4:7], s62 offen offset:2048  lds
    v_and_b32 v10, 15, v1
    v_mfma_f32_32x32x16_bf16 v[140:155], a[52:55], v[240:243], v[140:155]
    ds_read_b64_tr_b16 v[232:233], v33 offset:57344
    ds_read_b64_tr_b16 v[234:235], v33 offset:58368
    buffer_load_dwordx4 v15, s[4:7], s62 offen offset:3072  lds
    v_lshl_add_u32 v45, v10, 2, s52
    s_waitcnt lgkmcnt(9)
    v_mfma_f32_32x32x16_bf16 v[156:171], a[52:55], v[244:247], v[156:171]
    ds_read_b128 a[60:63], v25 offset:32768
    ds_read_b64_tr_b16 v[236:237], v30 offset:61440
    ds_read_b64_tr_b16 v[238:239], v30 offset:62464
    s_add_u32 m0, s58, 81920
    s_nop 0
    buffer_load_dwordx4 v16, s[8:11], s63 offen offset:0  lds
    s_lshl1_add_u32 s52, s40, s47
    v_mfma_f32_32x32x16_bf16 v[172:187], a[52:55], v[248:251], v[172:187]
    ds_read_b64_tr_b16 v[240:241], v31 offset:61440
    ds_read_b64_tr_b16 v[242:243], v31 offset:62464
    buffer_load_dwordx4 v17, s[8:11], s63 offen offset:1024  lds
    s_mul_i32 s53, s52, 45056
    s_waitcnt lgkmcnt(9)
    v_mfma_f32_32x32x16_bf16 v[124:139], a[56:59], v[220:223], v[124:139]
    ds_read_b64_tr_b16 v[244:245], v32 offset:61440
    ds_read_b64_tr_b16 v[246:247], v32 offset:62464
    buffer_load_dwordx4 v18, s[8:11], s63 offen offset:2048  lds
    s_add_u32 s53, s53, 0x600000
    v_mfma_f32_32x32x16_bf16 v[140:155], a[56:59], v[224:227], v[140:155]
    ds_read_b64_tr_b16 v[248:249], v33 offset:61440
    ds_read_b64_tr_b16 v[250:251], v33 offset:62464
    buffer_load_dwordx4 v19, s[8:11], s63 offen offset:3072  lds
    v_add_u32 v64, s53, v2
    s_waitcnt lgkmcnt(9)
    v_mfma_f32_32x32x16_bf16 v[156:171], a[56:59], v[228:231], v[156:171]
    s_waitcnt vmcnt(17)
    s_barrier
    ds_read_b128 a[64:67], v22 offset:0
    ds_read_b64_tr_b16 v[220:221], v30 offset:0
    ds_read_b64_tr_b16 v[222:223], v30 offset:1024
    s_bfe_u32 s56, s57, 0x3001c
    s_lshl_b32 s62, s56, 7
    s_mul_i32 s63, s56, s61
    s_add_u32 m0, s58, 32768
    s_nop 0
    buffer_load_dwordx4 v12, s[4:7], s62 offen offset:0  lds
    s_lshl3_add_u32 s52, s52, s76
    v_mfma_f32_32x32x16_bf16 v[172:187], a[56:59], v[232:235], v[172:187]
    ds_read_b64_tr_b16 v[224:225], v31 offset:0
    ds_read_b64_tr_b16 v[226:227], v31 offset:1024
    s_waitcnt vmcnt(15)
    v_cmp_eq_u32 vcc, 0, v74
    s_cbranch_vccnz TAGV_slow
TAGV_back:
    v_mov_b32 v68, v72
    v_add_u32 v69, s83, v73
    buffer_store_dwordx2 v[68:69], v41, s[24:27], s84 offen
    s_lshl_b32 s52, s52, 11
    s_waitcnt lgkmcnt(9)
    v_mfma_f32_32x32x16_bf16 v[124:139], a[60:63], v[236:239], v[124:139]
    ds_read_b64_tr_b16 v[228:229], v32 offset:0
    ds_read_b64_tr_b16 v[230:231], v32 offset:1024
    buffer_load_dwordx4 v13, s[4:7], s62 offen offset:1024  lds
    s_add_u32 s78, s52, 0xc00000
    v_mfma_f32_32x32x16_bf16 v[140:155], a[60:63], v[240:243], v[140:155]
    ds_read_b64_tr_b16 v[232:233], v33 offset:0
    ds_read_b64_tr_b16 v[234:235], v33 offset:1024
    v_lshl_add_u32 v62, v4, 4, s67
    s_lshl_b32 s52, s40, 8
    s_waitcnt lgkmcnt(9)
    v_mfma_f32_32x32x16_bf16 v[156:171], a[60:63], v[244:247], v[156:171]
    ds_read_b128 a[68:71], v23 offset:0
    ds_read_b64_tr_b16 v[236:237], v30 offset:4096
    ds_read_b64_tr_b16 v[238:239], v30 offset:5120
    buffer_load_dwordx4 v14, s[4:7], s62 offen offset:2048  lds
    s_lshl1_add_u32 s53, s54, s47
    v_mfma_f32_32x32x16_bf16 v[172:187], a[60:63], v[248:251], v[172:187]
    ds_read_b64_tr_b16 v[240:241], v31 offset:4096
    ds_read_b64_tr_b16 v[242:243], v31 offset:5120
    s_add_u32 s52, s52, s54
    s_lshl1_add_u32 s52, s52, s47
    s_waitcnt lgkmcnt(9)
    v_mfma_f32_32x32x16_bf16 v[124:139], a[64:67], v[220:223], v[124:139]
    ds_read_b64_tr_b16 v[244:245], v32 offset:4096
    ds_read_b64_tr_b16 v[246:247], v32 offset:5120
    buffer_load_dwordx4 v15, s[4:7], s62 offen offset:3072  lds
    s_lshl_b32 s52, s52, 6
    v_mfma_f32_32x32x16_bf16 v[140:155], a[64:67], v[224:227], v[140:155]
    ds_read_b64_tr_b16 v[248:249], v33 offset:4096
    ds_read_b64_tr_b16 v[250:251], v33 offset:5120
    v_and_b32 v63, 3, v1
    v_lshl_add_u32 v63, v63, 4, s52
    s_waitcnt lgkmcnt(9)
    v_mfma_f32_32x32x16_bf16 v[156:171], a[64:67], v[228:231], v[156:171]
    ds_read_b128 a[72:75], v24 offset:0
    ds_read_b64_tr_b16 v[220:221], v30 offset:8192
    ds_read_b64_tr_b16 v[222:223], v30 offset:9216
    s_add_u32 m0, s58, 98304
    s_nop 0
    buffer_load_dwordx4 v16, s[8:11], s63 offen offset:0  lds
    v_lshrrev_b32 v9, 2, v1
    v_mfma_f32_32x32x16_bf16 v[172:187], a[64:67], v[232:235], v[172:187]
    ds_read_b64_tr_b16 v[224:225], v31 offset:8192
    ds_read_b64_tr_b16 v[226:227], v31 offset:9216
    v_lshl_add_u32 v63, v9, 10, v63
    v_lshrrev_b32 v66, 4, v1
    s_waitcnt lgkmcnt(9)
    v_mfma_f32_32x32x16_bf16 v[124:139], a[68:71], v[236:239], v[124:139]
    ds_read_b64_tr_b16 v[228:229], v32 offset:8192
    ds_read_b64_tr_b16 v[230:231], v32 offset:9216
    buffer_load_dwordx4 v17, s[8:11], s63 offen offset:1024  lds
    v_xor_b32 v66, v66, v1
    v_mfma_f32_32x32x16_bf16 v[140:155], a[68:71], v[240:243], v[140:155]
    ds_read_b64_tr_b16 v[232:233], v33 offset:8192
    ds_read_b64_tr_b16 v[234:235], v33 offset:9216
    v_and_b32 v66, 3, v66
    v_lshlrev_b32 v66, 4, v66
    s_waitcnt lgkmcnt(9)
    v_mfma_f32_32x32x16_bf16 v[156:171], a[68:71], v[244:247], v[156:171]
    ds_read_b128 a[76:79], v25 offset:0
    ds_read_b64_tr_b16 v[236:237], v30 offset:12288
    ds_read_b64_tr_b16 v[238:239], v30 offset:13312
    buffer_load_dwordx4 v18, s[8:11], s63 offen offset:2048  lds
    v_lshl_add_u32 v66, v9, 6, v66
    v_mfma_f32_32x32x16_bf16 v[172:187], a[68:71], v[248:251], v[172:187]
    ds_read_b64_tr_b16 v[240:241], v31 offset:12288
    ds_read_b64_tr_b16 v[242:243], v31 offset:13312
    v_lshl_add_u32 v66, s46, 11, v66
    v_lshrrev_b32 v65, 2, v4
    s_waitcnt lgkmcnt(9)
    v_mfma_f32_32x32x16_bf16 v[124:139], a[72:75], v[220:223], v[124:139]
    ds_read_b64_tr_b16 v[244:245], v32 offset:12288
    ds_read_b64_tr_b16 v[246:247], v32 offset:13312
    buffer_load_dwordx4 v19, s[8:11], s63 offen offset:3072  lds
    v_and_b32 v65, 3, v65
    v_mfma_f32_32x32x16_bf16 v[140:155], a[72:75], v[224:227], v[140:155]
    ds_read_b64_tr_b16 v[248:249], v33 offset:12288
    ds_read_b64_tr_b16 v[250:251], v33 offset:13312
    v_lshlrev_b32 v65, 4, v65
    v_lshl_add_u32 v65, v5, 3, v65
    s_waitcnt lgkmcnt(9)
    v_mfma_f32_32x32x16_bf16 v[156:171], a[72:75], v[228:231], v[156:171]
    s_waitcnt vmcnt(17)
    s_barrier
    ds_read_b128 a[80:83], v22 offset:16384
    ds_read_b64_tr_b16 v[220:221], v30 offset:16384
    ds_read_b64_tr_b16 v[222:223], v30 offset:17408
    s_bfe_u32 s56, s57, 0x30000
    s_mul_i32 s64, s56, 176128
    s_add_u32 m0, s59, 131072
    s_nop 0
    buffer_load_dwordx4 v20, s[12:15], s64 offen offset:0  lds
    v_lshl_add_u32 v65, v4, 6, v65
    v_mfma_f32_32x32x16_bf16 v[172:187], a[72:75], v[232:235], v[172:187]
    ds_read_b64_tr_b16 v[224:225], v31 offset:16384
    ds_read_b64_tr_b16 v[226:227], v31 offset:17408
    buffer_load_dwordx4 v21, s[12:15], s64 offen offset:1024  lds
    v_lshl_add_u32 v65, s46, 11, v65
    s_waitcnt lgkmcnt(9)
    v_mfma_f32_32x32x16_bf16 v[124:139], a[76:79], v[236:239], v[124:139]
    ds_read_b64_tr_b16 v[228:229], v32 offset:16384
    ds_read_b64_tr_b16 v[230:231], v32 offset:17408
    s_bfe_u32 s56, s57, 0x30004
    s_mul_i32 s64, s56, 176128
    s_add_u32 m0, s59, 139264
    s_nop 0
    buffer_load_dwordx4 v20, s[12:15], s64 offen offset:0  lds
    s_lshl4_add_u32 s53, s49, s53
    v_mfma_f32_32x32x16_bf16 v[140:155], a[76:79], v[240:243], v[140:155]
    ds_read_b64_tr_b16 v[232:233], v33 offset:16384
    ds_read_b64_tr_b16 v[234:235], v33 offset:17408
    buffer_load_dwordx4 v21, s[12:15], s64 offen offset:1024  lds
    s_lshl2_add_u32 s53, s53, s46
    s_waitcnt lgkmcnt(9)
    v_mfma_f32_32x32x16_bf16 v[156:171], a[76:79], v[244:247], v[156:171]
    ds_read_b128 a[84:87], v23 offset:16384
    ds_read_b64_tr_b16 v[236:237], v30 offset:20480
    ds_read_b64_tr_b16 v[238:239], v30 offset:21504
    s_lshl_b32 s53, s53, 12
    s_add_u32 s53, s53, 0x1000000
    v_mfma_f32_32x32x16_bf16 v[172:187], a[76:79], v[248:251], v[172:187]
    ds_read_b64_tr_b16 v[240:241], v31 offset:20480
    ds_read_b64_tr_b16 v[242:243], v31 offset:21504
    s_bfe_u32 s56, s57, 0x30010
    s_mul_i32 s64, s56, 176128
    s_add_u32 m0, s59, 147456
    s_nop 0
    buffer_load_dwordx4 v20, s[12:15], s64 offen offset:0  lds
    s_xor_b32 s79, s53, 0x4000
    s_waitcnt lgkmcnt(9)
    v_mfma_f32_32x32x16_bf16 v[124:139], a[80:83], v[220:223], v[124:139]
    ds_read_b64_tr_b16 v[244:245], v32 offset:20480
    ds_read_b64_tr_b16 v[246:247], v32 offset:21504
    buffer_load_dwordx4 v21, s[12:15], s64 offen offset:1024  lds
    v_cmp_gt_u32 vcc, 32, v1
    s_addk_i32 s53, 2048
    v_mov_b32 v9, s53
    v_cndmask_b32 v45, v9, v45, vcc
    v_lshl_add_u32 v9, v5, 2, v6
    v_lshrrev_b32 v11, 1, v6
    v_xor_b32 v11, s47, v11
    v_lshl_add_u32 v9, v9, 1, v11
    v_lshl_add_u32 v56, v9, 6, v8
    v_add_u32 v57, 0x10000, v56
    v_add_u32 v58, 0x20000, v56
    v_xor_b32 v59, 64, v56
    v_xor_b32 v60, 64, v57
    v_xor_b32 v61, 64, v58
    s_and_b32 s54, s48, 15
    s_lshl4_add_u32 s54, s47, s54
    s_lshr_b32 s41, s49, 1
    s_sub_u32 s52, 7, s46
    s_movk_i32 s53, -1024
    s_cmp_eq_u32 s41, 0
    s_cselect_b32 s85, s52, 12
    s_cselect_b32 s86, 0, 0x3f803f80
    s_cselect_b32 s87, 0, -1
    s_bitcmp1_b32 s41, 0
    s_cselect_b32 s52, s46, s52
    s_cselect_b32 s67, 0x400, s53
    s_and_b32 s87, s87, s67
    s_lshl3_add_u32 s55, s41, s52
    s_lshl_b32 s40, s54, 6
    s_add_u32 s72, s40, s55
    s_lshl_b32 s72, s72, 10
    s_lshl_b32 s55, s55, 5
    s_add_u32 s55, s55, s54
    s_lshl_b32 s55, s55, 10
    s_add_u32 s74, s55, 0xc00000
    s_and_b32 s52, s52, 3
    s_lshl2_add_u32 s55, s41, s52
    s_lshl1_add_u32 s55, s55, s47
    s_lshl_b32 s55, s55, 5
    s_and_b32 s53, s48, 15
    s_add_u32 s55, s55, s53
    s_lshl2_add_u32 s69, s55, 0xe48000
    buffer_load_dword v55, v41, s[24:27], s79 offen offset:2048 sc1
    s_lshr_b32 s54, s54, 3
    v_mfma_f32_32x32x16_bf16 v[140:155], a[80:83], v[224:227], v[140:155]
    ds_read_b64_tr_b16 v[248:249], v33 offset:20480
    ds_read_b64_tr_b16 v[250:251], v33 offset:21504
    s_bfe_u32 s56, s57, 0x30014
    s_mul_i32 s64, s56, 176128
    s_add_u32 m0, s59, 155648
    s_nop 0
    buffer_load_dwordx4 v20, s[12:15], s64 offen offset:0  lds
    s_lshl3_add_u32 s55, s41, s54
    s_waitcnt lgkmcnt(9)
    v_mfma_f32_32x32x16_bf16 v[156:171], a[80:83], v[228:231], v[156:171]
    ds_read_b128 a[88:91], v24 offset:16384
    ds_read_b64_tr_b16 v[220:221], v30 offset:24576
    ds_read_b64_tr_b16 v[222:223], v30 offset:25600
    buffer_load_dwordx4 v21, s[12:15], s64 offen offset:1024  lds
    s_lshl4_add_u32 s55, s55, s52
    v_mfma_f32_32x32x16_bf16 v[172:187], a[80:83], v[232:235], v[172:187]
    ds_read_b64_tr_b16 v[224:225], v31 offset:24576
    ds_read_b64_tr_b16 v[226:227], v31 offset:25600
    v_and_b32 v9, 1, v1
    v_lshl_add_u32 v11, v9, 6, s55
    s_waitcnt lgkmcnt(9)
    v_mfma_f32_32x32x16_bf16 v[124:139], a[84:87], v[236:239], v[124:139]
    ds_read_b64_tr_b16 v[228:229], v32 offset:24576
    ds_read_b64_tr_b16 v[230:231], v32 offset:25600
    s_bfe_u32 s56, s57, 0x30008
    s_mul_i32 s64, s56, 176128
    s_add_u32 m0, s59, 49152
    s_nop 0
    buffer_load_dwordx4 v20, s[12:15], s64 offen offset:0  lds
    s_lshl_b32 s52, s46, 1
    v_mfma_f32_32x32x16_bf16 v[140:155], a[84:87], v[240:243], v[140:155]
    ds_read_b64_tr_b16 v[232:233], v33 offset:24576
    ds_read_b64_tr_b16 v[234:235], v33 offset:25600
    buffer_load_dwordx4 v21, s[12:15], s64 offen offset:1024  lds
    s_sub_u32 s53, 7, s52
    s_waitcnt lgkmcnt(9)
    v_mfma_f32_32x32x16_bf16 v[156:171], a[84:87], v[244:247], v[156:171]
    ds_read_b128 a[92:95], v25 offset:16384
    ds_read_b64_tr_b16 v[236:237], v30 offset:28672
    ds_read_b64_tr_b16 v[238:239], v30 offset:29696
    s_bfe_u32 s56, s57, 0x3000c
    s_mul_i32 s64, s56, 176128
    s_add_u32 m0, s59, 57344
    s_nop 0
    buffer_load_dwordx4 v20, s[12:15], s64 offen offset:0  lds
    s_sub_u32 s52, s52, 8
    v_mfma_f32_32x32x16_bf16 v[172:187], a[84:87], v[248:251], v[172:187]
    ds_read_b64_tr_b16 v[240:241], v31 offset:28672
    ds_read_b64_tr_b16 v[242:243], v31 offset:29696
    buffer_load_dwordx4 v21, s[12:15], s64 offen offset:1024  lds
    s_bitcmp1_b32 s41, 0
    s_cselect_b32 s52, s52, s53
    s_waitcnt lgkmcnt(9)
    v_mfma_f32_32x32x16_bf16 v[124:139], a[88:91], v[220:223], v[124:139]
    ds_read_b64_tr_b16 v[244:245], v32 offset:28672
    ds_read_b64_tr_b16 v[246:247], v32 offset:29696
    s_lshl3_add_u32 s52, s41, s52
    s_add_u32 s40, s40, s52
    v_mfma_f32_32x32x16_bf16 v[140:155], a[88:91], v[224:227], v[140:155]
    ds_read_b64_tr_b16 v[248:249], v33 offset:28672
    ds_read_b64_tr_b16 v[250:251], v33 offset:29696
    s_lshl_b32 s40, s40, 10
    s_add_u32 s70, s40, 0x200000
    s_waitcnt lgkmcnt(9)
    v_mfma_f32_32x32x16_bf16 v[156:171], a[88:91], v[228:231], v[156:171]
    s_waitcnt vmcnt(22)
    s_barrier
    ds_read_b128 a[96:99], v26
    ds_read_b64_tr_b16 v[220:221], v30 offset:32768
    ds_read_b64_tr_b16 v[222:223], v30 offset:33792
    v_and_b32 v77, 31, v1
    s_andn2_b32 s84, s84, 0xff
    v_lshlrev_b32 v77, 3, v77
    buffer_load_dwordx2 v[70:71], v77, s[24:27], s84 offen sc1
    s_add_u32 s71, s40, 0x400000
    v_mfma_f32_32x32x16_bf16 v[172:187], a[88:91], v[232:235], v[172:187]
    ds_read_b64_tr_b16 v[224:225], v31 offset:32768
    ds_read_b64_tr_b16 v[226:227], v31 offset:33792
    s_and_b32 s53, s52, -4
    s_add_u32 s53, s53, s54
    s_waitcnt lgkmcnt(9)
    v_mfma_f32_32x32x16_bf16 v[124:139], a[92:95], v[236:239], v[124:139]
    ds_read_b64_tr_b16 v[228:229], v32 offset:32768
    ds_read_b64_tr_b16 v[230:231], v32 offset:33792
    s_and_b32 s52, s52, 2
    s_lshl4_add_u32 s53, s53, s52
    v_mfma_f32_32x32x16_bf16 v[140:155], a[92:95], v[240:243], v[140:155]
    ds_read_b64_tr_b16 v[232:233], v33 offset:32768
    ds_read_b64_tr_b16 v[234:235], v33 offset:33792
    s_addk_i32 s53, 1024
    v_and_b32 v42, 2, v1
    s_waitcnt lgkmcnt(9)
    v_mfma_f32_32x32x16_bf16 v[156:171], a[92:95], v[244:247], v[156:171]
    ds_read_b128 a[100:103], v27
    ds_read_b64_tr_b16 v[236:237], v30 offset:36864
    ds_read_b64_tr_b16 v[238:239], v30 offset:37888
    v_lshl_add_u32 v43, v42, 1, v9
    v_add_u32 v43, s53, v43
    v_mfma_f32_32x32x16_bf16 v[172:187], a[92:95], v[248:251], v[172:187]
    ds_read_b64_tr_b16 v[240:241], v31 offset:36864
    ds_read_b64_tr_b16 v[242:243], v31 offset:37888
    s_mul_i32 s73, s46, 2080
    v_mul_u32_u24 v9, 1040, v9
    s_waitcnt lgkmcnt(9)
    v_mfma_f32_32x32x16_bf16 v[124:139], a[96:99], v[220:223], v[124:139]
    ds_read_b64_tr_b16 v[244:245], v32 offset:36864
    ds_read_b64_tr_b16 v[246:247], v32 offset:37888
    s_bfe_u32 s56, s57, 0x30018
    s_mul_i32 s64, s56, 176128
    s_add_u32 m0, s59, 65536
    s_nop 0
    buffer_load_dwordx4 v20, s[12:15], s64 offen offset:0  lds
    s_movk_i32 s55, 4160
    v_mfma_f32_32x32x16_bf16 v[140:155], a[96:99], v[224:227], v[140:155]
    ds_read_b64_tr_b16 v[248:249], v33 offset:36864
    ds_read_b64_tr_b16 v[250:251], v33 offset:37888
    buffer_load_dwordx4 v21, s[12:15], s64 offen offset:1024  lds
    v_mad_u32_u24 v9, v42, s55, v9
    s_waitcnt lgkmcnt(9)
    v_mfma_f32_32x32x16_bf16 v[156:171], a[96:99], v[228:231], v[156:171]
    ds_read_b128 a[104:107], v28
    ds_read_b64_tr_b16 v[220:221], v30 offset:40960
    ds_read_b64_tr_b16 v[222:223], v30 offset:41984
    s_bfe_u32 s56, s57, 0x3001c
    s_mul_i32 s64, s56, 176128
    s_add_u32 m0, s59, 73728
    s_nop 0
    buffer_load_dwordx4 v20, s[12:15], s64 offen offset:0  lds
    s_add_u32 s73, s73, 16384
    v_mfma_f32_32x32x16_bf16 v[172:187], a[96:99], v[232:235], v[172:187]
    ds_read_b64_tr_b16 v[224:225], v31 offset:40960
    ds_read_b64_tr_b16 v[226:227], v31 offset:41984
    buffer_load_dwordx4 v21, s[12:15], s64 offen offset:1024  lds
    s_add_u32 s55, s73, 1024
    s_waitcnt lgkmcnt(9)
    v_mfma_f32_32x32x16_bf16 v[124:139], a[100:103], v[236:239], v[124:139]
    ds_read_b64_tr_b16 v[228:229], v32 offset:40960
    ds_read_b64_tr_b16 v[230:231], v32 offset:41984
    v_add_u32 v49, s55, v9
    v_mov_b32 v9, s86
    v_mfma_f32_32x32x16_bf16 v[140:155], a[100:103], v[240:243], v[140:155]
    ds_read_b64_tr_b16 v[232:233], v33 offset:40960
    ds_read_b64_tr_b16 v[234:235], v33 offset:41984
    v_cmp_eq_u32 vcc, 0, v42
    v_mov_b32 v80, 0x3f803f80
    s_mov_b32 s55, 0xe40000
    v_cndmask_b32 v80, v9, v80, vcc
    v_mov_b32 v81, v80
    s_waitcnt lgkmcnt(9)
    v_mfma_f32_32x32x16_bf16 v[156:171], a[100:103], v[244:247], v[156:171]
    ds_read_b128 a[108:111], v29
    ds_read_b64_tr_b16 v[236:237], v30 offset:45056
    ds_read_b64_tr_b16 v[238:239], v30 offset:46080
    v_mov_b32 v82, v80
    v_mov_b32 v83, v80
    v_mfma_f32_32x32x16_bf16 v[172:187], a[100:103], v[248:251], v[172:187]
    ds_read_b64_tr_b16 v[240:241], v31 offset:45056
    ds_read_b64_tr_b16 v[242:243], v31 offset:46080
    v_cmp_gt_u32 vcc, 32, v1
    v_add_u32 v46, s60, v2
    s_add_u32 s87, s87, s55
    v_cndmask_b32 v9, v11, v43, vcc
    v_lshl_add_u32 v42, v9, 3, s55
    s_waitcnt lgkmcnt(9)
    v_mfma_f32_32x32x16_bf16 v[124:139], a[104:107], v[220:223], v[124:139]
    ds_read_b64_tr_b16 v[244:245], v32 offset:45056
    ds_read_b64_tr_b16 v[246:247], v32 offset:46080
    v_lshl_add_u32 v43, v43, 3, s87
    v_lshlrev_b32 v9, 8, v5
    v_mfma_f32_32x32x16_bf16 v[140:155], a[104:107], v[224:227], v[140:155]
    ds_read_b64_tr_b16 v[248:249], v33 offset:45056
    ds_read_b64_tr_b16 v[250:251], v33 offset:46080
    v_lshl_add_u32 v9, v10, 4, v9
    v_add_u32 v11, 512, v9
    s_waitcnt lgkmcnt(9)
    v_mfma_f32_32x32x16_bf16 v[156:171], a[104:107], v[228:231], v[156:171]
    s_waitcnt vmcnt(18)
    s_barrier
    ds_read_b128 a[112:115], v22 offset:32768
    ds_read_b64_tr_b16 v[220:221], v30 offset:49152
    ds_read_b64_tr_b16 v[222:223], v30 offset:50176
    v_cmp_eq_u32 vcc, 0, v7
    v_mov_b32 v48, 1024
    s_mul_i32 s55, s46, 1040
    v_cndmask_b32 v47, v48, v9, vcc
    v_cndmask_b32 v48, v48, v11, vcc
    v_add_u32 v47, s55, v47
    v_mfma_f32_32x32x16_bf16 v[172:187], a[104:107], v[232:235], v[172:187]
    ds_read_b128 a[116:119], v23 offset:32768
    ds_read_b64_tr_b16 v[224:225], v30 offset:53248
    ds_read_b64_tr_b16 v[226:227], v30 offset:54272
    v_add_u32 v48, s55, v48
    v_lshl_add_u32 v84, v7, 16, v9
    s_waitcnt lgkmcnt(10)
    v_mfma_f32_32x32x16_bf16 v[124:139], a[108:111], v[236:239], v[124:139]
    ds_read_b128 a[120:123], v24 offset:32768
    ds_read_b64_tr_b16 v[228:229], v30 offset:57344
    ds_read_b64_tr_b16 v[230:231], v30 offset:58368
    v_lshlrev_b32 v9, 2, v5
    v_sub_u32 v9, v4, v9
    v_mfma_f32_32x32x16_bf16 v[140:155], a[108:111], v[240:243], v[140:155]
    ds_read_b128 a[124:127], v25 offset:32768
    ds_read_b64_tr_b16 v[232:233], v30 offset:61440
    ds_read_b64_tr_b16 v[234:235], v30 offset:62464
    v_cvt_f32_i32 v9, v9
    v_cvt_f32_i32 v11, s67
    s_waitcnt lgkmcnt(12)
    v_mfma_f32_32x32x16_bf16 v[156:171], a[108:111], v[244:247], v[156:171]
    ds_read_b64_tr_b16 v[236:237], v31 offset:49152
    ds_read_b64_tr_b16 v[238:239], v31 offset:50176
    v_mul_f32 v11, 0x6cc9f2ca, v11
    v_mul_f32 v9, v9, v11
    v_mfma_f32_32x32x16_bf16 v[172:187], a[108:111], v[248:251], v[172:187]
    ds_read_b64_tr_b16 v[240:241], v31 offset:53248
    ds_read_b64_tr_b16 v[242:243], v31 offset:54272
    v_fmamk_f32 v108, v11, 0x3f000000, v9
    v_min_f32 v92, 0, v108
    s_waitcnt lgkmcnt(10)
    v_mfma_f32_32x32x16_bf16 v[124:139], a[112:115], v[220:223], v[124:139]
    ds_read_b64_tr_b16 v[244:245], v31 offset:57344
    ds_read_b64_tr_b16 v[246:247], v31 offset:58368
    v_min_f32 v108, 0, -v108
    v_fmamk_f32 v109, v11, 0xbf000000, v9
    v_mfma_f32_32x32x16_bf16 v[124:139], a[116:119], v[224:227], v[124:139]
    ds_read_b64_tr_b16 v[248:249], v31 offset:61440
    ds_read_b64_tr_b16 v[250:251], v31 offset:62464
    v_min_f32 v93, 0, v109
    v_min_f32 v109, 0, -v109
    s_waitcnt lgkmcnt(8)
    v_mfma_f32_32x32x16_bf16 v[124:139], a[120:123], v[228:231], v[124:139]
    ds_read_b64_tr_b16 v[220:221], v32 offset:49152
    ds_read_b64_tr_b16 v[222:223], v32 offset:50176
    v_fmamk_f32 v110, v11, 0xbfc00000, v9
    v_min_f32 v94, 0, v110
    v_mfma_f32_32x32x16_bf16 v[124:139], a[124:127], v[232:235], v[124:139]
    ds_read_b64_tr_b16 v[224:225], v32 offset:53248
    ds_read_b64_tr_b16 v[226:227], v32 offset:54272
    v_min_f32 v110, 0, -v110
    v_fmamk_f32 v111, v11, 0xc0200000, v9
    s_waitcnt vmcnt(4)
    v_cmp_ne_u64 vcc, v[70:71], v[68:69]
    s_cbranch_vccnz CHKV_slow
CHKV_back:
    s_or_b32 s82, s82, s81
    s_cmp_lg_u32 s82, 0
    s_cbranch_scc1 DUPV
    s_waitcnt lgkmcnt(8)
    v_mfma_f32_32x32x16_bf16 v[140:155], a[112:115], v[236:239], v[140:155]
    ds_read_b64_tr_b16 v[228:229], v32 offset:57344
    ds_read_b64_tr_b16 v[230:231], v32 offset:58368
    v_min_f32 v95, 0, v111
    v_min_f32 v111, 0, -v111
    v_mfma_f32_32x32x16_bf16 v[140:155], a[116:119], v[240:243], v[140:155]
    ds_read_b64_tr_b16 v[232:233], v32 offset:61440
    ds_read_b64_tr_b16 v[234:235], v32 offset:62464
    v_fmamk_f32 v112, v11, 0xc0f00000, v9
    v_min_f32 v96, 0, v112
    s_waitcnt lgkmcnt(8)
    v_mfma_f32_32x32x16_bf16 v[140:155], a[120:123], v[244:247], v[140:155]
    ds_read_b64_tr_b16 v[236:237], v33 offset:49152
    ds_read_b64_tr_b16 v[238:239], v33 offset:50176
    v_mov_b32 v40, v84
    v_cvt_pk_bf16_f32 v124, v124, v125
    v_cvt_pk_bf16_f32 v125, v126, v127
    v_cvt_pk_bf16_f32 v126, v128, v129
    v_mfma_f32_32x32x16_bf16 v[140:155], a[124:127], v[248:251], v[140:155]
    ds_read_b64_tr_b16 v[240:241], v33 offset:53248
    ds_read_b64_tr_b16 v[242:243], v33 offset:54272
    v_cvt_pk_bf16_f32 v127, v130, v131
    buffer_store_dwordx4 v[124:127], v40, s[24:27], s65 offen offset:0 sc1
    s_waitcnt lgkmcnt(8)
    v_mfma_f32_32x32x16_bf16 v[156:171], a[112:115], v[220:223], v[156:171]
    ds_read_b64_tr_b16 v[244:245], v33 offset:57344
    ds_read_b64_tr_b16 v[246:247], v33 offset:58368
    v_cvt_pk_bf16_f32 v132, v132, v133
    v_cvt_pk_bf16_f32 v133, v134, v135
    v_cvt_pk_bf16_f32 v134, v136, v137
    v_cvt_pk_bf16_f32 v135, v138, v139
    v_mfma_f32_32x32x16_bf16 v[156:171], a[116:119], v[224:227], v[156:171]
    ds_read_b64_tr_b16 v[248:249], v33 offset:61440
    ds_read_b64_tr_b16 v[250:251], v33 offset:62464
    buffer_store_dwordx4 v[132:135], v40, s[24:27], s65 offen offset:512 sc1
    s_waitcnt lgkmcnt(8)
    v_mfma_f32_32x32x16_bf16 v[156:171], a[120:123], v[228:231], v[156:171]
    s_barrier
    ds_read_b64_tr_b16 v[220:221], v36 offset:0
    ds_read_b64_tr_b16 v[222:223], v36 offset:512
    v_cvt_pk_bf16_f32 v140, v140, v141
    v_cvt_pk_bf16_f32 v141, v142, v143
    v_cvt_pk_bf16_f32 v142, v144, v145
    v_mfma_f32_32x32x16_bf16 v[156:171], a[124:127], v[232:235], v[156:171]
    ds_read_b64_tr_b16 v[224:225], v36 offset:2048
    ds_read_b64_tr_b16 v[226:227], v36 offset:2560
    v_cvt_pk_bf16_f32 v143, v146, v147
    s_add_u32 s65, s65, 131072
    s_waitcnt lgkmcnt(8)
    v_mfma_f32_32x32x16_bf16 v[172:187], a[112:115], v[236:239], v[172:187]
    ds_read_b64_tr_b16 v[228:229], v36 offset:4096
    ds_read_b64_tr_b16 v[230:231], v36 offset:4608
    buffer_store_dwordx4 v[140:143], v40, s[24:27], s65 offen offset:0 sc1
    v_cvt_pk_bf16_f32 v148, v148, v149
    v_cvt_pk_bf16_f32 v149, v150, v151
    v_mfma_f32_32x32x16_bf16 v[172:187], a[116:119], v[240:243], v[172:187]
    ds_read_b64_tr_b16 v[232:233], v36 offset:6144
    ds_read_b64_tr_b16 v[234:235], v36 offset:6656
    v_cvt_pk_bf16_f32 v150, v152, v153
    v_cvt_pk_bf16_f32 v151, v154, v155
    s_waitcnt lgkmcnt(8)
    v_mfma_f32_32x32x16_bf16 v[172:187], a[120:123], v[244:247], v[172:187]
    ds_read_b64_tr_b16 v[236:237], v36 offset:8192
    ds_read_b64_tr_b16 v[238:239], v36 offset:8704
    buffer_store_dwordx4 v[148:151], v40, s[24:27], s65 offen offset:512 sc1
    v_cvt_pk_bf16_f32 v156, v156, v157
    v_cvt_pk_bf16_f32 v157, v158, v159
    v_mfma_f32_32x32x16_bf16 v[172:187], a[124:127], v[248:251], v[172:187]
    ds_read_b64_tr_b16 v[240:241], v36 offset:10240
    ds_read_b64_tr_b16 v[242:243], v36 offset:10752
    v_cvt_pk_bf16_f32 v158, v160, v161
    v_cvt_pk_bf16_f32 v159, v162, v163
    s_add_u32 s65, s65, 131072
    s_waitcnt lgkmcnt(8)
    v_mfma_f32_32x32x16_bf16 v[188:203], v[220:223], a[0:3], 0
    ds_read_b64_tr_b16 v[244:245], v36 offset:12288
    ds_read_b64_tr_b16 v[246:247], v36 offset:12800
    buffer_store_dwordx4 v[156:159], v40, s[24:27], s65 offen offset:0 sc1
    v_cvt_pk_bf16_f32 v164, v164, v165
    v_cvt_pk_bf16_f32 v165, v166, v167
    v_mfma_f32_32x32x16_bf16 v[188:203], v[224:227], a[4:7], v[188:203]
    ds_read_b64_tr_b16 v[248:249], v36 offset:14336
    ds_read_b64_tr_b16 v[250:251], v36 offset:14848
    v_cvt_pk_bf16_f32 v166, v168, v169
    v_cvt_pk_bf16_f32 v167, v170, v171
    s_waitcnt lgkmcnt(8)
    v_mfma_f32_32x32x16_bf16 v[188:203], v[228:231], a[8:11], v[188:203]
    s_barrier
    ds_read_b64_tr_b16 v[220:221], v34 offset:0
    ds_read_b64_tr_b16 v[222:223], v34 offset:512
    buffer_store_dwordx4 v[164:167], v40, s[24:27], s65 offen offset:512 sc1
    v_cvt_pk_bf16_f32 v172, v172, v173
    v_mfma_f32_32x32x16_bf16 v[188:203], v[232:235], a[12:15], v[188:203]
    ds_read_b64_tr_b16 v[224:225], v34 offset:2048
    ds_read_b64_tr_b16 v[226:227], v34 offset:2560
    v_cvt_pk_bf16_f32 v173, v174, v175
    v_cvt_pk_bf16_f32 v174, v176, v177
    v_cvt_pk_bf16_f32 v175, v178, v179
    s_waitcnt lgkmcnt(8)
    v_mfma_f32_32x32x16_bf16 v[188:203], v[236:239], a[16:19], v[188:203]
    ds_read_b64_tr_b16 v[228:229], v34 offset:4096
    ds_read_b64_tr_b16 v[230:231], v34 offset:4608
    s_add_u32 s65, s65, 131072
    buffer_store_dwordx4 v[172:175], v40, s[24:27], s65 offen offset:0 sc1
    v_cvt_pk_bf16_f32 v180, v180, v181
    v_mfma_f32_32x32x16_bf16 v[188:203], v[240:243], a[20:23], v[188:203]
    ds_read_b64_tr_b16 v[232:233], v34 offset:6144
    ds_read_b64_tr_b16 v[234:235], v34 offset:6656
    v_cvt_pk_bf16_f32 v181, v182, v183
    v_cvt_pk_bf16_f32 v182, v184, v185
    v_cvt_pk_bf16_f32 v183, v186, v187
    s_waitcnt lgkmcnt(8)
    v_mfma_f32_32x32x16_bf16 v[188:203], v[244:247], a[24:27], v[188:203]
    ds_read_b64_tr_b16 v[236:237], v34 offset:8192
    ds_read_b64_tr_b16 v[238:239], v34 offset:8704
    buffer_store_dwordx4 v[180:183], v40, s[24:27], s65 offen offset:512 sc1
    v_mfma_f32_32x32x16_bf16 v[188:203], v[248:251], a[28:31], v[188:203]
    ds_read_b64_tr_b16 v[240:241], v34 offset:10240
    ds_read_b64_tr_b16 v[242:243], v34 offset:10752
    v_min_f32 v112, 0, -v112
    v_fmamk_f32 v113, v11, 0xc1080000, v9
    s_waitcnt lgkmcnt(8)
    v_mfma_f32_32x32x16_bf16 v[188:203], v[220:223], a[32:35], v[188:203]
    ds_read_b64_tr_b16 v[244:245], v34 offset:12288
    ds_read_b64_tr_b16 v[246:247], v34 offset:12800
    v_min_f32 v97, 0, v113
    v_min_f32 v113, 0, -v113
    v_mfma_f32_32x32x16_bf16 v[188:203], v[224:227], a[36:39], v[188:203]
    ds_read_b64_tr_b16 v[248:249], v34 offset:14336
    ds_read_b64_tr_b16 v[250:251], v34 offset:14848
    v_fmamk_f32 v114, v11, 0xc1180000, v9
    v_min_f32 v98, 0, v114
    s_waitcnt lgkmcnt(8)
    v_mfma_f32_32x32x16_bf16 v[188:203], v[228:231], a[40:43], v[188:203]
    s_barrier
    ds_read_b64_tr_b16 v[220:221], v36 offset:16384
    ds_read_b64_tr_b16 v[222:223], v36 offset:16896
    v_min_f32 v114, 0, -v114
    v_fmamk_f32 v115, v11, 0xc1280000, v9
    v_mfma_f32_32x32x16_bf16 v[188:203], v[232:235], a[44:47], v[188:203]
    ds_read_b64_tr_b16 v[224:225], v36 offset:18432
    ds_read_b64_tr_b16 v[226:227], v36 offset:18944
    v_min_f32 v99, 0, v115
    v_min_f32 v115, 0, -v115
    s_waitcnt lgkmcnt(8)
    v_mfma_f32_32x32x16_bf16 v[188:203], v[236:239], a[48:51], v[188:203]
    ds_read_b64_tr_b16 v[228:229], v36 offset:20480
    ds_read_b64_tr_b16 v[230:231], v36 offset:20992
    v_fmamk_f32 v116, v11, 0xc1780000, v9
    v_min_f32 v100, 0, v116
    v_mfma_f32_32x32x16_bf16 v[188:203], v[240:243], a[52:55], v[188:203]
    ds_read_b64_tr_b16 v[232:233], v36 offset:22528
    ds_read_b64_tr_b16 v[234:235], v36 offset:23040
    v_min_f32 v116, 0, -v116
    v_fmamk_f32 v117, v11, 0xc1840000, v9
    s_waitcnt lgkmcnt(8)
    v_mfma_f32_32x32x16_bf16 v[188:203], v[244:247], a[56:59], v[188:203]
    ds_read_b64_tr_b16 v[236:237], v36 offset:24576
    ds_read_b64_tr_b16 v[238:239], v36 offset:25088
    v_min_f32 v101, 0, v117
    v_min_f32 v117, 0, -v117
    v_mfma_f32_32x32x16_bf16 v[188:203], v[248:251], a[60:63], v[188:203]
    ds_read_b64_tr_b16 v[240:241], v36 offset:26624
    ds_read_b64_tr_b16 v[242:243], v36 offset:27136
    v_fmamk_f32 v118, v11, 0xc18c0000, v9
    v_min_f32 v102, 0, v118
    s_waitcnt lgkmcnt(8)
    v_mfma_f32_32x32x16_bf16 v[188:203], v[220:223], a[64:67], v[188:203]
    ds_read_b64_tr_b16 v[244:245], v36 offset:28672
    ds_read_b64_tr_b16 v[246:247], v36 offset:29184
    v_min_f32 v118, 0, -v118
    v_fmamk_f32 v119, v11, 0xc1940000, v9
    v_mfma_f32_32x32x16_bf16 v[188:203], v[224:227], a[68:71], v[188:203]
    ds_read_b64_tr_b16 v[248:249], v36 offset:30720
    ds_read_b64_tr_b16 v[250:251], v36 offset:31232
    v_min_f32 v103, 0, v119
    v_min_f32 v119, 0, -v119
    s_waitcnt lgkmcnt(8)
    v_mfma_f32_32x32x16_bf16 v[188:203], v[228:231], a[72:75], v[188:203]
    s_waitcnt vmcnt(8)
    s_barrier
    ds_read_b64_tr_b16 v[220:221], v34 offset:16384
    ds_read_b64_tr_b16 v[222:223], v34 offset:16896
    v_fmamk_f32 v120, v11, 0xc1bc0000, v9
    v_min_f32 v104, 0, v120
    v_mfma_f32_32x32x16_bf16 v[188:203], v[232:235], a[76:79], v[188:203]
    ds_read_b64_tr_b16 v[224:225], v34 offset:18432
    ds_read_b64_tr_b16 v[226:227], v34 offset:18944
    v_min_f32 v120, 0, -v120
    v_fmamk_f32 v121, v11, 0xc1c40000, v9
    s_waitcnt lgkmcnt(8)
    v_mfma_f32_32x32x16_bf16 v[188:203], v[236:239], a[80:83], v[188:203]
    ds_read_b64_tr_b16 v[228:229], v34 offset:20480
    ds_read_b64_tr_b16 v[230:231], v34 offset:20992
    v_min_f32 v105, 0, v121
    v_min_f32 v121, 0, -v121
    v_mfma_f32_32x32x16_bf16 v[188:203], v[240:243], a[84:87], v[188:203]
    ds_read_b64_tr_b16 v[232:233], v34 offset:22528
    ds_read_b64_tr_b16 v[234:235], v34 offset:23040
    v_fmamk_f32 v122, v11, 0xc1cc0000, v9
    v_min_f32 v106, 0, v122
    s_waitcnt lgkmcnt(8)
    v_mfma_f32_32x32x16_bf16 v[188:203], v[244:247], a[88:91], v[188:203]
    ds_read_b64_tr_b16 v[236:237], v34 offset:24576
    ds_read_b64_tr_b16 v[238:239], v34 offset:25088
    s_waitcnt vmcnt(0)
    buffer_store_dwordx2 v[72:73], v41, s[24:27], s68 offen
DUPV_back:
    v_min_f32 v122, 0, -v122
    v_mfma_f32_32x32x16_bf16 v[188:203], v[248:251], a[92:95], v[188:203]
    ds_read_b64_tr_b16 v[240:241], v34 offset:26624
    ds_read_b64_tr_b16 v[242:243], v34 offset:27136
    v_fmamk_f32 v123, v11, 0xc1d40000, v9
    v_min_f32 v107, 0, v123
    s_waitcnt lgkmcnt(8)
    v_mfma_f32_32x32x16_bf16 v[188:203], v[220:223], a[96:99], v[188:203]
    ds_read_b64_tr_b16 v[244:245], v34 offset:28672
    ds_read_b64_tr_b16 v[246:247], v34 offset:29184
    s_add_u32 m0, s58, 114688
    s_nop 0
    buffer_load_dwordx4 v50, s[16:19], s77 offen offset:0  lds
    v_min_f32 v123, 0, -v123
    v_mfma_f32_32x32x16_bf16 v[188:203], v[224:227], a[100:103], v[188:203]
    ds_read_b64_tr_b16 v[248:249], v34 offset:30720
    ds_read_b64_tr_b16 v[250:251], v34 offset:31232
    buffer_load_dwordx4 v51, s[16:19], s77 offen offset:1024  lds
    s_mov_b32 s86, 0x21800000
    s_waitcnt lgkmcnt(8)
    v_mfma_f32_32x32x16_bf16 v[188:203], v[228:231], a[104:107], v[188:203]
    ds_read_b64_tr_b16 v[220:221], v37 offset:0
    ds_read_b64_tr_b16 v[222:223], v37 offset:512
    buffer_load_dwordx4 v52, s[16:19], s77 offen offset:2048  lds
    s_mov_b32 s87, 0x5d800000
    v_mfma_f32_32x32x16_bf16 v[188:203], v[232:235], a[108:111], v[188:203]
    ds_read_b64_tr_b16 v[224:225], v37 offset:2048
    ds_read_b64_tr_b16 v[226:227], v37 offset:2560
    buffer_load_dwordx4 v53, s[16:19], s77 offen offset:3072  lds
    s_waitcnt lgkmcnt(8)
    v_mfma_f32_32x32x16_bf16 v[188:203], v[236:239], a[112:115], v[188:203]
    ds_read_b64_tr_b16 v[228:229], v37 offset:4096
    ds_read_b64_tr_b16 v[230:231], v37 offset:4608
    s_xor_b32 s77, s77, 0x20000
    s_add_u32 m0, s58, 81920
    s_nop 0
    buffer_load_dwordx4 v50, s[16:19], s77 offen offset:0  lds
    v_mfma_f32_32x32x16_bf16 v[188:203], v[240:243], a[116:119], v[188:203]
    ds_read_b64_tr_b16 v[232:233], v37 offset:6144
    ds_read_b64_tr_b16 v[234:235], v37 offset:6656
    buffer_load_dwordx4 v51, s[16:19], s77 offen offset:1024  lds
    s_waitcnt lgkmcnt(8)
    v_mfma_f32_32x32x16_bf16 v[188:203], v[244:247], a[120:123], v[188:203]
    ds_read_b64_tr_b16 v[236:237], v37 offset:8192
    ds_read_b64_tr_b16 v[238:239], v37 offset:8704
    buffer_load_dwordx4 v52, s[16:19], s77 offen offset:2048  lds
    v_mfma_f32_32x32x16_bf16 v[188:203], v[248:251], a[124:127], v[188:203]
    ds_read_b64_tr_b16 v[240:241], v37 offset:10240
    ds_read_b64_tr_b16 v[242:243], v37 offset:10752
    buffer_load_dwordx4 v53, s[16:19], s77 offen offset:3072  lds
    s_waitcnt lgkmcnt(8)
    v_mfma_f32_32x32x16_bf16 v[204:219], v[220:223], a[0:3], 0
    ds_read_b64_tr_b16 v[244:245], v37 offset:12288
    ds_read_b64_tr_b16 v[246:247], v37 offset:12800
    s_xor_b32 s77, s77, 0x60000
    s_add_u32 m0, s58, 98304
    s_nop 0
    buffer_load_dwordx4 v50, s[16:19], s77 offen offset:0  lds
    v_mfma_f32_32x32x16_bf16 v[204:219], v[224:227], a[4:7], v[204:219]
    ds_read_b64_tr_b16 v[248:249], v37 offset:14336
    ds_read_b64_tr_b16 v[250:251], v37 offset:14848
    buffer_load_dwordx4 v51, s[16:19], s77 offen offset:1024  lds
    s_waitcnt lgkmcnt(8)
    v_mfma_f32_32x32x16_bf16 v[204:219], v[228:231], a[8:11], v[204:219]
    ds_read_b64_tr_b16 v[220:221], v35 offset:0
    ds_read_b64_tr_b16 v[222:223], v35 offset:512
    buffer_load_dwordx4 v52, s[16:19], s77 offen offset:2048  lds
    v_mul_f32 v124, s44, v188
    v_mul_f32 v125, s44, v189
    v_mfma_f32_32x32x16_bf16 v[204:219], v[232:235], a[12:15], v[204:219]
    ds_read_b64_tr_b16 v[224:225], v35 offset:2048
    ds_read_b64_tr_b16 v[226:227], v35 offset:2560
    buffer_load_dwordx4 v53, s[16:19], s77 offen offset:3072  lds
    v_exp_f32 v124, v124
    s_waitcnt lgkmcnt(8)
    v_mfma_f32_32x32x16_bf16 v[204:219], v[236:239], a[16:19], v[204:219]
    ds_read_b64_tr_b16 v[228:229], v35 offset:4096
    ds_read_b64_tr_b16 v[230:231], v35 offset:4608
    v_mul_f32 v126, s44, v190
    v_exp_f32 v125, v125
    v_add_f32 v124, 1.0, v124
    v_mfma_f32_32x32x16_bf16 v[204:219], v[240:243], a[20:23], v[204:219]
    ds_read_b64_tr_b16 v[232:233], v35 offset:6144
    ds_read_b64_tr_b16 v[234:235], v35 offset:6656
    v_mul_f32 v127, s44, v191
    v_exp_f32 v126, v126
    s_waitcnt lgkmcnt(8)
    v_mfma_f32_32x32x16_bf16 v[204:219], v[244:247], a[24:27], v[204:219]
    ds_read_b64_tr_b16 v[236:237], v35 offset:8192
    ds_read_b64_tr_b16 v[238:239], v35 offset:8704
    v_add_f32 v125, 1.0, v125
    v_rcp_f32 v124, v124
    v_mul_f32 v128, s44, v192
    v_mfma_f32_32x32x16_bf16 v[204:219], v[248:251], a[28:31], v[204:219]
    ds_read_b64_tr_b16 v[240:241], v35 offset:10240
    ds_read_b64_tr_b16 v[242:243], v35 offset:10752
    v_exp_f32 v127, v127
    v_add_f32 v126, 1.0, v126
    s_waitcnt lgkmcnt(8)
    v_mfma_f32_32x32x16_bf16 v[204:219], v[220:223], a[32:35], v[204:219]
    ds_read_b64_tr_b16 v[244:245], v35 offset:12288
    ds_read_b64_tr_b16 v[246:247], v35 offset:12800
    v_rcp_f32 v125, v125
    v_mul_f32 v188, v188, v124
    v_mul_f32 v129, s44, v193
    v_mfma_f32_32x32x16_bf16 v[204:219], v[224:227], a[36:39], v[204:219]
    ds_read_b64_tr_b16 v[248:249], v35 offset:14336
    ds_read_b64_tr_b16 v[250:251], v35 offset:14848
    v_exp_f32 v128, v128
    v_add_f32 v127, 1.0, v127
    s_waitcnt lgkmcnt(8)
    v_mfma_f32_32x32x16_bf16 v[204:219], v[228:231], a[40:43], v[204:219]
    ds_read_b64_tr_b16 v[220:221], v37 offset:16384
    ds_read_b64_tr_b16 v[222:223], v37 offset:16896
    v_rcp_f32 v126, v126
    v_mul_f32 v189, v189, v125
    v_mul_f32 v130, s44, v194
    v_mfma_f32_32x32x16_bf16 v[204:219], v[232:235], a[44:47], v[204:219]
    ds_read_b64_tr_b16 v[224:225], v37 offset:18432
    ds_read_b64_tr_b16 v[226:227], v37 offset:18944
    v_exp_f32 v129, v129
    v_add_f32 v128, 1.0, v128
    s_waitcnt lgkmcnt(8)
    v_mfma_f32_32x32x16_bf16 v[204:219], v[236:239], a[48:51], v[204:219]
    ds_read_b64_tr_b16 v[228:229], v37 offset:20480
    ds_read_b64_tr_b16 v[230:231], v37 offset:20992
    buffer_load_dwordx2 v[70:71], v42, s[24:27], 0 offen sc1
    v_rcp_f32 v127, v127
    v_mul_f32 v190, v190, v126
    v_mfma_f32_32x32x16_bf16 v[204:219], v[240:243], a[52:55], v[204:219]
    ds_read_b64_tr_b16 v[232:233], v37 offset:22528
    ds_read_b64_tr_b16 v[234:235], v37 offset:23040
    v_cvt_pk_bf16_f32 v188, v188, v189
    v_mul_f32 v131, s44, v195
    s_waitcnt lgkmcnt(8)
    v_mfma_f32_32x32x16_bf16 v[204:219], v[244:247], a[56:59], v[204:219]
    ds_read_b64_tr_b16 v[236:237], v37 offset:24576
    ds_read_b64_tr_b16 v[238:239], v37 offset:25088
    v_exp_f32 v130, v130
    v_add_f32 v129, 1.0, v129
    v_mfma_f32_32x32x16_bf16 v[204:219], v[248:251], a[60:63], v[204:219]
    ds_read_b64_tr_b16 v[240:241], v37 offset:26624
    ds_read_b64_tr_b16 v[242:243], v37 offset:27136
    v_rcp_f32 v128, v128
    v_mul_f32 v191, v191, v127
    s_waitcnt lgkmcnt(8)
    v_mfma_f32_32x32x16_bf16 v[204:219], v[220:223], a[64:67], v[204:219]
    ds_read_b64_tr_b16 v[244:245], v37 offset:28672
    ds_read_b64_tr_b16 v[246:247], v37 offset:29184
    v_mul_f32 v132, s44, v196
    v_exp_f32 v131, v131
    v_add_f32 v130, 1.0, v130
    v_mfma_f32_32x32x16_bf16 v[204:219], v[224:227], a[68:71], v[204:219]
    ds_read_b64_tr_b16 v[248:249], v37 offset:30720
    ds_read_b64_tr_b16 v[250:251], v37 offset:31232
    v_rcp_f32 v129, v129
    v_mul_f32 v192, v192, v128
    s_waitcnt lgkmcnt(8)
    v_mfma_f32_32x32x16_bf16 v[204:219], v[228:231], a[72:75], v[204:219]
    ds_read_b64_tr_b16 v[220:221], v35 offset:16384
    ds_read_b64_tr_b16 v[222:223], v35 offset:16896
    v_cvt_pk_bf16_f32 v189, v190, v191
    v_mul_f32 v133, s44, v197
    v_exp_f32 v132, v132
    v_mfma_f32_32x32x16_bf16 v[204:219], v[232:235], a[76:79], v[204:219]
    ds_read_b64_tr_b16 v[224:225], v35 offset:18432
    ds_read_b64_tr_b16 v[226:227], v35 offset:18944
    v_add_f32 v131, 1.0, v131
    v_rcp_f32 v130, v130
    s_waitcnt lgkmcnt(8)
    v_mfma_f32_32x32x16_bf16 v[204:219], v[236:239], a[80:83], v[204:219]
    ds_read_b64_tr_b16 v[228:229], v35 offset:20480
    ds_read_b64_tr_b16 v[230:231], v35 offset:20992
    v_mul_f32 v193, v193, v129
    v_mul_f32 v134, s44, v198
    v_exp_f32 v133, v133
    v_mfma_f32_32x32x16_bf16 v[204:219], v[240:243], a[84:87], v[204:219]
    ds_read_b64_tr_b16 v[232:233], v35 offset:22528
    ds_read_b64_tr_b16 v[234:235], v35 offset:23040
    v_add_f32 v132, 1.0, v132
    v_rcp_f32 v131, v131
    s_waitcnt lgkmcnt(8)
    v_mfma_f32_32x32x16_bf16 v[204:219], v[244:247], a[88:91], v[204:219]
    ds_read_b64_tr_b16 v[236:237], v35 offset:24576
    ds_read_b64_tr_b16 v[238:239], v35 offset:25088
    v_mul_f32 v194, v194, v130
    v_cvt_pk_bf16_f32 v190, v192, v193
    v_mul_f32 v135, s44, v199
    v_mfma_f32_32x32x16_bf16 v[204:219], v[248:251], a[92:95], v[204:219]
    ds_read_b64_tr_b16 v[240:241], v35 offset:26624
    ds_read_b64_tr_b16 v[242:243], v35 offset:27136
    v_exp_f32 v134, v134
    v_add_f32 v133, 1.0, v133
    s_waitcnt lgkmcnt(8)
    v_mfma_f32_32x32x16_bf16 v[204:219], v[220:223], a[96:99], v[204:219]
    ds_read_b64_tr_b16 v[244:245], v35 offset:28672
    ds_read_b64_tr_b16 v[246:247], v35 offset:29184
    s_waitcnt vmcnt(0)
    v_cmp_ne_u64 vcc, v[70:71], v[72:73]
    s_cbranch_vccnz P1V_slow
P1V_back:
    ds_write_b128 v49, v[80:83]
    s_mov_b32 m0, s59
    s_nop 0
    buffer_load_dwordx4 v2, s[24:27], s70 offen sc1 lds
    v_mfma_f32_32x32x16_bf16 v[204:219], v[224:227], a[100:103], v[204:219]
    ds_read_b64_tr_b16 v[248:249], v35 offset:30720
    ds_read_b64_tr_b16 v[250:251], v35 offset:31232
    s_add_u32 s70, s70, s67
    s_add_u32 m0, s59, 1024
    s_nop 0
    buffer_load_dwordx4 v2, s[24:27], s70 offen sc1 lds
    s_waitcnt lgkmcnt(9)
    v_mfma_f32_32x32x16_bf16 v[204:219], v[228:231], a[104:107], v[204:219]
    buffer_load_dwordx4 v[84:87], v2, s[24:27], s72 offen sc1
    v_rcp_f32 v132, v132
    v_mul_f32 v195, v195, v131
    v_mul_f32 v136, s44, v200
    v_mfma_f32_32x32x16_bf16 v[204:219], v[232:235], a[108:111], v[204:219]
    s_lshl2_add_u32 s72, s67, s72
    buffer_load_dwordx4 v[88:91], v2, s[24:27], s72 offen sc1
    v_exp_f32 v135, v135
    v_add_f32 v134, 1.0, v134
    s_waitcnt lgkmcnt(5)
    v_mfma_f32_32x32x16_bf16 v[204:219], v[236:239], a[112:115], v[204:219]
    s_mov_b32 m0, s73
    s_nop 0
    buffer_load_dwordx4 v2, s[24:27], s71 offen sc1 lds
    v_rcp_f32 v133, v133
    v_mul_f32 v196, v196, v132
    v_mfma_f32_32x32x16_bf16 v[204:219], v[240:243], a[116:119], v[204:219]
    s_add_u32 s71, s71, s67
    s_add_u32 m0, s73, 1040
    s_nop 0
    buffer_load_dwordx4 v2, s[24:27], s71 offen sc1 lds
    v_cvt_pk_bf16_f32 v191, v194, v195
    s_waitcnt lgkmcnt(0)
    v_mfma_f32_32x32x16_bf16 v[204:219], v[244:247], a[120:123], v[204:219]
    v_mul_f32 v137, s44, v201
    v_exp_f32 v136, v136
    v_add_f32 v135, 1.0, v135
    v_rcp_f32 v134, v134
    v_mfma_f32_32x32x16_bf16 v[204:219], v[248:251], a[124:127], v[204:219]
    v_mul_f32 v197, v197, v133
    v_mul_f32 v138, s44, v202
    v_exp_f32 v137, v137
    v_add_f32 v136, 1.0, v136
    v_rcp_f32 v135, v135
    v_mul_f32 v198, v198, v134
    v_cvt_pk_bf16_f32 v196, v196, v197
    v_mul_f32 v139, s44, v203
    v_exp_f32 v138, v138
    v_add_f32 v137, 1.0, v137
    v_rcp_f32 v136, v136
    v_mul_f32 v199, v199, v135
    v_exp_f32 v139, v139
    v_add_f32 v138, 1.0, v138
    v_rcp_f32 v137, v137
    v_mul_f32 v200, v200, v136
    v_cvt_pk_bf16_f32 v197, v198, v199
    v_add_f32 v139, 1.0, v139
    v_rcp_f32 v138, v138
    v_mul_f32 v201, v201, v137
    v_rcp_f32 v139, v139
    v_mul_f32 v202, v202, v138
    v_cvt_pk_bf16_f32 v198, v200, v201
    v_mul_f32 v203, v203, v139
    v_cvt_pk_bf16_f32 v199, v202, v203
    s_cmp_lg_u32 s81, 0
    s_cbranch_scc1 ALT2
    buffer_store_dwordx4 v[188:191], v2, s[24:27], s66 offen offset:0 sc1
    buffer_store_dwordx4 v[196:199], v2, s[24:27], s66 offen offset:1024 sc1
ALT2_back:
    v_pk_mul_f32 v[124:125], v[204:205], s[44:45]
    v_pk_mul_f32 v[126:127], v[206:207], s[44:45]
    v_pk_mul_f32 v[128:129], v[208:209], s[44:45]
    v_pk_mul_f32 v[130:131], v[210:211], s[44:45]
    v_pk_mul_f32 v[132:133], v[212:213], s[44:45]
    v_pk_mul_f32 v[134:135], v[214:215], s[44:45]
    v_pk_mul_f32 v[136:137], v[216:217], s[44:45]
    v_pk_mul_f32 v[138:139], v[218:219], s[44:45]
    v_exp_f32 v124, v124
    v_exp_f32 v125, v125
    v_exp_f32 v126, v126
    v_exp_f32 v127, v127
    v_exp_f32 v128, v128
    v_exp_f32 v129, v129
    v_exp_f32 v130, v130
    v_exp_f32 v131, v131
    v_exp_f32 v132, v132
    v_exp_f32 v133, v133
    v_exp_f32 v134, v134
    v_exp_f32 v135, v135
    v_exp_f32 v136, v136
    v_exp_f32 v137, v137
    v_exp_f32 v138, v138
    v_exp_f32 v139, v139
    v_pk_add_f32 v[124:125], v[124:125], 1.0 op_sel_hi:[1,0]
    v_pk_add_f32 v[126:127], v[126:127], 1.0 op_sel_hi:[1,0]
    v_pk_add_f32 v[128:129], v[128:129], 1.0 op_sel_hi:[1,0]
    v_pk_add_f32 v[130:131], v[130:131], 1.0 op_sel_hi:[1,0]
    v_pk_add_f32 v[132:133], v[132:133], 1.0 op_sel_hi:[1,0]
    v_pk_add_f32 v[134:135], v[134:135], 1.0 op_sel_hi:[1,0]
    v_pk_add_f32 v[136:137], v[136:137], 1.0 op_sel_hi:[1,0]
    v_pk_add_f32 v[138:139], v[138:139], 1.0 op_sel_hi:[1,0]
    v_rcp_f32 v124, v124
    v_rcp_f32 v125, v125
    v_rcp_f32 v126, v126
    v_rcp_f32 v127, v127
    v_rcp_f32 v128, v128
    v_rcp_f32 v129, v129
    v_rcp_f32 v130, v130
    v_rcp_f32 v131, v131
    v_rcp_f32 v132, v132
    v_rcp_f32 v133, v133
    v_rcp_f32 v134, v134
    v_rcp_f32 v135, v135
    v_rcp_f32 v136, v136
    v_rcp_f32 v137, v137
    v_rcp_f32 v138, v138
    v_rcp_f32 v139, v139
    v_pk_mul_f32 v[204:205], v[204:205], v[124:125]
    v_pk_mul_f32 v[206:207], v[206:207], v[126:127]
    v_pk_mul_f32 v[208:209], v[208:209], v[128:129]
    v_pk_mul_f32 v[210:211], v[210:211], v[130:131]
    v_pk_mul_f32 v[212:213], v[212:213], v[132:133]
    v_pk_mul_f32 v[214:215], v[214:215], v[134:135]
    v_pk_mul_f32 v[216:217], v[216:217], v[136:137]
    v_pk_mul_f32 v[218:219], v[218:219], v[138:139]
    v_cvt_pk_bf16_f32 v204, v204, v205
    v_cvt_pk_bf16_f32 v205, v206, v207
    v_cvt_pk_bf16_f32 v206, v208, v209
    v_cvt_pk_bf16_f32 v207, v210, v211
    v_cvt_pk_bf16_f32 v212, v212, v213
    v_cvt_pk_bf16_f32 v213, v214, v215
    v_cvt_pk_bf16_f32 v214, v216, v217
    v_cvt_pk_bf16_f32 v215, v218, v219
    s_cmp_lg_u32 s81, 0
    s_cbranch_scc1 ALT3
    buffer_store_dwordx4 v[204:207], v2, s[24:27], s66 offen offset:2048 sc1
    buffer_store_dwordx4 v[212:215], v2, s[24:27], s66 offen offset:3072 sc1
ALT3_back:
    buffer_load_dwordx2 v[70:71], v43, s[24:27], 0 offen sc1
    s_waitcnt vmcnt(5)
    s_waitcnt lgkmcnt(0)
    s_branch JOIN
    .p2align 3
VAR_C:
    v_lshlrev_b32 v2, 4, v1
    v_and_b32 v4, 31, v1
    v_lshrrev_b32 v5, 5, v1
    v_bfe_u32 v6, v1, 1, 3
    v_xor_b32 v6, v6, v5
    v_lshlrev_b32 v6, 4, v6
    v_lshl_add_u32 v6, v4, 7, v6
    v_add_u32 v22, s58, v6
    v_xor_b32 v23, 32, v22
    v_xor_b32 v24, 64, v22
    v_xor_b32 v25, 96, v22
    v_add_u32 v26, 114688, v22
    v_add_u32 v27, 114688, v23
    v_add_u32 v28, 114688, v24
    v_add_u32 v29, 114688, v25
    v_bfe_u32 v6, v1, 2, 2
    v_bfe_u32 v7, v1, 4, 1
    v_and_b32 v8, 3, v1
    v_lshlrev_b32 v8, 3, v8
    v_lshl_add_u32 v8, v7, 5, v8
    v_lshl_add_u32 v9, v5, 3, v6
    v_lshl_add_u32 v10, v9, 2, v6
    v_lshl_add_u32 v10, v10, 6, v8
    v_add_u32 v30, 49152, v10
    v_xor_b32 v31, 64, v30
    v_xor_b32 v32, 128, v30
    v_xor_b32 v33, 192, v30
    s_lshl_b32 s59, s46, 11
    s_lshl_b32 s60, s46, 10
    v_mov_b32 v9, 0x40000000
    v_cmp_eq_u32 vcc, 63, v1
    s_getreg_b32 s83, hwreg(HW_REG_XCC_ID)
    s_mov_b32 s81, 0
    v_cndmask_b32 v41, v9, 0, vcc
    v_lshl_add_u32 v9, v5, 3, v6
    s_and_b32 s84, s2, 7
    s_lshl_b32 s84, s84, 5
    s_add_u32 s84, s84, s48
    s_lshl3_add_u32 s84, s84, 0xe4c000
    s_mov_b32 s34, 0x100
    s_mov_b32 s35, s7
    s_mov_b32 s38, 0x400
    s_mov_b32 s39, s7
    s_mov_b32 s14, 0x158000
    s_mov_b32 s15, s7
    s_mov_b32 s30, 0x200000
    s_mov_b32 s31, s7
    v_lshrrev_b32 v10, 1, v6
    v_lshl_add_u32 v10, v9, 1, v10
    v_lshl_add_u32 v10, v10, 6, v8
    v_add_u32 v34, 49152, v10
    v_xor_b32 v35, 64, v34
    v_lshl_add_u32 v10, v9, 6, v8
    v_add_u32 v40, 131072, v10
    v_lshlrev_b32 v10, 2, v7
    v_xor_b32 v10, v10, v1
    v_and_b32 v10, 7, v10
    v_lshlrev_b32 v10, 4, v10
    v_lshrrev_b32 v11, 3, v1
    v_lshl_add_u32 v50, v11, 10, v10
    s_lshl_b32 s52, s46, 4
    v_add_u32 v11, s52, v11
    s_mul_i32 s53, s51, 3
    s_add_u32 s53, s53, s50
    s_mul_i32 s54, s47, 5
    s_add_u32 s53, s53, s54
    s_lshl_b32 s54, s53, 7
    v_add_u32 v10, s54, v10
    s_movk_i32 s55, 2752
    v_mad_u32_u24 v20, v11, s55, v10
    v_lshrrev_b32 v11, 2, v1
    v_add_u32 v11, s52, v11
    v_and_b32 v10, 3, v1
    s_bfe_u32 s56, s57, 0x30004
    s_lshl_b32 s62, s56, 7
    s_mul_i32 s63, s56, s61
    s_add_u32 m0, s58, 65536
    s_nop 0
    buffer_load_dwordx4 v16, s[8:11], s63 offen offset:0  lds
    buffer_load_dwordx4 v17, s[8:11], s63 offen offset:1024  lds
    buffer_load_dwordx4 v18, s[8:11], s63 offen offset:2048  lds
    buffer_load_dwordx4 v19, s[8:11], s63 offen offset:3072  lds
    s_add_u32 m0, s58, 16384
    s_nop 0
    buffer_load_dwordx4 v12, s[4:7], s62 offen offset:0  lds
    buffer_load_dwordx4 v13, s[4:7], s62 offen offset:1024  lds
    buffer_load_dwordx4 v14, s[4:7], s62 offen offset:2048  lds
    buffer_load_dwordx4 v15, s[4:7], s62 offen offset:3072  lds
    s_waitcnt vmcnt(11)
    s_waitcnt lgkmcnt(0)
    s_barrier
    ds_read_b128 a[0:3], v22 offset:0
    ds_read_b64_tr_b16 v[220:221], v30 offset:0
    ds_read_b64_tr_b16 v[222:223], v30 offset:1024
    ds_read_b64_tr_b16 v[224:225], v31 offset:0
    ds_read_b64_tr_b16 v[226:227], v31 offset:1024
    ds_read_b64_tr_b16 v[228:229], v32 offset:0
    ds_read_b64_tr_b16 v[230:231], v32 offset:1024
    ds_read_b64_tr_b16 v[232:233], v33 offset:0
    ds_read_b64_tr_b16 v[234:235], v33 offset:1024
    ds_read_b128 a[4:7], v23 offset:0
    ds_read_b64_tr_b16 v[236:237], v30 offset:4096
    ds_read_b64_tr_b16 v[238:239], v30 offset:5120
    ds_read_b64_tr_b16 v[240:241], v31 offset:4096
    ds_read_b64_tr_b16 v[242:243], v31 offset:5120
    .p2align 3
    s_waitcnt lgkmcnt(9)
    v_mfma_f32_32x32x16_bf16 v[124:139], v[220:223], a[0:3], 0
    ds_read_b64_tr_b16 v[244:245], v32 offset:4096
    ds_read_b64_tr_b16 v[246:247], v32 offset:5120
    s_bfe_u32 s56, s57, 0x30008
    s_lshl_b32 s62, s56, 7
    s_mul_i32 s63, s56, s61
    s_add_u32 m0, s58, 81920
    s_nop 0
    buffer_load_dwordx4 v16, s[8:11], s63 offen offset:0  lds
    s_mul_i32 s54, s51, 320
    v_mfma_f32_32x32x16_bf16 v[140:155], v[224:227], a[0:3], 0
    ds_read_b64_tr_b16 v[248:249], v33 offset:4096
    ds_read_b64_tr_b16 v[250:251], v33 offset:5120
    buffer_load_dwordx4 v17, s[8:11], s63 offen offset:1024  lds
    s_mul_i32 s52, s47, 768
    s_waitcnt lgkmcnt(9)
    v_mfma_f32_32x32x16_bf16 v[156:171], v[228:231], a[0:3], 0
    ds_read_b128 a[8:11], v24 offset:0
    ds_read_b64_tr_b16 v[220:221], v30 offset:8192
    ds_read_b64_tr_b16 v[222:223], v30 offset:9216
    buffer_load_dwordx4 v18, s[8:11], s63 offen offset:2048  lds
    s_addk_i32 s54, 1024
    v_mfma_f32_32x32x16_bf16 v[172:187], v[232:235], a[0:3], 0
    ds_read_b64_tr_b16 v[224:225], v31 offset:8192
    ds_read_b64_tr_b16 v[226:227], v31 offset:9216
    buffer_load_dwordx4 v19, s[8:11], s63 offen offset:3072  lds
    s_add_u32 s54, s54, s52
    s_waitcnt lgkmcnt(9)
    v_mfma_f32_32x32x16_bf16 v[124:139], v[236:239], a[4:7], v[124:139]
    ds_read_b64_tr_b16 v[228:229], v32 offset:8192
    ds_read_b64_tr_b16 v[230:231], v32 offset:9216
    v_lshl_add_u32 v10, v10, 4, s54
    v_mad_u32_u24 v21, v11, s55, v10
    v_mov_b32 v20, v21
    v_mov_b32 v34, v40
    v_mfma_f32_32x32x16_bf16 v[140:155], v[240:243], a[4:7], v[140:155]
    ds_read_b64_tr_b16 v[232:233], v33 offset:8192
    ds_read_b64_tr_b16 v[234:235], v33 offset:9216
    s_add_u32 m0, s58, 114688
    s_nop 0
    buffer_load_dwordx4 v12, s[4:7], s62 offen offset:0  lds
    s_lshl_b32 s53, s53, 1
    s_waitcnt lgkmcnt(9)
    v_mfma_f32_32x32x16_bf16 v[156:171], v[244:247], a[4:7], v[156:171]
    ds_read_b128 a[12:15], v25 offset:0
    ds_read_b64_tr_b16 v[236:237], v30 offset:12288
    ds_read_b64_tr_b16 v[238:239], v30 offset:13312
    buffer_load_dwordx4 v13, s[4:7], s62 offen offset:1024  lds
    s_mul_i32 s54, s51, 5
    v_mfma_f32_32x32x16_bf16 v[172:187], v[248:251], a[4:7], v[172:187]
    ds_read_b64_tr_b16 v[240:241], v31 offset:12288
    ds_read_b64_tr_b16 v[242:243], v31 offset:13312
    buffer_load_dwordx4 v14, s[4:7], s62 offen offset:2048  lds
    s_mul_i32 s55, s47, 12
    s_waitcnt lgkmcnt(9)
    v_mfma_f32_32x32x16_bf16 v[124:139], v[220:223], a[8:11], v[124:139]
    ds_read_b64_tr_b16 v[244:245], v32 offset:12288
    ds_read_b64_tr_b16 v[246:247], v32 offset:13312
    buffer_load_dwordx4 v15, s[4:7], s62 offen offset:3072  lds
    s_add_u32 s54, s54, s55
    v_mfma_f32_32x32x16_bf16 v[140:155], v[224:227], a[8:11], v[140:155]
    ds_read_b64_tr_b16 v[248:249], v33 offset:12288
    ds_read_b64_tr_b16 v[250:251], v33 offset:13312
    s_add_u32 s54, s54, 12
    s_cmp_eq_u32 s50, 3
    s_cselect_b32 s53, s54, s53
    s_waitcnt lgkmcnt(9)
    v_mfma_f32_32x32x16_bf16 v[156:171], v[228:231], a[8:11], v[156:171]
    s_waitcnt vmcnt(8)
    s_barrier
    ds_read_b128 a[16:19], v22 offset:16384
    ds_read_b64_tr_b16 v[220:221], v30 offset:16384
    ds_read_b64_tr_b16 v[222:223], v30 offset:17408
    s_bfe_u32 s56, s57, 0x3000c
    s_lshl_b32 s62, s56, 7
    s_mul_i32 s63, s56, s61
    s_add_u32 m0, s58, 98304
    s_nop 0
    buffer_load_dwordx4 v16, s[8:11], s63 offen offset:0  lds
    s_lshl2_add_u32 s40, s49, s46
    v_mfma_f32_32x32x16_bf16 v[172:187], v[232:235], a[8:11], v[172:187]
    ds_read_b64_tr_b16 v[224:225], v31 offset:16384
    ds_read_b64_tr_b16 v[226:227], v31 offset:17408
    v_add_u32 v72, 1, v70
    v_mov_b32 v73, v71
    v_mov_b32 v74, 1
    v_mov_b32 v75, 0
    buffer_store_dwordx4 v[72:75], v41, s[32:35], s90 offen sc1
    buffer_store_dwordx2 v[72:73], v41, s[24:27], s91 offen sc1
    s_mul_i32 s54, s40, 44
    s_waitcnt lgkmcnt(9)
    v_mfma_f32_32x32x16_bf16 v[124:139], v[236:239], a[12:15], v[124:139]
    ds_read_b64_tr_b16 v[228:229], v32 offset:16384
    ds_read_b64_tr_b16 v[230:231], v32 offset:17408
    buffer_load_dwordx4 v17, s[8:11], s63 offen offset:1024  lds
    s_add_u32 s53, s53, s54
    v_mfma_f32_32x32x16_bf16 v[140:155], v[240:243], a[12:15], v[140:155]
    ds_read_b64_tr_b16 v[232:233], v33 offset:16384
    ds_read_b64_tr_b16 v[234:235], v33 offset:17408
    s_lshl_b32 s53, s53, 11
    s_add_u32 s66, s53, 0x600000
    s_waitcnt lgkmcnt(9)
    v_mfma_f32_32x32x16_bf16 v[156:171], v[244:247], a[12:15], v[156:171]
    ds_read_b128 a[20:23], v23 offset:16384
    ds_read_b64_tr_b16 v[236:237], v30 offset:20480
    ds_read_b64_tr_b16 v[238:239], v30 offset:21504
    buffer_load_dwordx4 v18, s[8:11], s63 offen offset:2048  lds
    buffer_load_dword v55, v78, s[16:19], 0 offen
    s_lshl_b32 s67, s40, 9
    v_mfma_f32_32x32x16_bf16 v[172:187], v[248:251], a[12:15], v[172:187]
    ds_read_b64_tr_b16 v[240:241], v31 offset:20480
    ds_read_b64_tr_b16 v[242:243], v31 offset:21504
    s_add_u32 s67, s67, 0xe00000
    s_lshl_b32 s54, s50, 21
    s_waitcnt lgkmcnt(9)
    v_mfma_f32_32x32x16_bf16 v[124:139], v[220:223], a[16:19], v[124:139]
    ds_read_b64_tr_b16 v[244:245], v32 offset:20480
    ds_read_b64_tr_b16 v[246:247], v32 offset:21504
    buffer_load_dwordx4 v19, s[8:11], s63 offen offset:3072  lds
    s_lshl_b32 s55, s51, 19
    v_mfma_f32_32x32x16_bf16 v[140:155], v[224:227], a[16:19], v[140:155]
    ds_read_b64_tr_b16 v[248:249], v33 offset:20480
    ds_read_b64_tr_b16 v[250:251], v33 offset:21504
    s_add_u32 s54, s54, s55
    s_lshl_b32 s55, s40, 10
    s_waitcnt lgkmcnt(9)
    v_mfma_f32_32x32x16_bf16 v[156:171], v[228:231], a[16:19], v[156:171]
    ds_read_b128 a[24:27], v24 offset:16384
    ds_read_b64_tr_b16 v[220:221], v30 offset:24576
    ds_read_b64_tr_b16 v[222:223], v30 offset:25600
    s_add_u32 m0, s58, 32768
    s_nop 0
    buffer_load_dwordx4 v12, s[4:7], s62 offen offset:0  lds
    s_add_u32 s65, s54, s55
    v_mfma_f32_32x32x16_bf16 v[172:187], v[232:235], a[16:19], v[172:187]
    ds_read_b64_tr_b16 v[224:225], v31 offset:24576
    ds_read_b64_tr_b16 v[226:227], v31 offset:25600
    s_mov_b32 s42, 0x3eb8aa3b
    s_cmp_eq_u32 s50, 0
    s_cselect_b32 s42, s42, 1.0
    s_waitcnt lgkmcnt(9)
    v_mfma_f32_32x32x16_bf16 v[124:139], v[236:239], a[20:23], v[124:139]
    ds_read_b64_tr_b16 v[228:229], v32 offset:24576
    ds_read_b64_tr_b16 v[230:231], v32 offset:25600
    buffer_load_dwordx4 v13, s[4:7], s62 offen offset:1024  lds
    s_mov_b32 s43, s42
    v_mfma_f32_32x32x16_bf16 v[140:155], v[240:243], a[20:23], v[140:155]
    ds_read_b64_tr_b16 v[232:233], v33 offset:24576
    ds_read_b64_tr_b16 v[234:235], v33 offset:25600
    s_mov_b32 s44, 0xbfb8aa3b
    s_mov_b32 s45, s44
    s_waitcnt lgkmcnt(9)
    v_mfma_f32_32x32x16_bf16 v[156:171], v[244:247], a[20:23], v[156:171]
    ds_read_b128 a[28:31], v25 offset:16384
    ds_read_b64_tr_b16 v[236:237], v30 offset:28672
    ds_read_b64_tr_b16 v[238:239], v30 offset:29696
    buffer_load_dwordx4 v14, s[4:7], s62 offen offset:2048  lds
    s_and_b32 s54, s49, 3
    v_mfma_f32_32x32x16_bf16 v[172:187], v[248:251], a[20:23], v[172:187]
    ds_read_b64_tr_b16 v[240:241], v31 offset:28672
    ds_read_b64_tr_b16 v[242:243], v31 offset:29696
    s_lshr_b32 s54, s54, 1
    s_add_u32 s55, s50, 1
    s_waitcnt lgkmcnt(9)
    v_mfma_f32_32x32x16_bf16 v[124:139], v[220:223], a[24:27], v[124:139]
    ds_read_b64_tr_b16 v[244:245], v32 offset:28672
    ds_read_b64_tr_b16 v[246:247], v32 offset:29696
    buffer_load_dwordx4 v15, s[4:7], s62 offen offset:3072  lds
    s_bfe_u32 s55, s55, 0x10001
    v_mfma_f32_32x32x16_bf16 v[140:155], v[224:227], a[24:27], v[140:155]
    ds_read_b64_tr_b16 v[248:249], v33 offset:28672
    ds_read_b64_tr_b16 v[250:251], v33 offset:29696
    s_and_b32 s54, s54, s55
    s_cmp_lt_u32 s49, 12
    s_cselect_b32 s82, s54, 0
    s_waitcnt lgkmcnt(9)
    v_mfma_f32_32x32x16_bf16 v[156:171], v[228:231], a[24:27], v[156:171]
    s_waitcnt vmcnt(11)
    s_barrier
    ds_read_b128 a[32:35], v26
    ds_read_b64_tr_b16 v[220:221], v30 offset:32768
    ds_read_b64_tr_b16 v[222:223], v30 offset:33792
    s_bfe_u32 s56, s57, 0x30010
    s_lshl_b32 s62, s56, 7
    s_mul_i32 s63, s56, s61
    s_add_u32 m0, s58, 49152
    s_nop 0
    buffer_load_dwordx4 v16, s[8:11], s63 offen offset:0  lds
    s_and_b32 s54, s48, 7
    v_mfma_f32_32x32x16_bf16 v[172:187], v[232:235], a[24:27], v[172:187]
    ds_read_b64_tr_b16 v[224:225], v31 offset:32768
    ds_read_b64_tr_b16 v[226:227], v31 offset:33792
    s_lshl_b32 s55, s54, 7
    v_add_u32 v50, s55, v50
    s_waitcnt lgkmcnt(9)
    v_mfma_f32_32x32x16_bf16 v[124:139], v[236:239], a[28:31], v[124:139]
    ds_read_b64_tr_b16 v[228:229], v32 offset:32768
    ds_read_b64_tr_b16 v[230:231], v32 offset:33792
    buffer_load_dwordx4 v17, s[8:11], s63 offen offset:1024  lds
    s_lshl_b32 s55, s49, 1
    v_mfma_f32_32x32x16_bf16 v[140:155], v[240:243], a[28:31], v[140:155]
    ds_read_b64_tr_b16 v[232:233], v33 offset:32768
    ds_read_b64_tr_b16 v[234:235], v33 offset:33792
    s_xor_b32 s55, s55, s54
    s_and_b32 s76, s55, 7
    s_waitcnt lgkmcnt(9)
    v_mfma_f32_32x32x16_bf16 v[156:171], v[244:247], a[28:31], v[156:171]
    ds_read_b128 a[36:39], v27
    ds_read_b64_tr_b16 v[236:237], v30 offset:36864
    ds_read_b64_tr_b16 v[238:239], v30 offset:37888
    buffer_load_dwordx4 v18, s[8:11], s63 offen offset:2048  lds
    s_and_b32 s55, s76, 0
    v_mfma_f32_32x32x16_bf16 v[172:187], v[248:251], a[28:31], v[172:187]
    ds_read_b64_tr_b16 v[240:241], v31 offset:36864
    ds_read_b64_tr_b16 v[242:243], v31 offset:37888
    s_lshl_b32 s75, s55, 12
    s_lshl_b32 s55, s55, 1
    s_waitcnt lgkmcnt(9)
    v_mfma_f32_32x32x16_bf16 v[124:139], v[220:223], a[32:35], v[124:139]
    ds_read_b64_tr_b16 v[244:245], v32 offset:36864
    ds_read_b64_tr_b16 v[246:247], v32 offset:37888
    buffer_load_dwordx4 v19, s[8:11], s63 offen offset:3072  lds
    s_xor_b32 s55, s55, s46
    v_mfma_f32_32x32x16_bf16 v[140:155], v[224:227], a[32:35], v[140:155]
    ds_read_b64_tr_b16 v[248:249], v33 offset:36864
    ds_read_b64_tr_b16 v[250:251], v33 offset:37888
    s_lshl_b32 s77, s55, 15
    s_and_b32 s76, s76, 0
    s_waitcnt lgkmcnt(9)
    v_mfma_f32_32x32x16_bf16 v[156:171], v[228:231], a[32:35], v[156:171]
    ds_read_b128 a[40:43], v28
    ds_read_b64_tr_b16 v[220:221], v30 offset:40960
    ds_read_b64_tr_b16 v[222:223], v30 offset:41984
    s_mov_b32 m0, s58
    s_nop 0
    buffer_load_dwordx4 v12, s[4:7], s62 offen offset:0  lds
    v_add_u32 v51, 7168, v50
    v_mfma_f32_32x32x16_bf16 v[172:187], v[232:235], a[32:35], v[172:187]
    ds_read_b64_tr_b16 v[224:225], v31 offset:40960
    ds_read_b64_tr_b16 v[226:227], v31 offset:41984
    v_add_u32 v52, 7168, v51
    v_add_u32 v53, 7168, v52
    s_waitcnt lgkmcnt(9)
    v_mfma_f32_32x32x16_bf16 v[124:139], v[236:239], a[36:39], v[124:139]
    ds_read_b64_tr_b16 v[228:229], v32 offset:40960
    ds_read_b64_tr_b16 v[230:231], v32 offset:41984
    buffer_load_dwordx4 v13, s[4:7], s62 offen offset:1024  lds
    s_lshl2_add_u32 s52, s49, s51
    v_mfma_f32_32x32x16_bf16 v[140:155], v[240:243], a[36:39], v[140:155]
    ds_read_b64_tr_b16 v[232:233], v33 offset:40960
    ds_read_b64_tr_b16 v[234:235], v33 offset:41984
    s_lshl_b32 s52, s52, 4
    s_add_u32 s52, s52, s46
    s_waitcnt lgkmcnt(9)
    v_mfma_f32_32x32x16_bf16 v[156:171], v[244:247], a[36:39], v[156:171]
    ds_read_b128 a[44:47], v29
    ds_read_b64_tr_b16 v[236:237], v30 offset:45056
    ds_read_b64_tr_b16 v[238:239], v30 offset:46080
    buffer_load_dwordx4 v14, s[4:7], s62 offen offset:2048  lds
    s_lshl_b32 s53, s50, 2
    v_mfma_f32_32x32x16_bf16 v[172:187], v[248:251], a[36:39], v[172:187]
    ds_read_b64_tr_b16 v[240:241], v31 offset:45056
    ds_read_b64_tr_b16 v[242:243], v31 offset:46080
    s_add_u32 s53, s53, 1020
    s_cmp_eq_u32 s50, 0
    s_cselect_b32 s53, 0, s53
    s_waitcnt lgkmcnt(9)
    v_mfma_f32_32x32x16_bf16 v[124:139], v[220:223], a[40:43], v[124:139]
    ds_read_b64_tr_b16 v[244:245], v32 offset:45056
    ds_read_b64_tr_b16 v[246:247], v32 offset:46080
    buffer_load_dwordx4 v15, s[4:7], s62 offen offset:3072  lds
    s_add_u32 s52, s52, s53
    v_mfma_f32_32x32x16_bf16 v[140:155], v[224:227], a[40:43], v[140:155]
    ds_read_b64_tr_b16 v[248:249], v33 offset:45056
    ds_read_b64_tr_b16 v[250:251], v33 offset:46080
    s_lshl3_add_u32 s68, s52, 0xe40000
    s_lshl1_add_u32 s52, s40, s47
    s_waitcnt lgkmcnt(9)
    v_mfma_f32_32x32x16_bf16 v[156:171], v[228:231], a[40:43], v[156:171]
    s_waitcnt vmcnt(8)
    s_barrier
    ds_read_b128 a[48:51], v22 offset:32768
    ds_read_b64_tr_b16 v[220:221], v30 offset:49152
    ds_read_b64_tr_b16 v[222:223], v30 offset:50176
    s_bfe_u32 s56, s57, 0x30014
    s_lshl_b32 s62, s56, 7
    s_mul_i32 s63, s56, s61
    s_add_u32 m0, s58, 65536
    s_nop 0
    buffer_load_dwordx4 v16, s[8:11], s63 offen offset:0  lds
    s_lshl_b32 s52, s52, 7
    v_mfma_f32_32x32x16_bf16 v[172:187], v[232:235], a[40:43], v[172:187]
    ds_read_b64_tr_b16 v[224:225], v31 offset:49152
    ds_read_b64_tr_b16 v[226:227], v31 offset:50176
    buffer_load_dwordx4 v17, s[8:11], s63 offen offset:1024  lds
    buffer_load_dwordx4 v[72:75], off, s[32:35], 0 sc1
    s_add_u32 s52, s52, 0xe44000
    s_waitcnt lgkmcnt(9)
    v_mfma_f32_32x32x16_bf16 v[124:139], v[236:239], a[44:47], v[124:139]
    ds_read_b64_tr_b16 v[228:229], v32 offset:49152
    ds_read_b64_tr_b16 v[230:231], v32 offset:50176
    buffer_load_dwordx4 v18, s[8:11], s63 offen offset:2048  lds
    s_lshl2_add_u32 s80, s54, s52
    v_mfma_f32_32x32x16_bf16 v[140:155], v[240:243], a[44:47], v[140:155]
    ds_read_b64_tr_b16 v[232:233], v33 offset:49152
    ds_read_b64_tr_b16 v[234:235], v33 offset:50176
    buffer_load_dwordx4 v19, s[8:11], s63 offen offset:3072  lds
    v_and_b32 v9, 7, v1
    s_waitcnt lgkmcnt(9)
    v_mfma_f32_32x32x16_bf16 v[156:171], v[244:247], a[44:47], v[156:171]
    ds_read_b128 a[52:55], v23 offset:32768
    ds_read_b64_tr_b16 v[236:237], v30 offset:53248
    ds_read_b64_tr_b16 v[238:239], v30 offset:54272
    s_add_u32 m0, s58, 16384
    s_nop 0
    buffer_load_dwordx4 v12, s[4:7], s62 offen offset:0  lds
    v_lshl_add_u32 v44, v9, 2, s52
    v_mfma_f32_32x32x16_bf16 v[172:187], v[248:251], a[44:47], v[172:187]
    ds_read_b64_tr_b16 v[240:241], v31 offset:53248
    ds_read_b64_tr_b16 v[242:243], v31 offset:54272
    buffer_load_dwordx4 v13, s[4:7], s62 offen offset:1024  lds
    s_and_b32 s52, s40, -8
    s_waitcnt lgkmcnt(9)
    v_mfma_f32_32x32x16_bf16 v[124:139], v[220:223], a[48:51], v[124:139]
    ds_read_b64_tr_b16 v[244:245], v32 offset:53248
    ds_read_b64_tr_b16 v[246:247], v32 offset:54272
    buffer_load_dwordx4 v14, s[4:7], s62 offen offset:2048  lds
    s_lshl1_add_u32 s52, s46, s52
    v_mfma_f32_32x32x16_bf16 v[140:155], v[224:227], a[48:51], v[140:155]
    ds_read_b64_tr_b16 v[248:249], v33 offset:53248
    ds_read_b64_tr_b16 v[250:251], v33 offset:54272
    buffer_load_dwordx4 v15, s[4:7], s62 offen offset:3072  lds
    s_add_u32 s52, s52, s47
    s_waitcnt lgkmcnt(9)
    v_mfma_f32_32x32x16_bf16 v[156:171], v[228:231], a[48:51], v[156:171]
    ds_read_b128 a[56:59], v24 offset:32768
    ds_read_b64_tr_b16 v[220:221], v30 offset:57344
    ds_read_b64_tr_b16 v[222:223], v30 offset:58368
    s_bfe_u32 s56, s57, 0x30018
    s_lshl_b32 s62, s56, 7
    s_mul_i32 s63, s56, s61
    s_add_u32 m0, s58, 114688
    s_nop 0
    buffer_load_dwordx4 v12, s[4:7], s62 offen offset:0  lds
    s_lshl_b32 s52, s52, 7
    v_mfma_f32_32x32x16_bf16 v[172:187], v[232:235], a[48:51], v[172:187]
    ds_read_b64_tr_b16 v[224:225], v31 offset:57344
    ds_read_b64_tr_b16 v[226:227], v31 offset:58368
    buffer_load_dwordx4 v13, s[4:7], s62 offen offset:1024  lds
    s_add_u32 s52, s52, 0xe48000
    s_waitcnt lgkmcnt(9)
    v_mfma_f32_32x32x16_bf16 v[124:139], v[236:239], a[52:55], v[124:139]
    ds_read_b64_tr_b16 v[228:229], v32 offset:57344
    ds_read_b64_tr_b16 v[230:231], v32 offset:58368
    buffer_load_dwordx4 v14, s[4:7], s62 offen offset:2048  lds
    v_and_b32 v10, 15, v1
    v_mfma_f32_32x32x16_bf16 v[140:155], v[240:243], a[52:55], v[140:155]
    ds_read_b64_tr_b16 v[232:233], v33 offset:57344
    ds_read_b64_tr_b16 v[234:235], v33 offset:58368
    buffer_load_dwordx4 v15, s[4:7], s62 offen offset:3072  lds
    v_lshl_add_u32 v45, v10, 2, s52
    s_waitcnt lgkmcnt(9)
    v_mfma_f32_32x32x16_bf16 v[156:171], v[244:247], a[52:55], v[156:171]
    ds_read_b128 a[60:63], v25 offset:32768
    ds_read_b64_tr_b16 v[236:237], v30 offset:61440
    ds_read_b64_tr_b16 v[238:239], v30 offset:62464
    s_add_u32 m0, s58, 81920
    s_nop 0
    buffer_load_dwordx4 v16, s[8:11], s63 offen offset:0  lds
    s_lshl1_add_u32 s52, s40, s47
    v_mfma_f32_32x32x16_bf16 v[172:187], v[248:251], a[52:55], v[172:187]
    ds_read_b64_tr_b16 v[240:241], v31 offset:61440
    ds_read_b64_tr_b16 v[242:243], v31 offset:62464
    buffer_load_dwordx4 v17, s[8:11], s63 offen offset:1024  lds
    s_mul_i32 s53, s52, 45056
    s_waitcnt lgkmcnt(9)
    v_mfma_f32_32x32x16_bf16 v[124:139], v[220:223], a[56:59], v[124:139]
    ds_read_b64_tr_b16 v[244:245], v32 offset:61440
    ds_read_b64_tr_b16 v[246:247], v32 offset:62464
    buffer_load_dwordx4 v18, s[8:11], s63 offen offset:2048  lds
    s_add_u32 s53, s53, 0x600000
    v_mfma_f32_32x32x16_bf16 v[140:155], v[224:227], a[56:59], v[140:155]
    ds_read_b64_tr_b16 v[248:249], v33 offset:61440
    ds_read_b64_tr_b16 v[250:251], v33 offset:62464
    buffer_load_dwordx4 v19, s[8:11], s63 offen offset:3072  lds
    v_add_u32 v64, s53, v2
    s_waitcnt lgkmcnt(9)
    v_mfma_f32_32x32x16_bf16 v[156:171], v[228:231], a[56:59], v[156:171]
    s_waitcnt vmcnt(17)
    s_barrier
    ds_read_b128 a[64:67], v22 offset:0
    ds_read_b64_tr_b16 v[220:221], v30 offset:0
    ds_read_b64_tr_b16 v[222:223], v30 offset:1024
    s_bfe_u32 s56, s57, 0x3001c
    s_lshl_b32 s62, s56, 7
    s_mul_i32 s63, s56, s61
    s_add_u32 m0, s58, 32768
    s_nop 0
    buffer_load_dwordx4 v12, s[4:7], s62 offen offset:0  lds
    s_lshl3_add_u32 s52, s52, s76
    v_mfma_f32_32x32x16_bf16 v[172:187], v[232:235], a[56:59], v[172:187]
    ds_read_b64_tr_b16 v[224:225], v31 offset:0
    ds_read_b64_tr_b16 v[226:227], v31 offset:1024
    s_waitcnt vmcnt(15)
    v_cmp_eq_u32 vcc, 0, v74
    s_cbranch_vccnz TAGC_slow
TAGC_back:
    v_mov_b32 v68, v72
    v_add_u32 v69, s83, v73
    buffer_store_dwordx2 v[68:69], v41, s[24:27], s84 offen
    s_lshl_b32 s52, s52, 11
    s_waitcnt lgkmcnt(9)
    v_mfma_f32_32x32x16_bf16 v[124:139], v[236:239], a[60:63], v[124:139]
    ds_read_b64_tr_b16 v[228:229], v32 offset:0
    ds_read_b64_tr_b16 v[230:231], v32 offset:1024
    buffer_load_dwordx4 v13, s[4:7], s62 offen offset:1024  lds
    s_add_u32 s78, s52, 0xc00000
    v_mfma_f32_32x32x16_bf16 v[140:155], v[240:243], a[60:63], v[140:155]
    ds_read_b64_tr_b16 v[232:233], v33 offset:0
    ds_read_b64_tr_b16 v[234:235], v33 offset:1024
    v_lshl_add_u32 v62, v4, 4, s67
    s_lshl_b32 s52, s40, 8
    s_waitcnt lgkmcnt(9)
    v_mfma_f32_32x32x16_bf16 v[156:171], v[244:247], a[60:63], v[156:171]
    ds_read_b128 a[68:71], v23 offset:0
    ds_read_b64_tr_b16 v[236:237], v30 offset:4096
    ds_read_b64_tr_b16 v[238:239], v30 offset:5120
    buffer_load_dwordx4 v14, s[4:7], s62 offen offset:2048  lds
    s_lshl1_add_u32 s53, s54, s47
    v_mfma_f32_32x32x16_bf16 v[172:187], v[248:251], a[60:63], v[172:187]
    ds_read_b64_tr_b16 v[240:241], v31 offset:4096
    ds_read_b64_tr_b16 v[242:243], v31 offset:5120
    s_add_u32 s52, s52, s54
    s_lshl1_add_u32 s52, s52, s47
    s_waitcnt lgkmcnt(9)
    v_mfma_f32_32x32x16_bf16 v[124:139], v[220:223], a[64:67], v[124:139]
    ds_read_b64_tr_b16 v[244:245], v32 offset:4096
    ds_read_b64_tr_b16 v[246:247], v32 offset:5120
    buffer_load_dwordx4 v15, s[4:7], s62 offen offset:3072  lds
    s_lshl_b32 s52, s52, 6
    v_mfma_f32_32x32x16_bf16 v[140:155], v[224:227], a[64:67], v[140:155]
    ds_read_b64_tr_b16 v[248:249], v33 offset:4096
    ds_read_b64_tr_b16 v[250:251], v33 offset:5120
    v_and_b32 v63, 3, v1
    v_lshl_add_u32 v63, v63, 4, s52
    s_waitcnt lgkmcnt(9)
    v_mfma_f32_32x32x16_bf16 v[156:171], v[228:231], a[64:67], v[156:171]
    ds_read_b128 a[72:75], v24 offset:0
    ds_read_b64_tr_b16 v[220:221], v30 offset:8192
    ds_read_b64_tr_b16 v[222:223], v30 offset:9216
    s_add_u32 m0, s58, 98304
    s_nop 0
    buffer_load_dwordx4 v16, s[8:11], s63 offen offset:0  lds
    v_lshrrev_b32 v9, 2, v1
    v_mfma_f32_32x32x16_bf16 v[172:187], v[232:235], a[64:67], v[172:187]
    ds_read_b64_tr_b16 v[224:225], v31 offset:8192
    ds_read_b64_tr_b16 v[226:227], v31 offset:9216
    v_lshl_add_u32 v63, v9, 10, v63
    v_lshrrev_b32 v66, 4, v1
    s_waitcnt lgkmcnt(9)
    v_mfma_f32_32x32x16_bf16 v[124:139], v[236:239], a[68:71], v[124:139]
    ds_read_b64_tr_b16 v[228:229], v32 offset:8192
    ds_read_b64_tr_b16 v[230:231], v32 offset:9216
    buffer_load_dwordx4 v17, s[8:11], s63 offen offset:1024  lds
    v_xor_b32 v66, v66, v1
    v_mfma_f32_32x32x16_bf16 v[140:155], v[240:243], a[68:71], v[140:155]
    ds_read_b64_tr_b16 v[232:233], v33 offset:8192
    ds_read_b64_tr_b16 v[234:235], v33 offset:9216
    v_and_b32 v66, 3, v66
    v_lshlrev_b32 v66, 4, v66
    s_waitcnt lgkmcnt(9)
    v_mfma_f32_32x32x16_bf16 v[156:171], v[244:247], a[68:71], v[156:171]
    ds_read_b128 a[76:79], v25 offset:0
    ds_read_b64_tr_b16 v[236:237], v30 offset:12288
    ds_read_b64_tr_b16 v[238:239], v30 offset:13312
    buffer_load_dwordx4 v18, s[8:11], s63 offen offset:2048  lds
    v_lshl_add_u32 v66, v9, 6, v66
    v_mfma_f32_32x32x16_bf16 v[172:187], v[248:251], a[68:71], v[172:187]
    ds_read_b64_tr_b16 v[240:241], v31 offset:12288
    ds_read_b64_tr_b16 v[242:243], v31 offset:13312
    v_lshl_add_u32 v66, s46, 11, v66
    v_lshrrev_b32 v65, 2, v4
    s_waitcnt lgkmcnt(9)
    v_mfma_f32_32x32x16_bf16 v[124:139], v[220:223], a[72:75], v[124:139]
    ds_read_b64_tr_b16 v[244:245], v32 offset:12288
    ds_read_b64_tr_b16 v[246:247], v32 offset:13312
    buffer_load_dwordx4 v19, s[8:11], s63 offen offset:3072  lds
    v_and_b32 v65, 3, v65
    v_mfma_f32_32x32x16_bf16 v[140:155], v[224:227], a[72:75], v[140:155]
    ds_read_b64_tr_b16 v[248:249], v33 offset:12288
    ds_read_b64_tr_b16 v[250:251], v33 offset:13312
    v_lshlrev_b32 v65, 4, v65
    v_lshl_add_u32 v65, v5, 3, v65
    s_waitcnt lgkmcnt(9)
    v_mfma_f32_32x32x16_bf16 v[156:171], v[228:231], a[72:75], v[156:171]
    s_waitcnt vmcnt(17)
    s_barrier
    ds_read_b128 a[80:83], v22 offset:16384
    ds_read_b64_tr_b16 v[220:221], v30 offset:16384
    ds_read_b64_tr_b16 v[222:223], v30 offset:17408
    s_bfe_u32 s56, s57, 0x30000
    s_mul_i32 s64, s56, 176128
    s_add_u32 m0, s60, 131072
    s_nop 0
    buffer_load_dwordx4 v20, s[12:15], s64 offen  lds
    v_lshl_add_u32 v65, v4, 6, v65
    v_mfma_f32_32x32x16_bf16 v[172:187], v[232:235], a[72:75], v[172:187]
    ds_read_b64_tr_b16 v[224:225], v31 offset:16384
    ds_read_b64_tr_b16 v[226:227], v31 offset:17408
    v_lshl_add_u32 v65, s46, 11, v65
    s_lshl4_add_u32 s53, s49, s53
    s_waitcnt lgkmcnt(9)
    v_mfma_f32_32x32x16_bf16 v[124:139], v[236:239], a[76:79], v[124:139]
    ds_read_b64_tr_b16 v[228:229], v32 offset:16384
    ds_read_b64_tr_b16 v[230:231], v32 offset:17408
    s_bfe_u32 s56, s57, 0x30004
    s_mul_i32 s64, s56, 176128
    s_add_u32 m0, s60, 135168
    s_nop 0
    buffer_load_dwordx4 v20, s[12:15], s64 offen  lds
    s_lshl2_add_u32 s53, s53, s46
    v_mfma_f32_32x32x16_bf16 v[140:155], v[240:243], a[76:79], v[140:155]
    ds_read_b64_tr_b16 v[232:233], v33 offset:16384
    ds_read_b64_tr_b16 v[234:235], v33 offset:17408
    s_lshl_b32 s53, s53, 12
    s_add_u32 s53, s53, 0x1000000
    s_waitcnt lgkmcnt(9)
    v_mfma_f32_32x32x16_bf16 v[156:171], v[244:247], a[76:79], v[156:171]
    ds_read_b128 a[84:87], v23 offset:16384
    ds_read_b64_tr_b16 v[236:237], v30 offset:20480
    ds_read_b64_tr_b16 v[238:239], v30 offset:21504
    s_bfe_u32 s56, s57, 0x30008
    s_mul_i32 s64, s56, 176128
    s_add_u32 m0, s60, 139264
    s_nop 0
    buffer_load_dwordx4 v20, s[12:15], s64 offen  lds
    s_xor_b32 s79, s53, 0x4000
    v_mfma_f32_32x32x16_bf16 v[172:187], v[248:251], a[76:79], v[172:187]
    ds_read_b64_tr_b16 v[240:241], v31 offset:20480
    ds_read_b64_tr_b16 v[242:243], v31 offset:21504
    v_cmp_gt_u32 vcc, 32, v1
    s_addk_i32 s53, 2048
    v_mov_b32 v9, s53
    v_cndmask_b32 v45, v9, v45, vcc
    v_lshl_add_u32 v9, v5, 2, v6
    s_waitcnt lgkmcnt(9)
    v_mfma_f32_32x32x16_bf16 v[124:139], v[220:223], a[80:83], v[124:139]
    ds_read_b64_tr_b16 v[244:245], v32 offset:20480
    ds_read_b64_tr_b16 v[246:247], v32 offset:21504
    s_bfe_u32 s56, s57, 0x3000c
    s_mul_i32 s64, s56, 176128
    s_add_u32 m0, s60, 143360
    s_nop 0
    buffer_load_dwordx4 v20, s[12:15], s64 offen  lds
    v_lshrrev_b32 v11, 1, v6
    v_xor_b32 v11, s47, v11
    v_lshl_add_u32 v9, v9, 1, v11
    v_lshl_add_u32 v56, v9, 6, v8
    v_add_u32 v57, 0x10000, v56
    v_add_u32 v58, 0x20000, v56
    v_xor_b32 v59, 64, v56
    v_xor_b32 v60, 64, v57
    v_xor_b32 v61, 64, v58
    s_and_b32 s54, s48, 15
    s_lshl4_add_u32 s54, s47, s54
    s_lshr_b32 s41, s49, 1
    s_sub_u32 s52, 7, s46
    s_movk_i32 s53, -1024
    s_cmp_eq_u32 s41, 0
    s_cselect_b32 s85, s52, 12
    s_cselect_b32 s86, 0, 0x3f803f80
    s_cselect_b32 s87, 0, -1
    s_bitcmp1_b32 s41, 0
    s_cselect_b32 s52, s46, s52
    s_cselect_b32 s67, 0x400, s53
    s_and_b32 s87, s87, s67
    s_lshl3_add_u32 s55, s41, s52
    s_lshl_b32 s40, s54, 6
    s_add_u32 s72, s40, s55
    s_lshl_b32 s72, s72, 10
    s_lshl_b32 s55, s55, 5
    s_add_u32 s55, s55, s54
    s_lshl_b32 s55, s55, 10
    s_add_u32 s74, s55, 0xc00000
    s_and_b32 s52, s52, 3
    s_lshl2_add_u32 s55, s41, s52
    s_lshl1_add_u32 s55, s55, s47
    s_lshl_b32 s55, s55, 5
    s_and_b32 s53, s48, 15
    s_add_u32 s55, s55, s53
    s_lshl2_add_u32 s69, s55, 0xe48000
    buffer_load_dword v55, v41, s[24:27], s79 offen offset:2048 sc1
    s_lshr_b32 s54, s54, 3
    v_mfma_f32_32x32x16_bf16 v[140:155], v[224:227], a[80:83], v[140:155]
    ds_read_b64_tr_b16 v[248:249], v33 offset:20480
    ds_read_b64_tr_b16 v[250:251], v33 offset:21504
    s_lshl3_add_u32 s55, s41, s54
    s_lshl4_add_u32 s55, s55, s52
    s_waitcnt lgkmcnt(9)
    v_mfma_f32_32x32x16_bf16 v[156:171], v[228:231], a[80:83], v[156:171]
    ds_read_b128 a[88:91], v24 offset:16384
    ds_read_b64_tr_b16 v[220:221], v30 offset:24576
    ds_read_b64_tr_b16 v[222:223], v30 offset:25600
    s_bfe_u32 s56, s57, 0x30010
    s_mul_i32 s64, s56, 176128
    s_add_u32 m0, s60, 147456
    s_nop 0
    buffer_load_dwordx4 v20, s[12:15], s64 offen  lds
    v_and_b32 v9, 1, v1
    v_mfma_f32_32x32x16_bf16 v[172:187], v[232:235], a[80:83], v[172:187]
    ds_read_b64_tr_b16 v[224:225], v31 offset:24576
    ds_read_b64_tr_b16 v[226:227], v31 offset:25600
    v_lshl_add_u32 v11, v9, 6, s55
    s_lshl_b32 s52, s46, 1
    s_waitcnt lgkmcnt(9)
    v_mfma_f32_32x32x16_bf16 v[124:139], v[236:239], a[84:87], v[124:139]
    ds_read_b64_tr_b16 v[228:229], v32 offset:24576
    ds_read_b64_tr_b16 v[230:231], v32 offset:25600
    s_bfe_u32 s56, s57, 0x30014
    s_mul_i32 s64, s56, 176128
    s_add_u32 m0, s60, 151552
    s_nop 0
    buffer_load_dwordx4 v20, s[12:15], s64 offen  lds
    s_sub_u32 s53, 7, s52
    v_mfma_f32_32x32x16_bf16 v[140:155], v[240:243], a[84:87], v[140:155]
    ds_read_b64_tr_b16 v[232:233], v33 offset:24576
    ds_read_b64_tr_b16 v[234:235], v33 offset:25600
    s_sub_u32 s52, s52, 8
    s_bitcmp1_b32 s41, 0
    s_cselect_b32 s52, s52, s53
    s_waitcnt lgkmcnt(9)
    v_mfma_f32_32x32x16_bf16 v[156:171], v[244:247], a[84:87], v[156:171]
    ds_read_b128 a[92:95], v25 offset:16384
    ds_read_b64_tr_b16 v[236:237], v30 offset:28672
    ds_read_b64_tr_b16 v[238:239], v30 offset:29696
    s_bfe_u32 s56, s57, 0x30018
    s_mul_i32 s64, s56, 176128
    s_add_u32 m0, s60, 155648
    s_nop 0
    buffer_load_dwordx4 v20, s[12:15], s64 offen  lds
    s_lshl3_add_u32 s52, s41, s52
    v_mfma_f32_32x32x16_bf16 v[172:187], v[248:251], a[84:87], v[172:187]
    ds_read_b64_tr_b16 v[240:241], v31 offset:28672
    ds_read_b64_tr_b16 v[242:243], v31 offset:29696
    s_add_u32 s40, s40, s52
    s_lshl_b32 s40, s40, 10
    s_waitcnt lgkmcnt(9)
    v_mfma_f32_32x32x16_bf16 v[124:139], v[220:223], a[88:91], v[124:139]
    ds_read_b64_tr_b16 v[244:245], v32 offset:28672
    ds_read_b64_tr_b16 v[246:247], v32 offset:29696
    s_bfe_u32 s56, s57, 0x3001c
    s_mul_i32 s64, s56, 176128
    s_add_u32 m0, s60, 159744
    s_nop 0
    buffer_load_dwordx4 v20, s[12:15], s64 offen  lds
    s_add_u32 s70, s40, 0x200000
    v_mfma_f32_32x32x16_bf16 v[140:155], v[224:227], a[88:91], v[140:155]
    ds_read_b64_tr_b16 v[248:249], v33 offset:28672
    ds_read_b64_tr_b16 v[250:251], v33 offset:29696
    s_add_u32 s71, s40, 0x400000
    s_and_b32 s53, s52, -4
    s_waitcnt lgkmcnt(9)
    v_mfma_f32_32x32x16_bf16 v[156:171], v[228:231], a[88:91], v[156:171]
    s_waitcnt vmcnt(18)
    s_barrier
    ds_read_b128 a[96:99], v26
    ds_read_b64_tr_b16 v[220:221], v30 offset:32768
    ds_read_b64_tr_b16 v[222:223], v30 offset:33792
    v_and_b32 v77, 31, v1
    s_andn2_b32 s84, s84, 0xff
    v_lshlrev_b32 v77, 3, v77
    buffer_load_dwordx2 v[70:71], v77, s[24:27], s84 offen sc1
    s_add_u32 s53, s53, s54
    v_mfma_f32_32x32x16_bf16 v[172:187], v[232:235], a[88:91], v[172:187]
    ds_read_b64_tr_b16 v[224:225], v31 offset:32768
    ds_read_b64_tr_b16 v[226:227], v31 offset:33792
    s_and_b32 s52, s52, 2
    s_lshl4_add_u32 s53, s53, s52
    s_waitcnt lgkmcnt(9)
    v_mfma_f32_32x32x16_bf16 v[124:139], v[236:239], a[92:95], v[124:139]
    ds_read_b64_tr_b16 v[228:229], v32 offset:32768
    ds_read_b64_tr_b16 v[230:231], v32 offset:33792
    s_addk_i32 s53, 1024
    v_and_b32 v42, 2, v1
    v_mfma_f32_32x32x16_bf16 v[140:155], v[240:243], a[92:95], v[140:155]
    ds_read_b64_tr_b16 v[232:233], v33 offset:32768
    ds_read_b64_tr_b16 v[234:235], v33 offset:33792
    v_lshl_add_u32 v43, v42, 1, v9
    v_add_u32 v43, s53, v43
    s_waitcnt lgkmcnt(9)
    v_mfma_f32_32x32x16_bf16 v[156:171], v[244:247], a[92:95], v[156:171]
    ds_read_b128 a[100:103], v27
    ds_read_b64_tr_b16 v[236:237], v30 offset:36864
    ds_read_b64_tr_b16 v[238:239], v30 offset:37888
    s_mul_i32 s73, s46, 2080
    v_mul_u32_u24 v9, 1040, v9
    v_mfma_f32_32x32x16_bf16 v[172:187], v[248:251], a[92:95], v[172:187]
    ds_read_b64_tr_b16 v[240:241], v31 offset:36864
    ds_read_b64_tr_b16 v[242:243], v31 offset:37888
    s_movk_i32 s55, 4160
    v_mad_u32_u24 v9, v42, s55, v9
    s_waitcnt lgkmcnt(9)
    v_mfma_f32_32x32x16_bf16 v[124:139], v[220:223], a[96:99], v[124:139]
    ds_read_b64_tr_b16 v[244:245], v32 offset:36864
    ds_read_b64_tr_b16 v[246:247], v32 offset:37888
    s_add_u32 s73, s73, 16384
    s_add_u32 s55, s73, 1024
    v_mfma_f32_32x32x16_bf16 v[140:155], v[224:227], a[96:99], v[140:155]
    ds_read_b64_tr_b16 v[248:249], v33 offset:36864
    ds_read_b64_tr_b16 v[250:251], v33 offset:37888
    v_add_u32 v49, s55, v9
    v_mov_b32 v9, s86
    s_waitcnt lgkmcnt(9)
    v_mfma_f32_32x32x16_bf16 v[156:171], v[228:231], a[96:99], v[156:171]
    ds_read_b128 a[104:107], v28
    ds_read_b64_tr_b16 v[220:221], v30 offset:40960
    ds_read_b64_tr_b16 v[222:223], v30 offset:41984
    v_cmp_eq_u32 vcc, 0, v42
    v_mov_b32 v80, 0x3f803f80
    s_mov_b32 s55, 0xe40000
    v_cndmask_b32 v80, v9, v80, vcc
    v_mov_b32 v81, v80
    v_mfma_f32_32x32x16_bf16 v[172:187], v[232:235], a[96:99], v[172:187]
    ds_read_b64_tr_b16 v[224:225], v31 offset:40960
    ds_read_b64_tr_b16 v[226:227], v31 offset:41984
    v_mov_b32 v82, v80
    v_mov_b32 v83, v80
    s_waitcnt lgkmcnt(9)
    v_mfma_f32_32x32x16_bf16 v[124:139], v[236:239], a[100:103], v[124:139]
    ds_read_b64_tr_b16 v[228:229], v32 offset:40960
    ds_read_b64_tr_b16 v[230:231], v32 offset:41984
    v_cmp_gt_u32 vcc, 32, v1
    v_add_u32 v46, s60, v2
    s_add_u32 s87, s87, s55
    v_cndmask_b32 v9, v11, v43, vcc
    v_lshl_add_u32 v42, v9, 3, s55
    v_mfma_f32_32x32x16_bf16 v[140:155], v[240:243], a[100:103], v[140:155]
    ds_read_b64_tr_b16 v[232:233], v33 offset:40960
    ds_read_b64_tr_b16 v[234:235], v33 offset:41984
    v_lshl_add_u32 v43, v43, 3, s87
    v_lshlrev_b32 v9, 8, v5
    s_waitcnt lgkmcnt(9)
    v_mfma_f32_32x32x16_bf16 v[156:171], v[244:247], a[100:103], v[156:171]
    ds_read_b128 a[108:111], v29
    ds_read_b64_tr_b16 v[236:237], v30 offset:45056
    ds_read_b64_tr_b16 v[238:239], v30 offset:46080
    v_lshl_add_u32 v9, v10, 4, v9
    v_add_u32 v11, 512, v9
    v_mfma_f32_32x32x16_bf16 v[172:187], v[248:251], a[100:103], v[172:187]
    ds_read_b64_tr_b16 v[240:241], v31 offset:45056
    ds_read_b64_tr_b16 v[242:243], v31 offset:46080
    v_cmp_eq_u32 vcc, 0, v7
    v_mov_b32 v48, 1024
    s_mul_i32 s55, s46, 1040
    v_cndmask_b32 v47, v48, v9, vcc
    v_cndmask_b32 v48, v48, v11, vcc
    v_add_u32 v47, s55, v47
    s_waitcnt lgkmcnt(9)
    v_mfma_f32_32x32x16_bf16 v[124:139], v[220:223], a[104:107], v[124:139]
    ds_read_b64_tr_b16 v[244:245], v32 offset:45056
    ds_read_b64_tr_b16 v[246:247], v32 offset:46080
    v_add_u32 v48, s55, v48
    v_lshl_add_u32 v84, v7, 16, v9
    v_mfma_f32_32x32x16_bf16 v[140:155], v[224:227], a[104:107], v[140:155]
    ds_read_b64_tr_b16 v[248:249], v33 offset:45056
    ds_read_b64_tr_b16 v[250:251], v33 offset:46080
    v_lshlrev_b32 v9, 2, v5
    v_sub_u32 v9, v4, v9
    s_waitcnt lgkmcnt(9)
    v_mfma_f32_32x32x16_bf16 v[156:171], v[228:231], a[104:107], v[156:171]
    s_waitcnt vmcnt(10)
    s_barrier
    ds_read_b128 a[112:115], v22 offset:32768
    ds_read_b64_tr_b16 v[220:221], v30 offset:49152
    ds_read_b64_tr_b16 v[222:223], v30 offset:50176
    v_cvt_f32_i32 v9, v9
    v_cvt_f32_i32 v11, s67
    v_mfma_f32_32x32x16_bf16 v[172:187], v[232:235], a[104:107], v[172:187]
    ds_read_b128 a[116:119], v23 offset:32768
    ds_read_b64_tr_b16 v[224:225], v30 offset:53248
    ds_read_b64_tr_b16 v[226:227], v30 offset:54272
    v_mul_f32 v11, 0x6cc9f2ca, v11
    v_mul_f32 v9, v9, v11
    s_waitcnt lgkmcnt(10)
    v_mfma_f32_32x32x16_bf16 v[124:139], v[236:239], a[108:111], v[124:139]
    ds_read_b128 a[120:123], v24 offset:32768
    ds_read_b64_tr_b16 v[228:229], v30 offset:57344
    ds_read_b64_tr_b16 v[230:231], v30 offset:58368
    v_fmamk_f32 v108, v11, 0x3f000000, v9
    v_min_f32 v92, 0, v108
    v_mfma_f32_32x32x16_bf16 v[140:155], v[240:243], a[108:111], v[140:155]
    ds_read_b128 a[124:127], v25 offset:32768
    ds_read_b64_tr_b16 v[232:233], v30 offset:61440
    ds_read_b64_tr_b16 v[234:235], v30 offset:62464
    v_min_f32 v108, 0, -v108
    v_fmamk_f32 v109, v11, 0xbf000000, v9
    s_waitcnt lgkmcnt(12)
    v_mfma_f32_32x32x16_bf16 v[156:171], v[244:247], a[108:111], v[156:171]
    ds_read_b64_tr_b16 v[236:237], v31 offset:49152
    ds_read_b64_tr_b16 v[238:239], v31 offset:50176
    v_min_f32 v93, 0, v109
    v_min_f32 v109, 0, -v109
    v_mfma_f32_32x32x16_bf16 v[172:187], v[248:251], a[108:111], v[172:187]
    ds_read_b64_tr_b16 v[240:241], v31 offset:53248
    ds_read_b64_tr_b16 v[242:243], v31 offset:54272
    v_fmamk_f32 v110, v11, 0xbfc00000, v9
    v_min_f32 v94, 0, v110
    s_waitcnt lgkmcnt(10)
    v_mfma_f32_32x32x16_bf16 v[124:139], v[220:223], a[112:115], v[124:139]
    ds_read_b64_tr_b16 v[244:245], v31 offset:57344
    ds_read_b64_tr_b16 v[246:247], v31 offset:58368
    v_min_f32 v110, 0, -v110
    v_fmamk_f32 v111, v11, 0xc0200000, v9
    v_mfma_f32_32x32x16_bf16 v[124:139], v[224:227], a[116:119], v[124:139]
    ds_read_b64_tr_b16 v[248:249], v31 offset:61440
    ds_read_b64_tr_b16 v[250:251], v31 offset:62464
    v_min_f32 v95, 0, v111
    v_min_f32 v111, 0, -v111
    s_waitcnt lgkmcnt(8)
    v_mfma_f32_32x32x16_bf16 v[124:139], v[228:231], a[120:123], v[124:139]
    ds_read_b64_tr_b16 v[220:221], v32 offset:49152
    ds_read_b64_tr_b16 v[222:223], v32 offset:50176
    v_fmamk_f32 v112, v11, 0xc0f00000, v9
    v_min_f32 v96, 0, v112
    v_mfma_f32_32x32x16_bf16 v[124:139], v[232:235], a[124:127], v[124:139]
    ds_read_b64_tr_b16 v[224:225], v32 offset:53248
    ds_read_b64_tr_b16 v[226:227], v32 offset:54272
    v_min_f32 v112, 0, -v112
    v_fmamk_f32 v113, v11, 0xc1080000, v9
    s_waitcnt vmcnt(0)
    v_cmp_ne_u64 vcc, v[70:71], v[68:69]
    s_cbranch_vccnz CHKC_slow
CHKC_back:
    s_or_b32 s82, s82, s81
    s_waitcnt lgkmcnt(8)
    v_mfma_f32_32x32x16_bf16 v[140:155], v[236:239], a[112:115], v[140:155]
    ds_read_b64_tr_b16 v[228:229], v32 offset:57344
    ds_read_b64_tr_b16 v[230:231], v32 offset:58368
    v_min_f32 v97, 0, v113
    v_min_f32 v113, 0, -v113
    v_mfma_f32_32x32x16_bf16 v[140:155], v[240:243], a[116:119], v[140:155]
    ds_read_b64_tr_b16 v[232:233], v32 offset:61440
    ds_read_b64_tr_b16 v[234:235], v32 offset:62464
    v_fmamk_f32 v114, v11, 0xc1180000, v9
    v_min_f32 v98, 0, v114
    s_waitcnt lgkmcnt(8)
    v_mfma_f32_32x32x16_bf16 v[140:155], v[244:247], a[120:123], v[140:155]
    ds_read_b64_tr_b16 v[236:237], v33 offset:49152
    ds_read_b64_tr_b16 v[238:239], v33 offset:50176
    v_mul_f32 v204, s44, v124
    v_mul_f32 v205, s44, v125
    v_exp_f32 v204, v204
    v_mfma_f32_32x32x16_bf16 v[140:155], v[248:251], a[124:127], v[140:155]
    ds_read_b64_tr_b16 v[240:241], v33 offset:53248
    ds_read_b64_tr_b16 v[242:243], v33 offset:54272
    v_mul_f32 v206, s44, v126
    v_exp_f32 v205, v205
    s_waitcnt lgkmcnt(8)
    v_mfma_f32_32x32x16_bf16 v[156:171], v[220:223], a[112:115], v[156:171]
    ds_read_b64_tr_b16 v[244:245], v33 offset:57344
    ds_read_b64_tr_b16 v[246:247], v33 offset:58368
    v_add_f32 v204, 1.0, v204
    v_mul_f32 v207, s44, v127
    v_exp_f32 v206, v206
    v_mfma_f32_32x32x16_bf16 v[156:171], v[224:227], a[116:119], v[156:171]
    ds_read_b64_tr_b16 v[248:249], v33 offset:61440
    ds_read_b64_tr_b16 v[250:251], v33 offset:62464
    v_add_f32 v205, 1.0, v205
    v_rcp_f32 v204, v204
    s_waitcnt lgkmcnt(8)
    v_mfma_f32_32x32x16_bf16 v[156:171], v[228:231], a[120:123], v[156:171]
    s_barrier
    ds_read_b64_tr_b16 v[220:221], v34 offset:0
    ds_read_b64_tr_b16 v[222:223], v34 offset:256
    v_mul_f32 v208, s44, v128
    v_exp_f32 v207, v207
    v_mfma_f32_32x32x16_bf16 v[156:171], v[232:235], a[124:127], v[156:171]
    ds_read_b64_tr_b16 v[224:225], v34 offset:1024
    ds_read_b64_tr_b16 v[226:227], v34 offset:1280
    v_add_f32 v206, 1.0, v206
    v_rcp_f32 v205, v205
    s_waitcnt lgkmcnt(8)
    v_mfma_f32_32x32x16_bf16 v[172:187], v[236:239], a[112:115], v[172:187]
    ds_read_b64_tr_b16 v[228:229], v34 offset:2048
    ds_read_b64_tr_b16 v[230:231], v34 offset:2304
    v_mul_f32 v124, v124, v204
    v_mul_f32 v209, s44, v129
    v_exp_f32 v208, v208
    v_mfma_f32_32x32x16_bf16 v[172:187], v[240:243], a[116:119], v[172:187]
    ds_read_b64_tr_b16 v[232:233], v34 offset:3072
    ds_read_b64_tr_b16 v[234:235], v34 offset:3328
    v_add_f32 v207, 1.0, v207
    v_rcp_f32 v206, v206
    s_waitcnt lgkmcnt(8)
    v_mfma_f32_32x32x16_bf16 v[172:187], v[244:247], a[120:123], v[172:187]
    ds_read_b64_tr_b16 v[236:237], v34 offset:4096
    ds_read_b64_tr_b16 v[238:239], v34 offset:4352
    v_mul_f32 v125, v125, v205
    v_mul_f32 v210, s44, v130
    v_exp_f32 v209, v209
    v_mfma_f32_32x32x16_bf16 v[172:187], v[248:251], a[124:127], v[172:187]
    ds_read_b64_tr_b16 v[240:241], v34 offset:5120
    ds_read_b64_tr_b16 v[242:243], v34 offset:5376
    v_add_f32 v208, 1.0, v208
    v_rcp_f32 v207, v207
    s_waitcnt lgkmcnt(8)
    v_mfma_f32_32x32x16_bf16 v[188:203], v[220:223], a[0:3], 0
    ds_read_b64_tr_b16 v[244:245], v34 offset:6144
    ds_read_b64_tr_b16 v[246:247], v34 offset:6400
    v_mul_f32 v126, v126, v206
    v_cvt_pk_bf16_f32 v124, v124, v125
    v_mul_f32 v211, s44, v131
    v_mfma_f32_32x32x16_bf16 v[188:203], v[224:227], a[4:7], v[188:203]
    ds_read_b64_tr_b16 v[248:249], v34 offset:7168
    ds_read_b64_tr_b16 v[250:251], v34 offset:7424
    v_exp_f32 v210, v210
    v_add_f32 v209, 1.0, v209
    s_waitcnt lgkmcnt(8)
    v_mfma_f32_32x32x16_bf16 v[188:203], v[228:231], a[8:11], v[188:203]
    ds_read_b64_tr_b16 v[220:221], v34 offset:8192
    ds_read_b64_tr_b16 v[222:223], v34 offset:8448
    s_add_u32 m0, s58, 114688
    s_nop 0
    buffer_load_dwordx4 v50, s[16:19], s77 offen offset:0  lds
    v_mfma_f32_32x32x16_bf16 v[188:203], v[232:235], a[12:15], v[188:203]
    ds_read_b64_tr_b16 v[224:225], v34 offset:9216
    ds_read_b64_tr_b16 v[226:227], v34 offset:9472
    v_rcp_f32 v208, v208
    v_mul_f32 v127, v127, v207
    s_waitcnt lgkmcnt(8)
    v_mfma_f32_32x32x16_bf16 v[188:203], v[236:239], a[16:19], v[188:203]
    ds_read_b64_tr_b16 v[228:229], v34 offset:10240
    ds_read_b64_tr_b16 v[230:231], v34 offset:10496
    buffer_load_dwordx4 v51, s[16:19], s77 offen offset:1024  lds
    v_mul_f32 v212, s44, v132
    v_exp_f32 v211, v211
    v_mfma_f32_32x32x16_bf16 v[188:203], v[240:243], a[20:23], v[188:203]
    ds_read_b64_tr_b16 v[232:233], v34 offset:11264
    ds_read_b64_tr_b16 v[234:235], v34 offset:11520
    v_add_f32 v210, 1.0, v210
    v_rcp_f32 v209, v209
    s_waitcnt lgkmcnt(8)
    v_mfma_f32_32x32x16_bf16 v[188:203], v[244:247], a[24:27], v[188:203]
    ds_read_b64_tr_b16 v[236:237], v34 offset:12288
    ds_read_b64_tr_b16 v[238:239], v34 offset:12544
    buffer_load_dwordx4 v52, s[16:19], s77 offen offset:2048  lds
    v_mul_f32 v128, v128, v208
    v_cvt_pk_bf16_f32 v125, v126, v127
    v_mul_f32 v213, s44, v133
    v_mfma_f32_32x32x16_bf16 v[188:203], v[248:251], a[28:31], v[188:203]
    ds_read_b64_tr_b16 v[240:241], v34 offset:13312
    ds_read_b64_tr_b16 v[242:243], v34 offset:13568
    v_exp_f32 v212, v212
    v_add_f32 v211, 1.0, v211
    s_waitcnt lgkmcnt(8)
    v_mfma_f32_32x32x16_bf16 v[188:203], v[220:223], a[32:35], v[188:203]
    ds_read_b64_tr_b16 v[244:245], v34 offset:14336
    ds_read_b64_tr_b16 v[246:247], v34 offset:14592
    buffer_load_dwordx4 v53, s[16:19], s77 offen offset:3072  lds
    v_rcp_f32 v210, v210
    v_mul_f32 v129, v129, v209
    v_mfma_f32_32x32x16_bf16 v[188:203], v[224:227], a[36:39], v[188:203]
    ds_read_b64_tr_b16 v[248:249], v34 offset:15360
    ds_read_b64_tr_b16 v[250:251], v34 offset:15616
    v_mul_f32 v214, s44, v134
    v_exp_f32 v213, v213
    s_waitcnt lgkmcnt(8)
    v_mfma_f32_32x32x16_bf16 v[188:203], v[228:231], a[40:43], v[188:203]
    ds_read_b64_tr_b16 v[220:221], v34 offset:16384
    ds_read_b64_tr_b16 v[222:223], v34 offset:16640
    s_xor_b32 s77, s77, 0x20000
    s_add_u32 m0, s58, 81920
    s_nop 0
    buffer_load_dwordx4 v50, s[16:19], s77 offen offset:0  lds
    v_mfma_f32_32x32x16_bf16 v[188:203], v[232:235], a[44:47], v[188:203]
    ds_read_b64_tr_b16 v[224:225], v34 offset:17408
    ds_read_b64_tr_b16 v[226:227], v34 offset:17664
    v_add_f32 v212, 1.0, v212
    v_rcp_f32 v211, v211
    s_waitcnt lgkmcnt(8)
    v_mfma_f32_32x32x16_bf16 v[188:203], v[236:239], a[48:51], v[188:203]
    ds_read_b64_tr_b16 v[228:229], v34 offset:18432
    ds_read_b64_tr_b16 v[230:231], v34 offset:18688
    buffer_load_dwordx4 v51, s[16:19], s77 offen offset:1024  lds
    v_mul_f32 v130, v130, v210
    v_cvt_pk_bf16_f32 v126, v128, v129
    v_mul_f32 v215, s44, v135
    v_mfma_f32_32x32x16_bf16 v[188:203], v[240:243], a[52:55], v[188:203]
    ds_read_b64_tr_b16 v[232:233], v34 offset:19456
    ds_read_b64_tr_b16 v[234:235], v34 offset:19712
    v_exp_f32 v214, v214
    v_add_f32 v213, 1.0, v213
    s_waitcnt lgkmcnt(8)
    v_mfma_f32_32x32x16_bf16 v[188:203], v[244:247], a[56:59], v[188:203]
    ds_read_b64_tr_b16 v[236:237], v34 offset:20480
    ds_read_b64_tr_b16 v[238:239], v34 offset:20736
    buffer_load_dwordx4 v52, s[16:19], s77 offen offset:2048  lds
    v_rcp_f32 v212, v212
    v_mul_f32 v131, v131, v211
    v_mfma_f32_32x32x16_bf16 v[188:203], v[248:251], a[60:63], v[188:203]
    ds_read_b64_tr_b16 v[240:241], v34 offset:21504
    ds_read_b64_tr_b16 v[242:243], v34 offset:21760
    v_mul_f32 v216, s44, v136
    v_exp_f32 v215, v215
    s_waitcnt lgkmcnt(8)
    v_mfma_f32_32x32x16_bf16 v[188:203], v[220:223], a[64:67], v[188:203]
    ds_read_b64_tr_b16 v[244:245], v34 offset:22528
    ds_read_b64_tr_b16 v[246:247], v34 offset:22784
    buffer_load_dwordx4 v53, s[16:19], s77 offen offset:3072  lds
    v_add_f32 v214, 1.0, v214
    v_rcp_f32 v213, v213
    v_mfma_f32_32x32x16_bf16 v[188:203], v[224:227], a[68:71], v[188:203]
    ds_read_b64_tr_b16 v[248:249], v34 offset:23552
    ds_read_b64_tr_b16 v[250:251], v34 offset:23808
    v_mul_f32 v132, v132, v212
    v_cvt_pk_bf16_f32 v127, v130, v131
    v_mul_f32 v217, s44, v137
    s_waitcnt lgkmcnt(8)
    v_mfma_f32_32x32x16_bf16 v[188:203], v[228:231], a[72:75], v[188:203]
    ds_read_b64_tr_b16 v[220:221], v34 offset:24576
    ds_read_b64_tr_b16 v[222:223], v34 offset:24832
    s_xor_b32 s77, s77, 0x60000
    s_add_u32 m0, s58, 98304
    s_nop 0
    buffer_load_dwordx4 v50, s[16:19], s77 offen offset:0  lds
    v_mfma_f32_32x32x16_bf16 v[188:203], v[232:235], a[76:79], v[188:203]
    ds_read_b64_tr_b16 v[224:225], v34 offset:25600
    ds_read_b64_tr_b16 v[226:227], v34 offset:25856
    v_exp_f32 v216, v216
    v_add_f32 v215, 1.0, v215
    s_waitcnt lgkmcnt(8)
    v_mfma_f32_32x32x16_bf16 v[188:203], v[236:239], a[80:83], v[188:203]
    ds_read_b64_tr_b16 v[228:229], v34 offset:26624
    ds_read_b64_tr_b16 v[230:231], v34 offset:26880
    buffer_load_dwordx4 v51, s[16:19], s77 offen offset:1024  lds
    v_rcp_f32 v214, v214
    v_mul_f32 v133, v133, v213
    v_mfma_f32_32x32x16_bf16 v[188:203], v[240:243], a[84:87], v[188:203]
    ds_read_b64_tr_b16 v[232:233], v34 offset:27648
    ds_read_b64_tr_b16 v[234:235], v34 offset:27904
    v_mul_f32 v218, s44, v138
    v_exp_f32 v217, v217
    s_waitcnt lgkmcnt(8)
    v_mfma_f32_32x32x16_bf16 v[188:203], v[244:247], a[88:91], v[188:203]
    ds_read_b64_tr_b16 v[236:237], v34 offset:28672
    ds_read_b64_tr_b16 v[238:239], v34 offset:28928
    buffer_load_dwordx4 v52, s[16:19], s77 offen offset:2048  lds
    v_add_f32 v216, 1.0, v216
    v_rcp_f32 v215, v215
    v_mfma_f32_32x32x16_bf16 v[188:203], v[248:251], a[92:95], v[188:203]
    ds_read_b64_tr_b16 v[240:241], v34 offset:29696
    ds_read_b64_tr_b16 v[242:243], v34 offset:29952
    v_mul_f32 v134, v134, v214
    v_cvt_pk_bf16_f32 v132, v132, v133
    v_mul_f32 v219, s44, v139
    s_waitcnt lgkmcnt(8)
    v_mfma_f32_32x32x16_bf16 v[188:203], v[220:223], a[96:99], v[188:203]
    ds_read_b64_tr_b16 v[244:245], v34 offset:30720
    ds_read_b64_tr_b16 v[246:247], v34 offset:30976
    buffer_load_dwordx4 v53, s[16:19], s77 offen offset:3072  lds
    v_exp_f32 v218, v218
    v_add_f32 v217, 1.0, v217
    v_mfma_f32_32x32x16_bf16 v[188:203], v[224:227], a[100:103], v[188:203]
    ds_read_b64_tr_b16 v[248:249], v34 offset:31744
    ds_read_b64_tr_b16 v[250:251], v34 offset:32000
    v_rcp_f32 v216, v216
    v_mul_f32 v135, v135, v215
    s_waitcnt lgkmcnt(8)
    v_mfma_f32_32x32x16_bf16 v[188:203], v[228:231], a[104:107], v[188:203]
    v_exp_f32 v219, v219
    v_add_f32 v218, 1.0, v218
    v_rcp_f32 v217, v217
    v_mul_f32 v136, v136, v216
    v_mfma_f32_32x32x16_bf16 v[188:203], v[232:235], a[108:111], v[188:203]
    v_cvt_pk_bf16_f32 v133, v134, v135
    v_add_f32 v219, 1.0, v219
    v_rcp_f32 v218, v218
    v_mul_f32 v137, v137, v217
    s_waitcnt lgkmcnt(4)
    v_mfma_f32_32x32x16_bf16 v[188:203], v[236:239], a[112:115], v[188:203]
    v_rcp_f32 v219, v219
    v_mul_f32 v138, v138, v218
    v_cvt_pk_bf16_f32 v134, v136, v137
    v_mul_f32 v139, v139, v219
    v_cvt_pk_bf16_f32 v135, v138, v139
    s_cmp_lg_u32 s81, 0
    s_cbranch_scc1 ALT4
    buffer_store_dwordx4 v[124:127], v2, s[24:27], s66 offen offset:0 sc1
    buffer_store_dwordx4 v[132:135], v2, s[24:27], s66 offen offset:1024 sc1
ALT4_back:
    v_mfma_f32_32x32x16_bf16 v[188:203], v[240:243], a[116:119], v[188:203]
    v_mul_f32 v204, s44, v140
    v_mul_f32 v205, s44, v141
    v_exp_f32 v204, v204
    v_mul_f32 v206, s44, v142
    s_waitcnt lgkmcnt(0)
    v_mfma_f32_32x32x16_bf16 v[188:203], v[244:247], a[120:123], v[188:203]
    v_exp_f32 v205, v205
    v_add_f32 v204, 1.0, v204
    v_mul_f32 v207, s44, v143
    v_exp_f32 v206, v206
    v_mfma_f32_32x32x16_bf16 v[188:203], v[248:251], a[124:127], v[188:203]
    v_add_f32 v205, 1.0, v205
    v_rcp_f32 v204, v204
    v_mul_f32 v208, s44, v144
    v_exp_f32 v207, v207
    v_add_f32 v206, 1.0, v206
    v_rcp_f32 v205, v205
    v_mul_f32 v140, v140, v204
    v_mul_f32 v209, s44, v145
    v_exp_f32 v208, v208
    v_add_f32 v207, 1.0, v207
    v_rcp_f32 v206, v206
    v_mul_f32 v141, v141, v205
    v_mul_f32 v210, s44, v146
    v_exp_f32 v209, v209
    v_add_f32 v208, 1.0, v208
    v_rcp_f32 v207, v207
    v_mul_f32 v142, v142, v206
    v_cvt_pk_bf16_f32 v140, v140, v141
    v_mul_f32 v211, s44, v147
    v_exp_f32 v210, v210
    v_add_f32 v209, 1.0, v209
    v_rcp_f32 v208, v208
    v_mul_f32 v143, v143, v207
    v_mul_f32 v212, s44, v148
    v_exp_f32 v211, v211
    v_add_f32 v210, 1.0, v210
    v_rcp_f32 v209, v209
    v_mul_f32 v144, v144, v208
    v_cvt_pk_bf16_f32 v141, v142, v143
    v_mul_f32 v213, s44, v149
    v_exp_f32 v212, v212
    v_add_f32 v211, 1.0, v211
    v_rcp_f32 v210, v210
    v_mul_f32 v145, v145, v209
    v_mul_f32 v214, s44, v150
    v_exp_f32 v213, v213
    v_add_f32 v212, 1.0, v212
    v_rcp_f32 v211, v211
    v_mul_f32 v146, v146, v210
    v_cvt_pk_bf16_f32 v142, v144, v145
    v_mul_f32 v215, s44, v151
    v_exp_f32 v214, v214
    v_add_f32 v213, 1.0, v213
    v_rcp_f32 v212, v212
    v_mul_f32 v147, v147, v211
    v_mul_f32 v216, s44, v152
    v_exp_f32 v215, v215
    v_add_f32 v214, 1.0, v214
    v_rcp_f32 v213, v213
    v_mul_f32 v148, v148, v212
    v_cvt_pk_bf16_f32 v143, v146, v147
    v_mul_f32 v217, s44, v153
    v_exp_f32 v216, v216
    v_add_f32 v215, 1.0, v215
    v_rcp_f32 v214, v214
    v_mul_f32 v149, v149, v213
    v_mul_f32 v218, s44, v154
    v_exp_f32 v217, v217
    v_add_f32 v216, 1.0, v216
    v_rcp_f32 v215, v215
    v_mul_f32 v150, v150, v214
    v_cvt_pk_bf16_f32 v148, v148, v149
    v_mul_f32 v219, s44, v155
    v_exp_f32 v218, v218
    v_add_f32 v217, 1.0, v217
    v_rcp_f32 v216, v216
    v_mul_f32 v151, v151, v215
    v_exp_f32 v219, v219
    v_add_f32 v218, 1.0, v218
    v_rcp_f32 v217, v217
    v_mul_f32 v152, v152, v216
    v_cvt_pk_bf16_f32 v149, v150, v151
    v_add_f32 v219, 1.0, v219
    v_rcp_f32 v218, v218
    v_mul_f32 v153, v153, v217
    v_rcp_f32 v219, v219
    v_mul_f32 v154, v154, v218
    v_cvt_pk_bf16_f32 v150, v152, v153
    v_mul_f32 v155, v155, v219
    v_cvt_pk_bf16_f32 v151, v154, v155
    s_cmp_lg_u32 s81, 0
    s_cbranch_scc1 ALT5
    buffer_store_dwordx4 v[140:143], v2, s[24:27], s66 offen offset:2048 sc1
    buffer_store_dwordx4 v[148:151], v2, s[24:27], s66 offen offset:3072 sc1
ALT5_back:
    v_min_f32 v114, 0, -v114
    v_fmamk_f32 v115, v11, 0xc1280000, v9
    v_min_f32 v99, 0, v115
    v_min_f32 v115, 0, -v115
    v_fmamk_f32 v116, v11, 0xc1780000, v9
    v_min_f32 v100, 0, v116
    v_min_f32 v116, 0, -v116
    v_fmamk_f32 v117, v11, 0xc1840000, v9
    v_min_f32 v101, 0, v117
    v_min_f32 v117, 0, -v117
    v_fmamk_f32 v118, v11, 0xc18c0000, v9
    v_min_f32 v102, 0, v118
    v_min_f32 v118, 0, -v118
    v_fmamk_f32 v119, v11, 0xc1940000, v9
    v_min_f32 v103, 0, v119
    v_min_f32 v119, 0, -v119
    v_fmamk_f32 v120, v11, 0xc1bc0000, v9
    v_min_f32 v104, 0, v120
    v_min_f32 v120, 0, -v120
    v_fmamk_f32 v121, v11, 0xc1c40000, v9
    v_min_f32 v105, 0, v121
    v_min_f32 v121, 0, -v121
    v_fmamk_f32 v122, v11, 0xc1cc0000, v9
    v_min_f32 v106, 0, v122
    v_min_f32 v122, 0, -v122
    v_fmamk_f32 v123, v11, 0xc1d40000, v9
    v_min_f32 v107, 0, v123
    v_min_f32 v123, 0, -v123
    s_mov_b32 s86, 0x21800000
    s_mov_b32 s87, 0x5d800000
    v_pk_mul_f32 v[204:205], v[156:157], s[44:45]
    v_pk_mul_f32 v[206:207], v[158:159], s[44:45]
    v_pk_mul_f32 v[208:209], v[160:161], s[44:45]
    v_pk_mul_f32 v[210:211], v[162:163], s[44:45]
    v_pk_mul_f32 v[212:213], v[164:165], s[44:45]
    v_pk_mul_f32 v[214:215], v[166:167], s[44:45]
    v_pk_mul_f32 v[216:217], v[168:169], s[44:45]
    v_pk_mul_f32 v[218:219], v[170:171], s[44:45]
    v_exp_f32 v204, v204
    v_exp_f32 v205, v205
    v_exp_f32 v206, v206
    v_exp_f32 v207, v207
    v_exp_f32 v208, v208
    v_exp_f32 v209, v209
    v_exp_f32 v210, v210
    v_exp_f32 v211, v211
    v_exp_f32 v212, v212
    v_exp_f32 v213, v213
    v_exp_f32 v214, v214
    v_exp_f32 v215, v215
    v_exp_f32 v216, v216
    v_exp_f32 v217, v217
    v_exp_f32 v218, v218
    v_exp_f32 v219, v219
    v_pk_add_f32 v[204:205], v[204:205], 1.0 op_sel_hi:[1,0]
    v_pk_add_f32 v[206:207], v[206:207], 1.0 op_sel_hi:[1,0]
    v_pk_add_f32 v[208:209], v[208:209], 1.0 op_sel_hi:[1,0]
    v_pk_add_f32 v[210:211], v[210:211], 1.0 op_sel_hi:[1,0]
    v_pk_add_f32 v[212:213], v[212:213], 1.0 op_sel_hi:[1,0]
    v_pk_add_f32 v[214:215], v[214:215], 1.0 op_sel_hi:[1,0]
    v_pk_add_f32 v[216:217], v[216:217], 1.0 op_sel_hi:[1,0]
    v_pk_add_f32 v[218:219], v[218:219], 1.0 op_sel_hi:[1,0]
    v_rcp_f32 v204, v204
    v_rcp_f32 v205, v205
    v_rcp_f32 v206, v206
    v_rcp_f32 v207, v207
    buffer_load_dwordx2 v[70:71], v42, s[24:27], 0 offen sc1
    v_rcp_f32 v208, v208
    v_rcp_f32 v209, v209
    v_rcp_f32 v210, v210
    v_rcp_f32 v211, v211
    v_rcp_f32 v212, v212
    v_rcp_f32 v213, v213
    v_rcp_f32 v214, v214
    v_rcp_f32 v215, v215
    v_rcp_f32 v216, v216
    v_rcp_f32 v217, v217
    v_rcp_f32 v218, v218
    v_rcp_f32 v219, v219
    v_pk_mul_f32 v[156:157], v[156:157], v[204:205]
    v_pk_mul_f32 v[158:159], v[158:159], v[206:207]
    v_pk_mul_f32 v[160:161], v[160:161], v[208:209]
    v_pk_mul_f32 v[162:163], v[162:163], v[210:211]
    v_pk_mul_f32 v[164:165], v[164:165], v[212:213]
    v_pk_mul_f32 v[166:167], v[166:167], v[214:215]
    v_pk_mul_f32 v[168:169], v[168:169], v[216:217]
    v_pk_mul_f32 v[170:171], v[170:171], v[218:219]
    v_cvt_pk_bf16_f32 v156, v156, v157
    v_cvt_pk_bf16_f32 v157, v158, v159
    v_cvt_pk_bf16_f32 v158, v160, v161
    v_cvt_pk_bf16_f32 v159, v162, v163
    v_cvt_pk_bf16_f32 v164, v164, v165
    v_cvt_pk_bf16_f32 v165, v166, v167
    v_cvt_pk_bf16_f32 v166, v168, v169
    v_cvt_pk_bf16_f32 v167, v170, v171
    s_cmp_lg_u32 s81, 0
    s_cbranch_scc1 ALT6
    s_add_u32 s66, s66, 4096
    buffer_store_dwordx4 v[156:159], v2, s[24:27], s66 offen offset:0 sc1
    buffer_store_dwordx4 v[164:167], v2, s[24:27], s66 offen offset:1024 sc1
ALT6_back:
    v_pk_mul_f32 v[204:205], v[172:173], s[44:45]
    v_pk_mul_f32 v[206:207], v[174:175], s[44:45]
    v_pk_mul_f32 v[208:209], v[176:177], s[44:45]
    v_pk_mul_f32 v[210:211], v[178:179], s[44:45]
    v_pk_mul_f32 v[212:213], v[180:181], s[44:45]
    v_pk_mul_f32 v[214:215], v[182:183], s[44:45]
    v_pk_mul_f32 v[216:217], v[184:185], s[44:45]
    v_pk_mul_f32 v[218:219], v[186:187], s[44:45]
    v_exp_f32 v204, v204
    v_exp_f32 v205, v205
    v_exp_f32 v206, v206
    v_exp_f32 v207, v207
    v_exp_f32 v208, v208
    v_exp_f32 v209, v209
    v_exp_f32 v210, v210
    v_exp_f32 v211, v211
    v_exp_f32 v212, v212
    v_exp_f32 v213, v213
    v_exp_f32 v214, v214
    v_exp_f32 v215, v215
    v_exp_f32 v216, v216
    v_exp_f32 v217, v217
    v_exp_f32 v218, v218
    v_exp_f32 v219, v219
    v_pk_add_f32 v[204:205], v[204:205], 1.0 op_sel_hi:[1,0]
    v_pk_add_f32 v[206:207], v[206:207], 1.0 op_sel_hi:[1,0]
    v_pk_add_f32 v[208:209], v[208:209], 1.0 op_sel_hi:[1,0]
    v_pk_add_f32 v[210:211], v[210:211], 1.0 op_sel_hi:[1,0]
    v_pk_add_f32 v[212:213], v[212:213], 1.0 op_sel_hi:[1,0]
    v_pk_add_f32 v[214:215], v[214:215], 1.0 op_sel_hi:[1,0]
    v_pk_add_f32 v[216:217], v[216:217], 1.0 op_sel_hi:[1,0]
    v_pk_add_f32 v[218:219], v[218:219], 1.0 op_sel_hi:[1,0]
    v_rcp_f32 v204, v204
    v_rcp_f32 v205, v205
    v_rcp_f32 v206, v206
    v_rcp_f32 v207, v207
    s_waitcnt vmcnt(2)
    v_cmp_ne_u64 vcc, v[70:71], v[72:73]
    s_cbranch_vccnz P1C_slow
P1C_back:
    ds_write_b128 v49, v[80:83]
    s_mov_b32 m0, s59
    s_nop 0
    buffer_load_dwordx4 v2, s[24:27], s70 offen sc1 lds
    v_rcp_f32 v208, v208
    v_rcp_f32 v209, v209
    v_rcp_f32 v210, v210
    v_rcp_f32 v211, v211
    s_add_u32 s70, s70, s67
    s_add_u32 m0, s59, 1024
    s_nop 0
    buffer_load_dwordx4 v2, s[24:27], s70 offen sc1 lds
    v_rcp_f32 v212, v212
    v_rcp_f32 v213, v213
    v_rcp_f32 v214, v214
    v_rcp_f32 v215, v215
    buffer_load_dwordx4 v[84:87], v2, s[24:27], s72 offen sc1
    v_rcp_f32 v216, v216
    v_rcp_f32 v217, v217
    v_rcp_f32 v218, v218
    v_rcp_f32 v219, v219
    s_lshl2_add_u32 s72, s67, s72
    buffer_load_dwordx4 v[88:91], v2, s[24:27], s72 offen sc1
    v_pk_mul_f32 v[172:173], v[172:173], v[204:205]
    v_pk_mul_f32 v[174:175], v[174:175], v[206:207]
    v_pk_mul_f32 v[176:177], v[176:177], v[208:209]
    v_pk_mul_f32 v[178:179], v[178:179], v[210:211]
    v_pk_mul_f32 v[180:181], v[180:181], v[212:213]
    v_pk_mul_f32 v[182:183], v[182:183], v[214:215]
    v_pk_mul_f32 v[184:185], v[184:185], v[216:217]
    v_pk_mul_f32 v[186:187], v[186:187], v[218:219]
    s_mov_b32 m0, s73
    s_nop 0
    buffer_load_dwordx4 v2, s[24:27], s71 offen sc1 lds
    s_add_u32 s71, s71, s67
    s_add_u32 m0, s73, 1040
    s_nop 0
    buffer_load_dwordx4 v2, s[24:27], s71 offen sc1 lds
    v_cvt_pk_bf16_f32 v172, v172, v173
    v_cvt_pk_bf16_f32 v173, v174, v175
    v_cvt_pk_bf16_f32 v174, v176, v177
    v_cvt_pk_bf16_f32 v175, v178, v179
    v_cvt_pk_bf16_f32 v180, v180, v181
    v_cvt_pk_bf16_f32 v181, v182, v183
    v_cvt_pk_bf16_f32 v182, v184, v185
    v_cvt_pk_bf16_f32 v183, v186, v187
    v_pk_mul_f32 v[204:205], v[188:189], s[44:45]
    v_pk_mul_f32 v[206:207], v[190:191], s[44:45]
    v_pk_mul_f32 v[208:209], v[192:193], s[44:45]
    v_pk_mul_f32 v[210:211], v[194:195], s[44:45]
    v_pk_mul_f32 v[212:213], v[196:197], s[44:45]
    v_pk_mul_f32 v[214:215], v[198:199], s[44:45]
    v_pk_mul_f32 v[216:217], v[200:201], s[44:45]
    v_pk_mul_f32 v[218:219], v[202:203], s[44:45]
    v_exp_f32 v204, v204
    v_exp_f32 v205, v205
    v_exp_f32 v206, v206
    v_exp_f32 v207, v207
    s_cmp_lg_u32 s81, 0
    s_cbranch_scc1 ALT7
    buffer_store_dwordx4 v[172:175], v2, s[24:27], s66 offen offset:2048 sc1
    buffer_store_dwordx4 v[180:183], v2, s[24:27], s66 offen offset:3072 sc1
ALT7_back:
    v_exp_f32 v208, v208
    v_exp_f32 v209, v209
    v_exp_f32 v210, v210
    v_exp_f32 v211, v211
    v_exp_f32 v212, v212
    v_exp_f32 v213, v213
    v_exp_f32 v214, v214
    v_exp_f32 v215, v215
    v_exp_f32 v216, v216
    v_exp_f32 v217, v217
    v_exp_f32 v218, v218
    v_exp_f32 v219, v219
    v_pk_add_f32 v[204:205], v[204:205], 1.0 op_sel_hi:[1,0]
    v_pk_add_f32 v[206:207], v[206:207], 1.0 op_sel_hi:[1,0]
    v_pk_add_f32 v[208:209], v[208:209], 1.0 op_sel_hi:[1,0]
    v_pk_add_f32 v[210:211], v[210:211], 1.0 op_sel_hi:[1,0]
    v_pk_add_f32 v[212:213], v[212:213], 1.0 op_sel_hi:[1,0]
    v_pk_add_f32 v[214:215], v[214:215], 1.0 op_sel_hi:[1,0]
    v_pk_add_f32 v[216:217], v[216:217], 1.0 op_sel_hi:[1,0]
    v_pk_add_f32 v[218:219], v[218:219], 1.0 op_sel_hi:[1,0]
    v_rcp_f32 v204, v204
    v_rcp_f32 v205, v205
    v_rcp_f32 v206, v206
    v_rcp_f32 v207, v207
    v_rcp_f32 v208, v208
    v_rcp_f32 v209, v209
    v_rcp_f32 v210, v210
    v_rcp_f32 v211, v211
    v_rcp_f32 v212, v212
    v_rcp_f32 v213, v213
    v_rcp_f32 v214, v214
    v_rcp_f32 v215, v215
    v_rcp_f32 v216, v216
    v_rcp_f32 v217, v217
    v_rcp_f32 v218, v218
    v_rcp_f32 v219, v219
    v_pk_mul_f32 v[188:189], v[188:189], v[204:205]
    v_pk_mul_f32 v[190:191], v[190:191], v[206:207]
    v_pk_mul_f32 v[192:193], v[192:193], v[208:209]
    v_pk_mul_f32 v[194:195], v[194:195], v[210:211]
    v_pk_mul_f32 v[196:197], v[196:197], v[212:213]
    v_pk_mul_f32 v[198:199], v[198:199], v[214:215]
    v_pk_mul_f32 v[200:201], v[200:201], v[216:217]
    v_pk_mul_f32 v[202:203], v[202:203], v[218:219]
    v_cvt_pk_bf16_f32 v188, v188, v189
    v_cvt_pk_bf16_f32 v189, v190, v191
    v_cvt_pk_bf16_f32 v190, v192, v193
    v_cvt_pk_bf16_f32 v191, v194, v195
    v_cvt_pk_bf16_f32 v196, v196, v197
    v_cvt_pk_bf16_f32 v197, v198, v199
    v_cvt_pk_bf16_f32 v198, v200, v201
    v_cvt_pk_bf16_f32 v199, v202, v203
    s_cmp_lg_u32 s81, 0
    s_cbranch_scc1 ALT8
    s_add_u32 s66, s66, 4096
    buffer_store_dwordx4 v[188:191], v2, s[24:27], s66 offen offset:0 sc1
    buffer_store_dwordx4 v[196:199], v2, s[24:27], s66 offen offset:1024 sc1
ALT8_back:
    buffer_load_dwordx2 v[70:71], v43, s[24:27], 0 offen sc1
    s_waitcnt vmcnt(5) lgkmcnt(0)
    s_waitcnt lgkmcnt(0)
    s_branch JOIN
    .p2align 3
VAR_G:
    v_lshlrev_b32 v2, 4, v1
    v_and_b32 v4, 31, v1
    v_lshrrev_b32 v5, 5, v1
    v_bfe_u32 v6, v1, 1, 3
    v_xor_b32 v6, v6, v5
    v_lshlrev_b32 v6, 4, v6
    v_lshl_add_u32 v6, v4, 7, v6
    v_add_u32 v22, s58, v6
    v_xor_b32 v23, 32, v22
    v_xor_b32 v24, 64, v22
    v_xor_b32 v25, 96, v22
    v_add_u32 v26, 114688, v22
    v_add_u32 v27, 114688, v23
    v_add_u32 v28, 114688, v24
    v_add_u32 v29, 114688, v25
    v_bfe_u32 v6, v1, 2, 2
    v_bfe_u32 v7, v1, 4, 1
    v_and_b32 v8, 3, v1
    v_lshlrev_b32 v8, 3, v8
    v_lshl_add_u32 v8, v7, 5, v8
    v_lshl_add_u32 v9, v5, 3, v6
    v_lshl_add_u32 v10, v9, 2, v6
    v_lshl_add_u32 v10, v10, 6, v8
    v_add_u32 v30, 49152, v10
    v_xor_b32 v31, 64, v30
    v_xor_b32 v32, 128, v30
    v_xor_b32 v33, 192, v30
    s_lshl_b32 s59, s46, 11
    s_lshl_b32 s60, s46, 10
    v_mov_b32 v9, 0x40000000
    v_cmp_eq_u32 vcc, 63, v1
    s_getreg_b32 s83, hwreg(HW_REG_XCC_ID)
    s_mov_b32 s81, 0
    v_cndmask_b32 v41, v9, 0, vcc
    v_lshl_add_u32 v9, v5, 3, v6
    s_and_b32 s84, s2, 7
    s_lshl_b32 s84, s84, 5
    s_add_u32 s84, s84, s48
    s_lshl3_add_u32 s84, s84, 0xe4c000
    s_mov_b32 s34, 0x100
    s_mov_b32 s35, s7
    s_mov_b32 s38, 0x400
    s_mov_b32 s39, s7
    s_mov_b32 s14, 0x158000
    s_mov_b32 s15, s7
    s_mov_b32 s30, 0x200000
    s_mov_b32 s31, s7
    v_lshrrev_b32 v10, 1, v6
    v_lshl_add_u32 v10, v9, 1, v10
    v_lshl_add_u32 v10, v10, 6, v8
    v_add_u32 v34, 49152, v10
    v_xor_b32 v35, 64, v34
    v_lshl_add_u32 v10, v9, 6, v8
    v_add_u32 v40, 131072, v10
    v_lshlrev_b32 v10, 2, v7
    v_xor_b32 v10, v10, v1
    v_and_b32 v10, 7, v10
    v_lshlrev_b32 v10, 4, v10
    v_lshrrev_b32 v11, 3, v1
    v_lshl_add_u32 v50, v11, 10, v10
    s_lshl_b32 s52, s46, 4
    v_add_u32 v11, s52, v11
    s_mul_i32 s53, s51, 3
    s_add_u32 s53, s53, s50
    s_mul_i32 s54, s47, 5
    s_add_u32 s53, s53, s54
    s_lshl_b32 s54, s53, 7
    v_add_u32 v10, s54, v10
    s_movk_i32 s55, 2752
    v_mad_u32_u24 v20, v11, s55, v10
    v_lshrrev_b32 v11, 2, v1
    v_add_u32 v11, s52, v11
    v_and_b32 v10, 3, v1
    s_bfe_u32 s56, s57, 0x30004
    s_lshl_b32 s62, s56, 7
    s_mul_i32 s63, s56, s61
    s_add_u32 m0, s58, 65536
    s_nop 0
    buffer_load_dwordx4 v16, s[8:11], s63 offen offset:0  lds
    buffer_load_dwordx4 v17, s[8:11], s63 offen offset:1024  lds
    buffer_load_dwordx4 v18, s[8:11], s63 offen offset:2048  lds
    buffer_load_dwordx4 v19, s[8:11], s63 offen offset:3072  lds
    s_add_u32 m0, s58, 16384
    s_nop 0
    buffer_load_dwordx4 v12, s[4:7], s62 offen offset:0  lds
    buffer_load_dwordx4 v13, s[4:7], s62 offen offset:1024  lds
    buffer_load_dwordx4 v14, s[4:7], s62 offen offset:2048  lds
    buffer_load_dwordx4 v15, s[4:7], s62 offen offset:3072  lds
    s_waitcnt vmcnt(11)
    s_waitcnt lgkmcnt(0)
    s_barrier
    ds_read_b128 a[0:3], v22 offset:0
    ds_read_b64_tr_b16 v[220:221], v30 offset:0
    ds_read_b64_tr_b16 v[222:223], v30 offset:1024
    ds_read_b64_tr_b16 v[224:225], v31 offset:0
    ds_read_b64_tr_b16 v[226:227], v31 offset:1024
    ds_read_b64_tr_b16 v[228:229], v32 offset:0
    ds_read_b64_tr_b16 v[230:231], v32 offset:1024
    ds_read_b64_tr_b16 v[232:233], v33 offset:0
    ds_read_b64_tr_b16 v[234:235], v33 offset:1024
    ds_read_b128 a[4:7], v23 offset:0
    ds_read_b64_tr_b16 v[236:237], v30 offset:4096
    ds_read_b64_tr_b16 v[238:239], v30 offset:5120
    ds_read_b64_tr_b16 v[240:241], v31 offset:4096
    ds_read_b64_tr_b16 v[242:243], v31 offset:5120
    .p2align 3
    s_waitcnt lgkmcnt(9)
    v_mfma_f32_32x32x16_bf16 v[124:139], v[220:223], a[0:3], 0
    ds_read_b64_tr_b16 v[244:245], v32 offset:4096
    ds_read_b64_tr_b16 v[246:247], v32 offset:5120
    s_bfe_u32 s56, s57, 0x30008
    s_lshl_b32 s62, s56, 7
    s_mul_i32 s63, s56, s61
    s_add_u32 m0, s58, 81920
    s_nop 0
    buffer_load_dwordx4 v16, s[8:11], s63 offen offset:0  lds
    s_mul_i32 s54, s51, 320
    v_mfma_f32_32x32x16_bf16 v[140:155], v[224:227], a[0:3], 0
    ds_read_b64_tr_b16 v[248:249], v33 offset:4096
    ds_read_b64_tr_b16 v[250:251], v33 offset:5120
    buffer_load_dwordx4 v17, s[8:11], s63 offen offset:1024  lds
    s_mul_i32 s52, s47, 768
    s_waitcnt lgkmcnt(9)
    v_mfma_f32_32x32x16_bf16 v[156:171], v[228:231], a[0:3], 0
    ds_read_b128 a[8:11], v24 offset:0
    ds_read_b64_tr_b16 v[220:221], v30 offset:8192
    ds_read_b64_tr_b16 v[222:223], v30 offset:9216
    buffer_load_dwordx4 v18, s[8:11], s63 offen offset:2048  lds
    s_addk_i32 s54, 1024
    v_mfma_f32_32x32x16_bf16 v[172:187], v[232:235], a[0:3], 0
    ds_read_b64_tr_b16 v[224:225], v31 offset:8192
    ds_read_b64_tr_b16 v[226:227], v31 offset:9216
    buffer_load_dwordx4 v19, s[8:11], s63 offen offset:3072  lds
    s_add_u32 s54, s54, s52
    s_waitcnt lgkmcnt(9)
    v_mfma_f32_32x32x16_bf16 v[124:139], v[236:239], a[4:7], v[124:139]
    ds_read_b64_tr_b16 v[228:229], v32 offset:8192
    ds_read_b64_tr_b16 v[230:231], v32 offset:9216
    v_lshl_add_u32 v10, v10, 4, s54
    v_mad_u32_u24 v21, v11, s55, v10
    v_lshrrev_b32 v34, 5, v1
    s_add_u32 s56, s60, 131072
    v_lshl_add_u32 v34, v34, 4, s56
    v_mfma_f32_32x32x16_bf16 v[140:155], v[240:243], a[4:7], v[140:155]
    ds_read_b64_tr_b16 v[232:233], v33 offset:8192
    ds_read_b64_tr_b16 v[234:235], v33 offset:9216
    s_add_u32 m0, s58, 114688
    s_nop 0
    buffer_load_dwordx4 v12, s[4:7], s62 offen offset:0  lds
    s_lshl_b32 s53, s53, 1
    s_waitcnt lgkmcnt(9)
    v_mfma_f32_32x32x16_bf16 v[156:171], v[244:247], a[4:7], v[156:171]
    ds_read_b128 a[12:15], v25 offset:0
    ds_read_b64_tr_b16 v[236:237], v30 offset:12288
    ds_read_b64_tr_b16 v[238:239], v30 offset:13312
    buffer_load_dwordx4 v13, s[4:7], s62 offen offset:1024  lds
    s_mul_i32 s54, s51, 5
    v_mfma_f32_32x32x16_bf16 v[172:187], v[248:251], a[4:7], v[172:187]
    ds_read_b64_tr_b16 v[240:241], v31 offset:12288
    ds_read_b64_tr_b16 v[242:243], v31 offset:13312
    buffer_load_dwordx4 v14, s[4:7], s62 offen offset:2048  lds
    s_mul_i32 s55, s47, 12
    s_waitcnt lgkmcnt(9)
    v_mfma_f32_32x32x16_bf16 v[124:139], v[220:223], a[8:11], v[124:139]
    ds_read_b64_tr_b16 v[244:245], v32 offset:12288
    ds_read_b64_tr_b16 v[246:247], v32 offset:13312
    buffer_load_dwordx4 v15, s[4:7], s62 offen offset:3072  lds
    s_add_u32 s54, s54, s55
    v_mfma_f32_32x32x16_bf16 v[140:155], v[224:227], a[8:11], v[140:155]
    ds_read_b64_tr_b16 v[248:249], v33 offset:12288
    ds_read_b64_tr_b16 v[250:251], v33 offset:13312
    s_add_u32 s54, s54, 12
    s_cmp_eq_u32 s50, 3
    s_cselect_b32 s53, s54, s53
    s_waitcnt lgkmcnt(9)
    v_mfma_f32_32x32x16_bf16 v[156:171], v[228:231], a[8:11], v[156:171]
    s_waitcnt vmcnt(8)
    s_barrier
    ds_read_b128 a[16:19], v22 offset:16384
    ds_read_b64_tr_b16 v[220:221], v30 offset:16384
    ds_read_b64_tr_b16 v[222:223], v30 offset:17408
    s_bfe_u32 s56, s57, 0x3000c
    s_lshl_b32 s62, s56, 7
    s_mul_i32 s63, s56, s61
    s_add_u32 m0, s58, 98304
    s_nop 0
    buffer_load_dwordx4 v16, s[8:11], s63 offen offset:0  lds
    s_lshl2_add_u32 s40, s49, s46
    v_mfma_f32_32x32x16_bf16 v[172:187], v[232:235], a[8:11], v[172:187]
    ds_read_b64_tr_b16 v[224:225], v31 offset:16384
    ds_read_b64_tr_b16 v[226:227], v31 offset:17408
    v_add_u32 v72, 1, v70
    v_mov_b32 v73, v71
    v_mov_b32 v74, 1
    v_mov_b32 v75, 0
    buffer_store_dwordx4 v[72:75], v41, s[32:35], s90 offen sc1
    buffer_store_dwordx2 v[72:73], v41, s[24:27], s91 offen sc1
    s_mul_i32 s54, s40, 44
    s_waitcnt lgkmcnt(9)
    v_mfma_f32_32x32x16_bf16 v[124:139], v[236:239], a[12:15], v[124:139]
    ds_read_b64_tr_b16 v[228:229], v32 offset:16384
    ds_read_b64_tr_b16 v[230:231], v32 offset:17408
    buffer_load_dwordx4 v17, s[8:11], s63 offen offset:1024  lds
    s_add_u32 s53, s53, s54
    v_mfma_f32_32x32x16_bf16 v[140:155], v[240:243], a[12:15], v[140:155]
    ds_read_b64_tr_b16 v[232:233], v33 offset:16384
    ds_read_b64_tr_b16 v[234:235], v33 offset:17408
    s_lshl_b32 s53, s53, 11
    s_add_u32 s66, s53, 0x600000
    s_waitcnt lgkmcnt(9)
    v_mfma_f32_32x32x16_bf16 v[156:171], v[244:247], a[12:15], v[156:171]
    ds_read_b128 a[20:23], v23 offset:16384
    ds_read_b64_tr_b16 v[236:237], v30 offset:20480
    ds_read_b64_tr_b16 v[238:239], v30 offset:21504
    buffer_load_dwordx4 v18, s[8:11], s63 offen offset:2048  lds
    buffer_load_dword v55, v78, s[16:19], 0 offen
    s_lshl_b32 s67, s40, 9
    v_mfma_f32_32x32x16_bf16 v[172:187], v[248:251], a[12:15], v[172:187]
    ds_read_b64_tr_b16 v[240:241], v31 offset:20480
    ds_read_b64_tr_b16 v[242:243], v31 offset:21504
    s_add_u32 s67, s67, 0xe00000
    s_lshl_b32 s54, s50, 21
    s_waitcnt lgkmcnt(9)
    v_mfma_f32_32x32x16_bf16 v[124:139], v[220:223], a[16:19], v[124:139]
    ds_read_b64_tr_b16 v[244:245], v32 offset:20480
    ds_read_b64_tr_b16 v[246:247], v32 offset:21504
    buffer_load_dwordx4 v19, s[8:11], s63 offen offset:3072  lds
    s_lshl_b32 s55, s51, 19
    v_mfma_f32_32x32x16_bf16 v[140:155], v[224:227], a[16:19], v[140:155]
    ds_read_b64_tr_b16 v[248:249], v33 offset:20480
    ds_read_b64_tr_b16 v[250:251], v33 offset:21504
    s_add_u32 s54, s54, s55
    s_lshl_b32 s55, s40, 10
    s_waitcnt lgkmcnt(9)
    v_mfma_f32_32x32x16_bf16 v[156:171], v[228:231], a[16:19], v[156:171]
    ds_read_b128 a[24:27], v24 offset:16384
    ds_read_b64_tr_b16 v[220:221], v30 offset:24576
    ds_read_b64_tr_b16 v[222:223], v30 offset:25600
    s_add_u32 m0, s58, 32768
    s_nop 0
    buffer_load_dwordx4 v12, s[4:7], s62 offen offset:0  lds
    s_add_u32 s65, s54, s55
    v_mfma_f32_32x32x16_bf16 v[172:187], v[232:235], a[16:19], v[172:187]
    ds_read_b64_tr_b16 v[224:225], v31 offset:24576
    ds_read_b64_tr_b16 v[226:227], v31 offset:25600
    s_mov_b32 s42, 0x3eb8aa3b
    s_cmp_eq_u32 s50, 0
    s_cselect_b32 s42, s42, 1.0
    s_waitcnt lgkmcnt(9)
    v_mfma_f32_32x32x16_bf16 v[124:139], v[236:239], a[20:23], v[124:139]
    ds_read_b64_tr_b16 v[228:229], v32 offset:24576
    ds_read_b64_tr_b16 v[230:231], v32 offset:25600
    buffer_load_dwordx4 v13, s[4:7], s62 offen offset:1024  lds
    s_mov_b32 s43, s42
    v_mfma_f32_32x32x16_bf16 v[140:155], v[240:243], a[20:23], v[140:155]
    ds_read_b64_tr_b16 v[232:233], v33 offset:24576
    ds_read_b64_tr_b16 v[234:235], v33 offset:25600
    s_mov_b32 s44, 0xbfb8aa3b
    s_mov_b32 s45, s44
    s_waitcnt lgkmcnt(9)
    v_mfma_f32_32x32x16_bf16 v[156:171], v[244:247], a[20:23], v[156:171]
    ds_read_b128 a[28:31], v25 offset:16384
    ds_read_b64_tr_b16 v[236:237], v30 offset:28672
    ds_read_b64_tr_b16 v[238:239], v30 offset:29696
    buffer_load_dwordx4 v14, s[4:7], s62 offen offset:2048  lds
    s_and_b32 s54, s49, 3
    v_mfma_f32_32x32x16_bf16 v[172:187], v[248:251], a[20:23], v[172:187]
    ds_read_b64_tr_b16 v[240:241], v31 offset:28672
    ds_read_b64_tr_b16 v[242:243], v31 offset:29696
    s_lshr_b32 s54, s54, 1
    s_add_u32 s55, s50, 1
    s_waitcnt lgkmcnt(9)
    v_mfma_f32_32x32x16_bf16 v[124:139], v[220:223], a[24:27], v[124:139]
    ds_read_b64_tr_b16 v[244:245], v32 offset:28672
    ds_read_b64_tr_b16 v[246:247], v32 offset:29696
    buffer_load_dwordx4 v15, s[4:7], s62 offen offset:3072  lds
    s_bfe_u32 s55, s55, 0x10001
    v_mfma_f32_32x32x16_bf16 v[140:155], v[224:227], a[24:27], v[140:155]
    ds_read_b64_tr_b16 v[248:249], v33 offset:28672
    ds_read_b64_tr_b16 v[250:251], v33 offset:29696
    s_and_b32 s54, s54, s55
    s_cmp_lt_u32 s49, 12
    s_cselect_b32 s82, s54, 0
    s_waitcnt lgkmcnt(9)
    v_mfma_f32_32x32x16_bf16 v[156:171], v[228:231], a[24:27], v[156:171]
    s_waitcnt vmcnt(11)
    s_barrier
    ds_read_b128 a[32:35], v26
    ds_read_b64_tr_b16 v[220:221], v30 offset:32768
    ds_read_b64_tr_b16 v[222:223], v30 offset:33792
    s_bfe_u32 s56, s57, 0x30010
    s_lshl_b32 s62, s56, 7
    s_mul_i32 s63, s56, s61
    s_add_u32 m0, s58, 49152
    s_nop 0
    buffer_load_dwordx4 v16, s[8:11], s63 offen offset:0  lds
    s_and_b32 s54, s48, 7
    v_mfma_f32_32x32x16_bf16 v[172:187], v[232:235], a[24:27], v[172:187]
    ds_read_b64_tr_b16 v[224:225], v31 offset:32768
    ds_read_b64_tr_b16 v[226:227], v31 offset:33792
    s_lshl_b32 s55, s54, 7
    v_add_u32 v50, s55, v50
    s_waitcnt lgkmcnt(9)
    v_mfma_f32_32x32x16_bf16 v[124:139], v[236:239], a[28:31], v[124:139]
    ds_read_b64_tr_b16 v[228:229], v32 offset:32768
    ds_read_b64_tr_b16 v[230:231], v32 offset:33792
    buffer_load_dwordx4 v17, s[8:11], s63 offen offset:1024  lds
    s_lshl_b32 s55, s49, 1
    v_mfma_f32_32x32x16_bf16 v[140:155], v[240:243], a[28:31], v[140:155]
    ds_read_b64_tr_b16 v[232:233], v33 offset:32768
    ds_read_b64_tr_b16 v[234:235], v33 offset:33792
    s_xor_b32 s55, s55, s54
    s_and_b32 s76, s55, 7
    s_waitcnt lgkmcnt(9)
    v_mfma_f32_32x32x16_bf16 v[156:171], v[244:247], a[28:31], v[156:171]
    ds_read_b128 a[36:39], v27
    ds_read_b64_tr_b16 v[236:237], v30 offset:36864
    ds_read_b64_tr_b16 v[238:239], v30 offset:37888
    buffer_load_dwordx4 v18, s[8:11], s63 offen offset:2048  lds
    s_and_b32 s55, s76, 0
    v_mfma_f32_32x32x16_bf16 v[172:187], v[248:251], a[28:31], v[172:187]
    ds_read_b64_tr_b16 v[240:241], v31 offset:36864
    ds_read_b64_tr_b16 v[242:243], v31 offset:37888
    s_lshl_b32 s75, s55, 12
    s_lshl_b32 s55, s55, 1
    s_waitcnt lgkmcnt(9)
    v_mfma_f32_32x32x16_bf16 v[124:139], v[220:223], a[32:35], v[124:139]
    ds_read_b64_tr_b16 v[244:245], v32 offset:36864
    ds_read_b64_tr_b16 v[246:247], v32 offset:37888
    buffer_load_dwordx4 v19, s[8:11], s63 offen offset:3072  lds
    s_xor_b32 s55, s55, s46
    v_mfma_f32_32x32x16_bf16 v[140:155], v[224:227], a[32:35], v[140:155]
    ds_read_b64_tr_b16 v[248:249], v33 offset:36864
    ds_read_b64_tr_b16 v[250:251], v33 offset:37888
    s_lshl_b32 s77, s55, 15
    s_and_b32 s76, s76, 0
    s_waitcnt lgkmcnt(9)
    v_mfma_f32_32x32x16_bf16 v[156:171], v[228:231], a[32:35], v[156:171]
    ds_read_b128 a[40:43], v28
    ds_read_b64_tr_b16 v[220:221], v30 offset:40960
    ds_read_b64_tr_b16 v[222:223], v30 offset:41984
    s_mov_b32 m0, s58
    s_nop 0
    buffer_load_dwordx4 v12, s[4:7], s62 offen offset:0  lds
    v_add_u32 v51, 7168, v50
    v_mfma_f32_32x32x16_bf16 v[172:187], v[232:235], a[32:35], v[172:187]
    ds_read_b64_tr_b16 v[224:225], v31 offset:40960
    ds_read_b64_tr_b16 v[226:227], v31 offset:41984
    v_add_u32 v52, 7168, v51
    v_add_u32 v53, 7168, v52
    s_waitcnt lgkmcnt(9)
    v_mfma_f32_32x32x16_bf16 v[124:139], v[236:239], a[36:39], v[124:139]
    ds_read_b64_tr_b16 v[228:229], v32 offset:40960
    ds_read_b64_tr_b16 v[230:231], v32 offset:41984
    buffer_load_dwordx4 v13, s[4:7], s62 offen offset:1024  lds
    s_lshl2_add_u32 s52, s49, s51
    v_mfma_f32_32x32x16_bf16 v[140:155], v[240:243], a[36:39], v[140:155]
    ds_read_b64_tr_b16 v[232:233], v33 offset:40960
    ds_read_b64_tr_b16 v[234:235], v33 offset:41984
    s_lshl_b32 s52, s52, 4
    s_add_u32 s52, s52, s46
    s_waitcnt lgkmcnt(9)
    v_mfma_f32_32x32x16_bf16 v[156:171], v[244:247], a[36:39], v[156:171]
    ds_read_b128 a[44:47], v29
    ds_read_b64_tr_b16 v[236:237], v30 offset:45056
    ds_read_b64_tr_b16 v[238:239], v30 offset:46080
    buffer_load_dwordx4 v14, s[4:7], s62 offen offset:2048  lds
    s_lshl_b32 s53, s50, 2
    v_mfma_f32_32x32x16_bf16 v[172:187], v[248:251], a[36:39], v[172:187]
    ds_read_b64_tr_b16 v[240:241], v31 offset:45056
    ds_read_b64_tr_b16 v[242:243], v31 offset:46080
    s_add_u32 s53, s53, 1020
    s_cmp_eq_u32 s50, 0
    s_cselect_b32 s53, 0, s53
    s_waitcnt lgkmcnt(9)
    v_mfma_f32_32x32x16_bf16 v[124:139], v[220:223], a[40:43], v[124:139]
    ds_read_b64_tr_b16 v[244:245], v32 offset:45056
    ds_read_b64_tr_b16 v[246:247], v32 offset:46080
    buffer_load_dwordx4 v15, s[4:7], s62 offen offset:3072  lds
    s_add_u32 s52, s52, s53
    v_mfma_f32_32x32x16_bf16 v[140:155], v[224:227], a[40:43], v[140:155]
    ds_read_b64_tr_b16 v[248:249], v33 offset:45056
    ds_read_b64_tr_b16 v[250:251], v33 offset:46080
    s_lshl3_add_u32 s68, s52, 0xe40000
    s_lshl1_add_u32 s52, s40, s47
    s_waitcnt lgkmcnt(9)
    v_mfma_f32_32x32x16_bf16 v[156:171], v[228:231], a[40:43], v[156:171]
    s_waitcnt vmcnt(8)
    s_barrier
    ds_read_b128 a[48:51], v22 offset:32768
    ds_read_b64_tr_b16 v[220:221], v30 offset:49152
    ds_read_b64_tr_b16 v[222:223], v30 offset:50176
    s_bfe_u32 s56, s57, 0x30014
    s_lshl_b32 s62, s56, 7
    s_mul_i32 s63, s56, s61
    s_add_u32 m0, s58, 65536
    s_nop 0
    buffer_load_dwordx4 v16, s[8:11], s63 offen offset:0  lds
    s_lshl_b32 s52, s52, 7
    v_mfma_f32_32x32x16_bf16 v[172:187], v[232:235], a[40:43], v[172:187]
    ds_read_b64_tr_b16 v[224:225], v31 offset:49152
    ds_read_b64_tr_b16 v[226:227], v31 offset:50176
    buffer_load_dwordx4 v17, s[8:11], s63 offen offset:1024  lds
    buffer_load_dwordx4 v[72:75], off, s[32:35], 0 sc1
    s_add_u32 s52, s52, 0xe44000
    s_waitcnt lgkmcnt(9)
    v_mfma_f32_32x32x16_bf16 v[124:139], v[236:239], a[44:47], v[124:139]
    ds_read_b64_tr_b16 v[228:229], v32 offset:49152
    ds_read_b64_tr_b16 v[230:231], v32 offset:50176
    buffer_load_dwordx4 v18, s[8:11], s63 offen offset:2048  lds
    s_lshl2_add_u32 s80, s54, s52
    v_mfma_f32_32x32x16_bf16 v[140:155], v[240:243], a[44:47], v[140:155]
    ds_read_b64_tr_b16 v[232:233], v33 offset:49152
    ds_read_b64_tr_b16 v[234:235], v33 offset:50176
    buffer_load_dwordx4 v19, s[8:11], s63 offen offset:3072  lds
    v_and_b32 v9, 7, v1
    s_waitcnt lgkmcnt(9)
    v_mfma_f32_32x32x16_bf16 v[156:171], v[244:247], a[44:47], v[156:171]
    ds_read_b128 a[52:55], v23 offset:32768
    ds_read_b64_tr_b16 v[236:237], v30 offset:53248
    ds_read_b64_tr_b16 v[238:239], v30 offset:54272
    s_add_u32 m0, s58, 16384
    s_nop 0
    buffer_load_dwordx4 v12, s[4:7], s62 offen offset:0  lds
    v_lshl_add_u32 v44, v9, 2, s52
    v_mfma_f32_32x32x16_bf16 v[172:187], v[248:251], a[44:47], v[172:187]
    ds_read_b64_tr_b16 v[240:241], v31 offset:53248
    ds_read_b64_tr_b16 v[242:243], v31 offset:54272
    buffer_load_dwordx4 v13, s[4:7], s62 offen offset:1024  lds
    s_and_b32 s52, s40, -8
    s_waitcnt lgkmcnt(9)
    v_mfma_f32_32x32x16_bf16 v[124:139], v[220:223], a[48:51], v[124:139]
    ds_read_b64_tr_b16 v[244:245], v32 offset:53248
    ds_read_b64_tr_b16 v[246:247], v32 offset:54272
    buffer_load_dwordx4 v14, s[4:7], s62 offen offset:2048  lds
    s_lshl1_add_u32 s52, s46, s52
    v_mfma_f32_32x32x16_bf16 v[140:155], v[224:227], a[48:51], v[140:155]
    ds_read_b64_tr_b16 v[248:249], v33 offset:53248
    ds_read_b64_tr_b16 v[250:251], v33 offset:54272
    buffer_load_dwordx4 v15, s[4:7], s62 offen offset:3072  lds
    s_add_u32 s52, s52, s47
    s_waitcnt lgkmcnt(9)
    v_mfma_f32_32x32x16_bf16 v[156:171], v[228:231], a[48:51], v[156:171]
    ds_read_b128 a[56:59], v24 offset:32768
    ds_read_b64_tr_b16 v[220:221], v30 offset:57344
    ds_read_b64_tr_b16 v[222:223], v30 offset:58368
    s_bfe_u32 s56, s57, 0x30018
    s_lshl_b32 s62, s56, 7
    s_mul_i32 s63, s56, s61
    s_add_u32 m0, s58, 114688
    s_nop 0
    buffer_load_dwordx4 v12, s[4:7], s62 offen offset:0  lds
    s_lshl_b32 s52, s52, 7
    v_mfma_f32_32x32x16_bf16 v[172:187], v[232:235], a[48:51], v[172:187]
    ds_read_b64_tr_b16 v[224:225], v31 offset:57344
    ds_read_b64_tr_b16 v[226:227], v31 offset:58368
    buffer_load_dwordx4 v13, s[4:7], s62 offen offset:1024  lds
    s_add_u32 s52, s52, 0xe48000
    s_waitcnt lgkmcnt(9)
    v_mfma_f32_32x32x16_bf16 v[124:139], v[236:239], a[52:55], v[124:139]
    ds_read_b64_tr_b16 v[228:229], v32 offset:57344
    ds_read_b64_tr_b16 v[230:231], v32 offset:58368
    buffer_load_dwordx4 v14, s[4:7], s62 offen offset:2048  lds
    v_and_b32 v10, 15, v1
    v_mfma_f32_32x32x16_bf16 v[140:155], v[240:243], a[52:55], v[140:155]
    ds_read_b64_tr_b16 v[232:233], v33 offset:57344
    ds_read_b64_tr_b16 v[234:235], v33 offset:58368
    buffer_load_dwordx4 v15, s[4:7], s62 offen offset:3072  lds
    v_lshl_add_u32 v45, v10, 2, s52
    s_waitcnt lgkmcnt(9)
    v_mfma_f32_32x32x16_bf16 v[156:171], v[244:247], a[52:55], v[156:171]
    ds_read_b128 a[60:63], v25 offset:32768
    ds_read_b64_tr_b16 v[236:237], v30 offset:61440
    ds_read_b64_tr_b16 v[238:239], v30 offset:62464
    s_add_u32 m0, s58, 81920
    s_nop 0
    buffer_load_dwordx4 v16, s[8:11], s63 offen offset:0  lds
    s_lshl1_add_u32 s52, s40, s47
    v_mfma_f32_32x32x16_bf16 v[172:187], v[248:251], a[52:55], v[172:187]
    ds_read_b64_tr_b16 v[240:241], v31 offset:61440
    ds_read_b64_tr_b16 v[242:243], v31 offset:62464
    buffer_load_dwordx4 v17, s[8:11], s63 offen offset:1024  lds
    s_mul_i32 s53, s52, 45056
    s_waitcnt lgkmcnt(9)
    v_mfma_f32_32x32x16_bf16 v[124:139], v[220:223], a[56:59], v[124:139]
    ds_read_b64_tr_b16 v[244:245], v32 offset:61440
    ds_read_b64_tr_b16 v[246:247], v32 offset:62464
    buffer_load_dwordx4 v18, s[8:11], s63 offen offset:2048  lds
    s_add_u32 s53, s53, 0x600000
    v_mfma_f32_32x32x16_bf16 v[140:155], v[224:227], a[56:59], v[140:155]
    ds_read_b64_tr_b16 v[248:249], v33 offset:61440
    ds_read_b64_tr_b16 v[250:251], v33 offset:62464
    buffer_load_dwordx4 v19, s[8:11], s63 offen offset:3072  lds
    v_add_u32 v64, s53, v2
    s_waitcnt lgkmcnt(9)
    v_mfma_f32_32x32x16_bf16 v[156:171], v[228:231], a[56:59], v[156:171]
    s_waitcnt vmcnt(17)
    s_barrier
    ds_read_b128 a[64:67], v22 offset:0
    ds_read_b64_tr_b16 v[220:221], v30 offset:0
    ds_read_b64_tr_b16 v[222:223], v30 offset:1024
    s_bfe_u32 s56, s57, 0x3001c
    s_lshl_b32 s62, s56, 7
    s_mul_i32 s63, s56, s61
    s_add_u32 m0, s58, 32768
    s_nop 0
    buffer_load_dwordx4 v12, s[4:7], s62 offen offset:0  lds
    s_lshl3_add_u32 s52, s52, s76
    v_mfma_f32_32x32x16_bf16 v[172:187], v[232:235], a[56:59], v[172:187]
    ds_read_b64_tr_b16 v[224:225], v31 offset:0
    ds_read_b64_tr_b16 v[226:227], v31 offset:1024
    s_waitcnt vmcnt(15)
    v_cmp_eq_u32 vcc, 0, v74
    s_cbranch_vccnz TAGG_slow
TAGG_back:
    v_mov_b32 v68, v72
    v_add_u32 v69, s83, v73
    buffer_store_dwordx2 v[68:69], v41, s[24:27], s84 offen
    s_lshl_b32 s52, s52, 11
    s_waitcnt lgkmcnt(9)
    v_mfma_f32_32x32x16_bf16 v[124:139], v[236:239], a[60:63], v[124:139]
    ds_read_b64_tr_b16 v[228:229], v32 offset:0
    ds_read_b64_tr_b16 v[230:231], v32 offset:1024
    buffer_load_dwordx4 v13, s[4:7], s62 offen offset:1024  lds
    s_add_u32 s78, s52, 0xc00000
    v_mfma_f32_32x32x16_bf16 v[140:155], v[240:243], a[60:63], v[140:155]
    ds_read_b64_tr_b16 v[232:233], v33 offset:0
    ds_read_b64_tr_b16 v[234:235], v33 offset:1024
    v_lshl_add_u32 v62, v4, 4, s67
    s_lshl_b32 s52, s40, 8
    s_waitcnt lgkmcnt(9)
    v_mfma_f32_32x32x16_bf16 v[156:171], v[244:247], a[60:63], v[156:171]
    ds_read_b128 a[68:71], v23 offset:0
    ds_read_b64_tr_b16 v[236:237], v30 offset:4096
    ds_read_b64_tr_b16 v[238:239], v30 offset:5120
    buffer_load_dwordx4 v14, s[4:7], s62 offen offset:2048  lds
    s_lshl1_add_u32 s53, s54, s47
    v_mfma_f32_32x32x16_bf16 v[172:187], v[248:251], a[60:63], v[172:187]
    ds_read_b64_tr_b16 v[240:241], v31 offset:4096
    ds_read_b64_tr_b16 v[242:243], v31 offset:5120
    s_add_u32 s52, s52, s54
    s_lshl1_add_u32 s52, s52, s47
    s_waitcnt lgkmcnt(9)
    v_mfma_f32_32x32x16_bf16 v[124:139], v[220:223], a[64:67], v[124:139]
    ds_read_b64_tr_b16 v[244:245], v32 offset:4096
    ds_read_b64_tr_b16 v[246:247], v32 offset:5120
    buffer_load_dwordx4 v15, s[4:7], s62 offen offset:3072  lds
    s_lshl_b32 s52, s52, 6
    v_mfma_f32_32x32x16_bf16 v[140:155], v[224:227], a[64:67], v[140:155]
    ds_read_b64_tr_b16 v[248:249], v33 offset:4096
    ds_read_b64_tr_b16 v[250:251], v33 offset:5120
    v_and_b32 v63, 3, v1
    v_lshl_add_u32 v63, v63, 4, s52
    s_waitcnt lgkmcnt(9)
    v_mfma_f32_32x32x16_bf16 v[156:171], v[228:231], a[64:67], v[156:171]
    ds_read_b128 a[72:75], v24 offset:0
    ds_read_b64_tr_b16 v[220:221], v30 offset:8192
    ds_read_b64_tr_b16 v[222:223], v30 offset:9216
    s_add_u32 m0, s58, 98304
    s_nop 0
    buffer_load_dwordx4 v16, s[8:11], s63 offen offset:0  lds
    v_lshrrev_b32 v9, 2, v1
    v_mfma_f32_32x32x16_bf16 v[172:187], v[232:235], a[64:67], v[172:187]
    ds_read_b64_tr_b16 v[224:225], v31 offset:8192
    ds_read_b64_tr_b16 v[226:227], v31 offset:9216
    v_lshl_add_u32 v63, v9, 10, v63
    v_lshrrev_b32 v66, 4, v1
    s_waitcnt lgkmcnt(9)
    v_mfma_f32_32x32x16_bf16 v[124:139], v[236:239], a[68:71], v[124:139]
    ds_read_b64_tr_b16 v[228:229], v32 offset:8192
    ds_read_b64_tr_b16 v[230:231], v32 offset:9216
    buffer_load_dwordx4 v17, s[8:11], s63 offen offset:1024  lds
    v_xor_b32 v66, v66, v1
    v_mfma_f32_32x32x16_bf16 v[140:155], v[240:243], a[68:71], v[140:155]
    ds_read_b64_tr_b16 v[232:233], v33 offset:8192
    ds_read_b64_tr_b16 v[234:235], v33 offset:9216
    v_and_b32 v66, 3, v66
    v_lshlrev_b32 v66, 4, v66
    s_waitcnt lgkmcnt(9)
    v_mfma_f32_32x32x16_bf16 v[156:171], v[244:247], a[68:71], v[156:171]
    ds_read_b128 a[76:79], v25 offset:0
    ds_read_b64_tr_b16 v[236:237], v30 offset:12288
    ds_read_b64_tr_b16 v[238:239], v30 offset:13312
    buffer_load_dwordx4 v18, s[8:11], s63 offen offset:2048  lds
    v_lshl_add_u32 v66, v9, 6, v66
    v_mfma_f32_32x32x16_bf16 v[172:187], v[248:251], a[68:71], v[172:187]
    ds_read_b64_tr_b16 v[240:241], v31 offset:12288
    ds_read_b64_tr_b16 v[242:243], v31 offset:13312
    v_lshl_add_u32 v66, s46, 11, v66
    v_lshrrev_b32 v65, 2, v4
    s_waitcnt lgkmcnt(9)
    v_mfma_f32_32x32x16_bf16 v[124:139], v[220:223], a[72:75], v[124:139]
    ds_read_b64_tr_b16 v[244:245], v32 offset:12288
    ds_read_b64_tr_b16 v[246:247], v32 offset:13312
    buffer_load_dwordx4 v19, s[8:11], s63 offen offset:3072  lds
    v_and_b32 v65, 3, v65
    v_mfma_f32_32x32x16_bf16 v[140:155], v[224:227], a[72:75], v[140:155]
    ds_read_b64_tr_b16 v[248:249], v33 offset:12288
    ds_read_b64_tr_b16 v[250:251], v33 offset:13312
    v_lshlrev_b32 v65, 4, v65
    v_lshl_add_u32 v65, v5, 3, v65
    s_waitcnt lgkmcnt(9)
    v_mfma_f32_32x32x16_bf16 v[156:171], v[228:231], a[72:75], v[156:171]
    s_waitcnt vmcnt(17)
    s_barrier
    ds_read_b128 a[80:83], v22 offset:16384
    ds_read_b64_tr_b16 v[220:221], v30 offset:16384
    ds_read_b64_tr_b16 v[222:223], v30 offset:17408
    s_add_u32 m0, s60, 131072
    s_nop 0
    buffer_load_dwordx4 v2, s[36:39], 0 offen lds
    v_lshl_add_u32 v65, v4, 6, v65
    v_mfma_f32_32x32x16_bf16 v[172:187], v[232:235], a[72:75], v[172:187]
    ds_read_b64_tr_b16 v[224:225], v31 offset:16384
    ds_read_b64_tr_b16 v[226:227], v31 offset:17408
    v_lshl_add_u32 v65, s46, 11, v65
    s_lshl4_add_u32 s53, s49, s53
    s_waitcnt lgkmcnt(9)
    v_mfma_f32_32x32x16_bf16 v[124:139], v[236:239], a[76:79], v[124:139]
    ds_read_b64_tr_b16 v[228:229], v32 offset:16384
    ds_read_b64_tr_b16 v[230:231], v32 offset:17408
    s_lshl2_add_u32 s53, s53, s46
    s_lshl_b32 s53, s53, 12
    v_mfma_f32_32x32x16_bf16 v[140:155], v[240:243], a[76:79], v[140:155]
    ds_read_b64_tr_b16 v[232:233], v33 offset:16384
    ds_read_b64_tr_b16 v[234:235], v33 offset:17408
    s_add_u32 s53, s53, 0x1000000
    s_xor_b32 s79, s53, 0x4000
    s_waitcnt lgkmcnt(9)
    v_mfma_f32_32x32x16_bf16 v[156:171], v[244:247], a[76:79], v[156:171]
    ds_read_b128 a[84:87], v23 offset:16384
    ds_read_b64_tr_b16 v[236:237], v30 offset:20480
    ds_read_b64_tr_b16 v[238:239], v30 offset:21504
    v_cmp_gt_u32 vcc, 32, v1
    s_addk_i32 s53, 2048
    v_mov_b32 v9, s53
    v_cndmask_b32 v45, v9, v45, vcc
    v_lshl_add_u32 v9, v5, 2, v6
    v_mfma_f32_32x32x16_bf16 v[172:187], v[248:251], a[76:79], v[172:187]
    ds_read_b64_tr_b16 v[240:241], v31 offset:20480
    ds_read_b64_tr_b16 v[242:243], v31 offset:21504
    v_lshrrev_b32 v11, 1, v6
    v_xor_b32 v11, s47, v11
    s_waitcnt lgkmcnt(9)
    v_mfma_f32_32x32x16_bf16 v[124:139], v[220:223], a[80:83], v[124:139]
    ds_read_b64_tr_b16 v[244:245], v32 offset:20480
    ds_read_b64_tr_b16 v[246:247], v32 offset:21504
    v_lshl_add_u32 v9, v9, 1, v11
    v_lshl_add_u32 v56, v9, 6, v8
    v_add_u32 v57, 0x10000, v56
    v_add_u32 v58, 0x20000, v56
    v_xor_b32 v59, 64, v56
    v_xor_b32 v60, 64, v57
    v_xor_b32 v61, 64, v58
    s_and_b32 s54, s48, 15
    s_lshl4_add_u32 s54, s47, s54
    s_lshr_b32 s41, s49, 1
    s_sub_u32 s52, 7, s46
    s_movk_i32 s53, -1024
    s_cmp_eq_u32 s41, 0
    s_cselect_b32 s85, s52, 12
    s_cselect_b32 s86, 0, 0x3f803f80
    s_cselect_b32 s87, 0, -1
    s_bitcmp1_b32 s41, 0
    s_cselect_b32 s52, s46, s52
    s_cselect_b32 s67, 0x400, s53
    s_and_b32 s87, s87, s67
    s_lshl3_add_u32 s55, s41, s52
    s_lshl_b32 s40, s54, 6
    s_add_u32 s72, s40, s55
    s_lshl_b32 s72, s72, 10
    s_lshl_b32 s55, s55, 5
    s_add_u32 s55, s55, s54
    s_lshl_b32 s55, s55, 10
    s_add_u32 s74, s55, 0xc00000
    s_and_b32 s52, s52, 3
    s_lshl2_add_u32 s55, s41, s52
    s_lshl1_add_u32 s55, s55, s47
    s_lshl_b32 s55, s55, 5
    s_and_b32 s53, s48, 15
    s_add_u32 s55, s55, s53
    s_lshl2_add_u32 s69, s55, 0xe48000
    buffer_load_dword v55, v41, s[24:27], s79 offen offset:2048 sc1
    s_lshr_b32 s54, s54, 3
    v_mfma_f32_32x32x16_bf16 v[140:155], v[224:227], a[80:83], v[140:155]
    ds_read_b64_tr_b16 v[248:249], v33 offset:20480
    ds_read_b64_tr_b16 v[250:251], v33 offset:21504
    s_lshl3_add_u32 s55, s41, s54
    s_lshl4_add_u32 s55, s55, s52
    s_waitcnt lgkmcnt(9)
    v_mfma_f32_32x32x16_bf16 v[156:171], v[228:231], a[80:83], v[156:171]
    ds_read_b128 a[88:91], v24 offset:16384
    ds_read_b64_tr_b16 v[220:221], v30 offset:24576
    ds_read_b64_tr_b16 v[222:223], v30 offset:25600
    v_and_b32 v9, 1, v1
    v_lshl_add_u32 v11, v9, 6, s55
    v_mfma_f32_32x32x16_bf16 v[172:187], v[232:235], a[80:83], v[172:187]
    ds_read_b64_tr_b16 v[224:225], v31 offset:24576
    ds_read_b64_tr_b16 v[226:227], v31 offset:25600
    s_lshl_b32 s52, s46, 1
    s_sub_u32 s53, 7, s52
    s_waitcnt lgkmcnt(9)
    v_mfma_f32_32x32x16_bf16 v[124:139], v[236:239], a[84:87], v[124:139]
    ds_read_b64_tr_b16 v[228:229], v32 offset:24576
    ds_read_b64_tr_b16 v[230:231], v32 offset:25600
    s_sub_u32 s52, s52, 8
    s_bitcmp1_b32 s41, 0
    s_cselect_b32 s52, s52, s53
    v_mfma_f32_32x32x16_bf16 v[140:155], v[240:243], a[84:87], v[140:155]
    ds_read_b64_tr_b16 v[232:233], v33 offset:24576
    ds_read_b64_tr_b16 v[234:235], v33 offset:25600
    s_lshl3_add_u32 s52, s41, s52
    s_add_u32 s40, s40, s52
    s_waitcnt lgkmcnt(9)
    v_mfma_f32_32x32x16_bf16 v[156:171], v[244:247], a[84:87], v[156:171]
    ds_read_b128 a[92:95], v25 offset:16384
    ds_read_b64_tr_b16 v[236:237], v30 offset:28672
    ds_read_b64_tr_b16 v[238:239], v30 offset:29696
    s_lshl_b32 s40, s40, 10
    s_add_u32 s70, s40, 0x200000
    v_mfma_f32_32x32x16_bf16 v[172:187], v[248:251], a[84:87], v[172:187]
    ds_read_b64_tr_b16 v[240:241], v31 offset:28672
    ds_read_b64_tr_b16 v[242:243], v31 offset:29696
    s_add_u32 s71, s40, 0x400000
    s_and_b32 s53, s52, -4
    s_waitcnt lgkmcnt(9)
    v_mfma_f32_32x32x16_bf16 v[124:139], v[220:223], a[88:91], v[124:139]
    ds_read_b64_tr_b16 v[244:245], v32 offset:28672
    ds_read_b64_tr_b16 v[246:247], v32 offset:29696
    s_add_u32 s53, s53, s54
    s_and_b32 s52, s52, 2
    v_mfma_f32_32x32x16_bf16 v[140:155], v[224:227], a[88:91], v[140:155]
    ds_read_b64_tr_b16 v[248:249], v33 offset:28672
    ds_read_b64_tr_b16 v[250:251], v33 offset:29696
    s_lshl4_add_u32 s53, s53, s52
    s_addk_i32 s53, 1024
    s_waitcnt lgkmcnt(9)
    v_mfma_f32_32x32x16_bf16 v[156:171], v[228:231], a[88:91], v[156:171]
    s_waitcnt vmcnt(11)
    s_barrier
    ds_read_b128 a[96:99], v26
    ds_read_b64_tr_b16 v[220:221], v30 offset:32768
    ds_read_b64_tr_b16 v[222:223], v30 offset:33792
    v_and_b32 v77, 31, v1
    s_andn2_b32 s84, s84, 0xff
    v_lshlrev_b32 v77, 3, v77
    buffer_load_dwordx2 v[70:71], v77, s[24:27], s84 offen sc1
    v_and_b32 v42, 2, v1
    v_mfma_f32_32x32x16_bf16 v[172:187], v[232:235], a[88:91], v[172:187]
    ds_read_b64_tr_b16 v[224:225], v31 offset:32768
    ds_read_b64_tr_b16 v[226:227], v31 offset:33792
    v_lshl_add_u32 v43, v42, 1, v9
    v_add_u32 v43, s53, v43
    s_waitcnt lgkmcnt(9)
    v_mfma_f32_32x32x16_bf16 v[124:139], v[236:239], a[92:95], v[124:139]
    ds_read_b64_tr_b16 v[228:229], v32 offset:32768
    ds_read_b64_tr_b16 v[230:231], v32 offset:33792
    s_mul_i32 s73, s46, 2080
    v_mul_u32_u24 v9, 1040, v9
    v_mfma_f32_32x32x16_bf16 v[140:155], v[240:243], a[92:95], v[140:155]
    ds_read_b64_tr_b16 v[232:233], v33 offset:32768
    ds_read_b64_tr_b16 v[234:235], v33 offset:33792
    s_movk_i32 s55, 4160
    v_mad_u32_u24 v9, v42, s55, v9
    s_waitcnt lgkmcnt(9)
    v_mfma_f32_32x32x16_bf16 v[156:171], v[244:247], a[92:95], v[156:171]
    ds_read_b128 a[100:103], v27
    ds_read_b64_tr_b16 v[236:237], v30 offset:36864
    ds_read_b64_tr_b16 v[238:239], v30 offset:37888
    s_add_u32 s73, s73, 16384
    s_add_u32 s55, s73, 1024
    v_mfma_f32_32x32x16_bf16 v[172:187], v[248:251], a[92:95], v[172:187]
    ds_read_b64_tr_b16 v[240:241], v31 offset:36864
    ds_read_b64_tr_b16 v[242:243], v31 offset:37888
    v_add_u32 v49, s55, v9
    v_mov_b32 v9, s86
    s_waitcnt lgkmcnt(9)
    v_mfma_f32_32x32x16_bf16 v[124:139], v[220:223], a[96:99], v[124:139]
    ds_read_b64_tr_b16 v[244:245], v32 offset:36864
    ds_read_b64_tr_b16 v[246:247], v32 offset:37888
    v_cmp_eq_u32 vcc, 0, v42
    v_mov_b32 v80, 0x3f803f80
    s_mov_b32 s55, 0xe40000
    v_cndmask_b32 v80, v9, v80, vcc
    v_mov_b32 v81, v80
    v_mfma_f32_32x32x16_bf16 v[140:155], v[224:227], a[96:99], v[140:155]
    ds_read_b64_tr_b16 v[248:249], v33 offset:36864
    ds_read_b64_tr_b16 v[250:251], v33 offset:37888
    v_mov_b32 v82, v80
    v_mov_b32 v83, v80
    s_waitcnt lgkmcnt(9)
    v_mfma_f32_32x32x16_bf16 v[156:171], v[228:231], a[96:99], v[156:171]
    ds_read_b128 a[104:107], v28
    ds_read_b64_tr_b16 v[220:221], v30 offset:40960
    ds_read_b64_tr_b16 v[222:223], v30 offset:41984
    v_cmp_gt_u32 vcc, 32, v1
    v_add_u32 v46, s60, v2
    s_add_u32 s87, s87, s55
    v_cndmask_b32 v9, v11, v43, vcc
    v_lshl_add_u32 v42, v9, 3, s55
    v_mfma_f32_32x32x16_bf16 v[172:187], v[232:235], a[96:99], v[172:187]
    ds_read_b64_tr_b16 v[224:225], v31 offset:40960
    ds_read_b64_tr_b16 v[226:227], v31 offset:41984
    v_lshl_add_u32 v43, v43, 3, s87
    v_lshlrev_b32 v9, 8, v5
    s_waitcnt lgkmcnt(9)
    v_mfma_f32_32x32x16_bf16 v[124:139], v[236:239], a[100:103], v[124:139]
    ds_read_b64_tr_b16 v[228:229], v32 offset:40960
    ds_read_b64_tr_b16 v[230:231], v32 offset:41984
    v_lshl_add_u32 v9, v10, 4, v9
    v_add_u32 v11, 512, v9
    v_mfma_f32_32x32x16_bf16 v[140:155], v[240:243], a[100:103], v[140:155]
    ds_read_b64_tr_b16 v[232:233], v33 offset:40960
    ds_read_b64_tr_b16 v[234:235], v33 offset:41984
    v_cmp_eq_u32 vcc, 0, v7
    v_mov_b32 v48, 1024
    s_mul_i32 s55, s46, 1040
    v_cndmask_b32 v47, v48, v9, vcc
    v_cndmask_b32 v48, v48, v11, vcc
    v_add_u32 v47, s55, v47
    s_waitcnt lgkmcnt(9)
    v_mfma_f32_32x32x16_bf16 v[156:171], v[244:247], a[100:103], v[156:171]
    ds_read_b128 a[108:111], v29
    ds_read_b64_tr_b16 v[236:237], v30 offset:45056
    ds_read_b64_tr_b16 v[238:239], v30 offset:46080
    v_add_u32 v48, s55, v48
    v_lshl_add_u32 v84, v7, 16, v9
    v_mfma_f32_32x32x16_bf16 v[172:187], v[248:251], a[100:103], v[172:187]
    ds_read_b64_tr_b16 v[240:241], v31 offset:45056
    ds_read_b64_tr_b16 v[242:243], v31 offset:46080
    v_lshlrev_b32 v9, 2, v5
    v_sub_u32 v9, v4, v9
    s_waitcnt lgkmcnt(9)
    v_mfma_f32_32x32x16_bf16 v[124:139], v[220:223], a[104:107], v[124:139]
    ds_read_b64_tr_b16 v[244:245], v32 offset:45056
    ds_read_b64_tr_b16 v[246:247], v32 offset:46080
    v_cvt_f32_i32 v9, v9
    v_cvt_f32_i32 v11, s67
    v_mfma_f32_32x32x16_bf16 v[140:155], v[224:227], a[104:107], v[140:155]
    ds_read_b64_tr_b16 v[248:249], v33 offset:45056
    ds_read_b64_tr_b16 v[250:251], v33 offset:46080
    v_mul_f32 v11, 0x6cc9f2ca, v11
    v_mul_f32 v9, v9, v11
    s_waitcnt lgkmcnt(9)
    v_mfma_f32_32x32x16_bf16 v[156:171], v[228:231], a[104:107], v[156:171]
    s_waitcnt vmcnt(3)
    s_barrier
    ds_read_b128 a[112:115], v22 offset:32768
    ds_read_b64_tr_b16 v[220:221], v30 offset:49152
    ds_read_b64_tr_b16 v[222:223], v30 offset:50176
    v_fmamk_f32 v108, v11, 0x3f000000, v9
    v_min_f32 v92, 0, v108
    v_mfma_f32_32x32x16_bf16 v[172:187], v[232:235], a[104:107], v[172:187]
    ds_read_b128 a[116:119], v23 offset:32768
    ds_read_b64_tr_b16 v[224:225], v30 offset:53248
    ds_read_b64_tr_b16 v[226:227], v30 offset:54272
    v_min_f32 v108, 0, -v108
    v_fmamk_f32 v109, v11, 0xbf000000, v9
    s_waitcnt lgkmcnt(10)
    v_mfma_f32_32x32x16_bf16 v[124:139], v[236:239], a[108:111], v[124:139]
    ds_read_b128 a[120:123], v24 offset:32768
    ds_read_b64_tr_b16 v[228:229], v30 offset:57344
    ds_read_b64_tr_b16 v[230:231], v30 offset:58368
    v_min_f32 v93, 0, v109
    v_min_f32 v109, 0, -v109
    v_mfma_f32_32x32x16_bf16 v[140:155], v[240:243], a[108:111], v[140:155]
    ds_read_b128 a[124:127], v25 offset:32768
    ds_read_b64_tr_b16 v[232:233], v30 offset:61440
    ds_read_b64_tr_b16 v[234:235], v30 offset:62464
    v_fmamk_f32 v110, v11, 0xbfc00000, v9
    v_min_f32 v94, 0, v110
    s_waitcnt lgkmcnt(12)
    v_mfma_f32_32x32x16_bf16 v[156:171], v[244:247], a[108:111], v[156:171]
    ds_read_b64_tr_b16 v[236:237], v31 offset:49152
    ds_read_b64_tr_b16 v[238:239], v31 offset:50176
    v_min_f32 v110, 0, -v110
    v_fmamk_f32 v111, v11, 0xc0200000, v9
    v_mfma_f32_32x32x16_bf16 v[172:187], v[248:251], a[108:111], v[172:187]
    ds_read_b64_tr_b16 v[240:241], v31 offset:53248
    ds_read_b64_tr_b16 v[242:243], v31 offset:54272
    v_min_f32 v95, 0, v111
    v_min_f32 v111, 0, -v111
    s_waitcnt lgkmcnt(10)
    v_mfma_f32_32x32x16_bf16 v[124:139], v[220:223], a[112:115], v[124:139]
    ds_read_b64_tr_b16 v[244:245], v31 offset:57344
    ds_read_b64_tr_b16 v[246:247], v31 offset:58368
    v_fmamk_f32 v112, v11, 0xc0f00000, v9
    v_min_f32 v96, 0, v112
    v_mfma_f32_32x32x16_bf16 v[124:139], v[224:227], a[116:119], v[124:139]
    ds_read_b64_tr_b16 v[248:249], v31 offset:61440
    ds_read_b64_tr_b16 v[250:251], v31 offset:62464
    v_min_f32 v112, 0, -v112
    v_fmamk_f32 v113, v11, 0xc1080000, v9
    s_waitcnt lgkmcnt(8)
    v_mfma_f32_32x32x16_bf16 v[124:139], v[228:231], a[120:123], v[124:139]
    ds_read_b64_tr_b16 v[220:221], v32 offset:49152
    ds_read_b64_tr_b16 v[222:223], v32 offset:50176
    v_min_f32 v97, 0, v113
    v_min_f32 v113, 0, -v113
    v_mfma_f32_32x32x16_bf16 v[124:139], v[232:235], a[124:127], v[124:139]
    ds_read_b64_tr_b16 v[224:225], v32 offset:53248
    ds_read_b64_tr_b16 v[226:227], v32 offset:54272
    v_fmamk_f32 v114, v11, 0xc1180000, v9
    v_min_f32 v98, 0, v114
    s_waitcnt vmcnt(0)
    v_cmp_ne_u64 vcc, v[70:71], v[68:69]
    s_cbranch_vccnz CHKG_slow
CHKG_back:
    s_or_b32 s82, s82, s81
    s_waitcnt lgkmcnt(8)
    v_mfma_f32_32x32x16_bf16 v[140:155], v[236:239], a[112:115], v[140:155]
    ds_read_b64_tr_b16 v[228:229], v32 offset:57344
    ds_read_b64_tr_b16 v[230:231], v32 offset:58368
    v_min_f32 v114, 0, -v114
    v_fmamk_f32 v115, v11, 0xc1280000, v9
    v_mfma_f32_32x32x16_bf16 v[140:155], v[240:243], a[116:119], v[140:155]
    ds_read_b64_tr_b16 v[232:233], v32 offset:61440
    ds_read_b64_tr_b16 v[234:235], v32 offset:62464
    v_min_f32 v99, 0, v115
    v_min_f32 v115, 0, -v115
    s_waitcnt lgkmcnt(8)
    v_mfma_f32_32x32x16_bf16 v[140:155], v[244:247], a[120:123], v[140:155]
    ds_read_b64_tr_b16 v[236:237], v33 offset:49152
    ds_read_b64_tr_b16 v[238:239], v33 offset:50176
    v_mul_f32 v204, s44, v124
    v_mul_f32 v205, s44, v125
    v_exp_f32 v204, v204
    v_mfma_f32_32x32x16_bf16 v[140:155], v[248:251], a[124:127], v[140:155]
    ds_read_b64_tr_b16 v[240:241], v33 offset:53248
    ds_read_b64_tr_b16 v[242:243], v33 offset:54272
    v_mul_f32 v206, s44, v126
    v_exp_f32 v205, v205
    s_waitcnt lgkmcnt(8)
    v_mfma_f32_32x32x16_bf16 v[156:171], v[220:223], a[112:115], v[156:171]
    ds_read_b64_tr_b16 v[244:245], v33 offset:57344
    ds_read_b64_tr_b16 v[246:247], v33 offset:58368
    v_add_f32 v204, 1.0, v204
    v_mul_f32 v207, s44, v127
    v_exp_f32 v206, v206
    v_mfma_f32_32x32x16_bf16 v[156:171], v[224:227], a[116:119], v[156:171]
    ds_read_b64_tr_b16 v[248:249], v33 offset:61440
    ds_read_b64_tr_b16 v[250:251], v33 offset:62464
    v_add_f32 v205, 1.0, v205
    v_rcp_f32 v204, v204
    s_waitcnt lgkmcnt(8)
    v_mfma_f32_32x32x16_bf16 v[156:171], v[228:231], a[120:123], v[156:171]
    s_barrier
    s_bfe_u32 s56, s57, 0x30000
    s_lshl_b32 s56, s56, 7
    v_add_u32 v35, s56, v34
    ds_read_b128 v[220:223], v35 offset:0
    v_mul_f32 v208, s44, v128
    v_mfma_f32_32x32x16_bf16 v[156:171], v[232:235], a[124:127], v[156:171]
    ds_read_b128 v[224:227], v35 offset:32
    v_exp_f32 v207, v207
    v_add_f32 v206, 1.0, v206
    s_waitcnt lgkmcnt(6)
    v_mfma_f32_32x32x16_bf16 v[172:187], v[236:239], a[112:115], v[172:187]
    ds_read_b128 v[228:231], v35 offset:64
    v_rcp_f32 v205, v205
    v_mul_f32 v124, v124, v204
    v_mul_f32 v209, s44, v129
    v_mfma_f32_32x32x16_bf16 v[172:187], v[240:243], a[116:119], v[172:187]
    ds_read_b128 v[232:235], v35 offset:96
    v_exp_f32 v208, v208
    v_add_f32 v207, 1.0, v207
    s_waitcnt lgkmcnt(4)
    v_mfma_f32_32x32x16_bf16 v[172:187], v[244:247], a[120:123], v[172:187]
    s_bfe_u32 s56, s57, 0x30004
    s_lshl_b32 s56, s56, 7
    v_add_u32 v35, s56, v34
    ds_read_b128 v[236:239], v35 offset:0
    v_rcp_f32 v206, v206
    v_mfma_f32_32x32x16_bf16 v[172:187], v[248:251], a[124:127], v[172:187]
    ds_read_b128 v[240:243], v35 offset:32
    v_mul_f32 v125, v125, v205
    v_mul_f32 v210, s44, v130
    v_exp_f32 v209, v209
    s_waitcnt lgkmcnt(4)
    v_mfma_f32_32x32x16_bf16 v[188:203], v[220:223], a[0:3], 0
    ds_read_b128 v[244:247], v35 offset:64
    v_add_f32 v208, 1.0, v208
    v_rcp_f32 v207, v207
    v_mul_f32 v126, v126, v206
    v_cvt_pk_bf16_f32 v124, v124, v125
    v_mfma_f32_32x32x16_bf16 v[188:203], v[224:227], a[4:7], v[188:203]
    ds_read_b128 v[248:251], v35 offset:96
    v_mul_f32 v211, s44, v131
    v_exp_f32 v210, v210
    v_add_f32 v209, 1.0, v209
    s_waitcnt lgkmcnt(4)
    v_mfma_f32_32x32x16_bf16 v[188:203], v[228:231], a[8:11], v[188:203]
    s_bfe_u32 s56, s57, 0x30008
    s_lshl_b32 s56, s56, 7
    v_add_u32 v35, s56, v34
    ds_read_b128 v[220:223], v35 offset:0
    s_add_u32 m0, s58, 114688
    s_nop 0
    buffer_load_dwordx4 v50, s[16:19], s77 offen offset:0  lds
    v_mfma_f32_32x32x16_bf16 v[188:203], v[232:235], a[12:15], v[188:203]
    ds_read_b128 v[224:227], v35 offset:32
    v_rcp_f32 v208, v208
    v_mul_f32 v127, v127, v207
    v_mul_f32 v212, s44, v132
    s_waitcnt lgkmcnt(4)
    v_mfma_f32_32x32x16_bf16 v[188:203], v[236:239], a[16:19], v[188:203]
    ds_read_b128 v[228:231], v35 offset:64
    buffer_load_dwordx4 v51, s[16:19], s77 offen offset:1024  lds
    v_exp_f32 v211, v211
    v_add_f32 v210, 1.0, v210
    v_mfma_f32_32x32x16_bf16 v[188:203], v[240:243], a[20:23], v[188:203]
    ds_read_b128 v[232:235], v35 offset:96
    v_rcp_f32 v209, v209
    v_mul_f32 v128, v128, v208
    v_cvt_pk_bf16_f32 v125, v126, v127
    s_waitcnt lgkmcnt(4)
    v_mfma_f32_32x32x16_bf16 v[188:203], v[244:247], a[24:27], v[188:203]
    s_bfe_u32 s56, s57, 0x3000c
    s_lshl_b32 s56, s56, 7
    v_add_u32 v35, s56, v34
    ds_read_b128 v[236:239], v35 offset:0
    buffer_load_dwordx4 v52, s[16:19], s77 offen offset:2048  lds
    v_mul_f32 v213, s44, v133
    v_mfma_f32_32x32x16_bf16 v[188:203], v[248:251], a[28:31], v[188:203]
    ds_read_b128 v[240:243], v35 offset:32
    v_exp_f32 v212, v212
    v_add_f32 v211, 1.0, v211
    s_waitcnt lgkmcnt(4)
    v_mfma_f32_32x32x16_bf16 v[188:203], v[220:223], a[32:35], v[188:203]
    ds_read_b128 v[244:247], v35 offset:64
    buffer_load_dwordx4 v53, s[16:19], s77 offen offset:3072  lds
    v_rcp_f32 v210, v210
    v_mul_f32 v129, v129, v209
    v_mul_f32 v214, s44, v134
    v_mfma_f32_32x32x16_bf16 v[188:203], v[224:227], a[36:39], v[188:203]
    ds_read_b128 v[248:251], v35 offset:96
    v_exp_f32 v213, v213
    v_add_f32 v212, 1.0, v212
    s_waitcnt lgkmcnt(4)
    v_mfma_f32_32x32x16_bf16 v[188:203], v[228:231], a[40:43], v[188:203]
    s_bfe_u32 s56, s57, 0x30010
    s_lshl_b32 s56, s56, 7
    v_add_u32 v35, s56, v34
    ds_read_b128 v[220:223], v35 offset:0
    s_xor_b32 s77, s77, 0x20000
    s_add_u32 m0, s58, 81920
    s_nop 0
    buffer_load_dwordx4 v50, s[16:19], s77 offen offset:0  lds
    v_mfma_f32_32x32x16_bf16 v[188:203], v[232:235], a[44:47], v[188:203]
    ds_read_b128 v[224:227], v35 offset:32
    v_rcp_f32 v211, v211
    v_mul_f32 v130, v130, v210
    v_cvt_pk_bf16_f32 v126, v128, v129
    s_waitcnt lgkmcnt(4)
    v_mfma_f32_32x32x16_bf16 v[188:203], v[236:239], a[48:51], v[188:203]
    ds_read_b128 v[228:231], v35 offset:64
    buffer_load_dwordx4 v51, s[16:19], s77 offen offset:1024  lds
    v_mul_f32 v215, s44, v135
    v_exp_f32 v214, v214
    v_add_f32 v213, 1.0, v213
    v_mfma_f32_32x32x16_bf16 v[188:203], v[240:243], a[52:55], v[188:203]
    ds_read_b128 v[232:235], v35 offset:96
    v_rcp_f32 v212, v212
    v_mul_f32 v131, v131, v211
    v_mul_f32 v216, s44, v136
    s_waitcnt lgkmcnt(4)
    v_mfma_f32_32x32x16_bf16 v[188:203], v[244:247], a[56:59], v[188:203]
    s_bfe_u32 s56, s57, 0x30014
    s_lshl_b32 s56, s56, 7
    v_add_u32 v35, s56, v34
    ds_read_b128 v[236:239], v35 offset:0
    buffer_load_dwordx4 v52, s[16:19], s77 offen offset:2048  lds
    v_mfma_f32_32x32x16_bf16 v[188:203], v[248:251], a[60:63], v[188:203]
    ds_read_b128 v[240:243], v35 offset:32
    v_exp_f32 v215, v215
    v_add_f32 v214, 1.0, v214
    s_waitcnt lgkmcnt(4)
    v_mfma_f32_32x32x16_bf16 v[188:203], v[220:223], a[64:67], v[188:203]
    ds_read_b128 v[244:247], v35 offset:64
    buffer_load_dwordx4 v53, s[16:19], s77 offen offset:3072  lds
    v_rcp_f32 v213, v213
    v_mul_f32 v132, v132, v212
    v_cvt_pk_bf16_f32 v127, v130, v131
    v_mfma_f32_32x32x16_bf16 v[188:203], v[224:227], a[68:71], v[188:203]
    ds_read_b128 v[248:251], v35 offset:96
    v_mul_f32 v217, s44, v137
    v_exp_f32 v216, v216
    v_add_f32 v215, 1.0, v215
    s_waitcnt lgkmcnt(4)
    v_mfma_f32_32x32x16_bf16 v[188:203], v[228:231], a[72:75], v[188:203]
    s_bfe_u32 s56, s57, 0x30018
    s_lshl_b32 s56, s56, 7
    v_add_u32 v35, s56, v34
    ds_read_b128 v[220:223], v35 offset:0
    s_xor_b32 s77, s77, 0x60000
    s_add_u32 m0, s58, 98304
    s_nop 0
    buffer_load_dwordx4 v50, s[16:19], s77 offen offset:0  lds
    v_mfma_f32_32x32x16_bf16 v[188:203], v[232:235], a[76:79], v[188:203]
    ds_read_b128 v[224:227], v35 offset:32
    v_rcp_f32 v214, v214
    v_mul_f32 v133, v133, v213
    v_mul_f32 v218, s44, v138
    s_waitcnt lgkmcnt(4)
    v_mfma_f32_32x32x16_bf16 v[188:203], v[236:239], a[80:83], v[188:203]
    ds_read_b128 v[228:231], v35 offset:64
    buffer_load_dwordx4 v51, s[16:19], s77 offen offset:1024  lds
    v_exp_f32 v217, v217
    v_add_f32 v216, 1.0, v216
    v_mfma_f32_32x32x16_bf16 v[188:203], v[240:243], a[84:87], v[188:203]
    ds_read_b128 v[232:235], v35 offset:96
    v_rcp_f32 v215, v215
    v_mul_f32 v134, v134, v214
    v_cvt_pk_bf16_f32 v132, v132, v133
    s_waitcnt lgkmcnt(4)
    v_mfma_f32_32x32x16_bf16 v[188:203], v[244:247], a[88:91], v[188:203]
    s_bfe_u32 s56, s57, 0x3001c
    s_lshl_b32 s56, s56, 7
    v_add_u32 v35, s56, v34
    ds_read_b128 v[236:239], v35 offset:0
    buffer_load_dwordx4 v52, s[16:19], s77 offen offset:2048  lds
    v_mul_f32 v219, s44, v139
    v_mfma_f32_32x32x16_bf16 v[188:203], v[248:251], a[92:95], v[188:203]
    ds_read_b128 v[240:243], v35 offset:32
    v_exp_f32 v218, v218
    v_add_f32 v217, 1.0, v217
    s_waitcnt lgkmcnt(4)
    v_mfma_f32_32x32x16_bf16 v[188:203], v[220:223], a[96:99], v[188:203]
    ds_read_b128 v[244:247], v35 offset:64
    buffer_load_dwordx4 v53, s[16:19], s77 offen offset:3072  lds
    v_rcp_f32 v216, v216
    v_mul_f32 v135, v135, v215
    v_mfma_f32_32x32x16_bf16 v[188:203], v[224:227], a[100:103], v[188:203]
    ds_read_b128 v[248:251], v35 offset:96
    v_exp_f32 v219, v219
    v_add_f32 v218, 1.0, v218
    s_waitcnt lgkmcnt(4)
    v_mfma_f32_32x32x16_bf16 v[188:203], v[228:231], a[104:107], v[188:203]
    v_rcp_f32 v217, v217
    v_mul_f32 v136, v136, v216
    v_cvt_pk_bf16_f32 v133, v134, v135
    v_add_f32 v219, 1.0, v219
    v_mfma_f32_32x32x16_bf16 v[188:203], v[232:235], a[108:111], v[188:203]
    v_rcp_f32 v218, v218
    v_mul_f32 v137, v137, v217
    v_rcp_f32 v219, v219
    s_waitcnt lgkmcnt(2)
    v_mfma_f32_32x32x16_bf16 v[188:203], v[236:239], a[112:115], v[188:203]
    v_mul_f32 v138, v138, v218
    v_cvt_pk_bf16_f32 v134, v136, v137
    v_mul_f32 v139, v139, v219
    v_cvt_pk_bf16_f32 v135, v138, v139
    s_cmp_lg_u32 s81, 0
    s_cbranch_scc1 ALT9
    buffer_store_dwordx4 v[124:127], v2, s[24:27], s66 offen offset:0 sc1
    buffer_store_dwordx4 v[132:135], v2, s[24:27], s66 offen offset:1024 sc1
ALT9_back:
    v_mul_f32 v204, s44, v140
    v_mul_f32 v205, s44, v141
    v_mfma_f32_32x32x16_bf16 v[188:203], v[240:243], a[116:119], v[188:203]
    v_exp_f32 v204, v204
    v_mul_f32 v206, s44, v142
    v_exp_f32 v205, v205
    s_waitcnt lgkmcnt(0)
    v_mfma_f32_32x32x16_bf16 v[188:203], v[244:247], a[120:123], v[188:203]
    v_add_f32 v204, 1.0, v204
    v_mul_f32 v207, s44, v143
    v_exp_f32 v206, v206
    v_add_f32 v205, 1.0, v205
    v_mfma_f32_32x32x16_bf16 v[188:203], v[248:251], a[124:127], v[188:203]
    v_rcp_f32 v204, v204
    v_mul_f32 v208, s44, v144
    v_exp_f32 v207, v207
    v_add_f32 v206, 1.0, v206
    v_rcp_f32 v205, v205
    v_mul_f32 v140, v140, v204
    v_mul_f32 v209, s44, v145
    v_exp_f32 v208, v208
    v_add_f32 v207, 1.0, v207
    v_rcp_f32 v206, v206
    v_mul_f32 v141, v141, v205
    v_mul_f32 v210, s44, v146
    v_exp_f32 v209, v209
    v_add_f32 v208, 1.0, v208
    v_rcp_f32 v207, v207
    v_mul_f32 v142, v142, v206
    v_cvt_pk_bf16_f32 v140, v140, v141
    v_mul_f32 v211, s44, v147
    v_exp_f32 v210, v210
    v_add_f32 v209, 1.0, v209
    v_rcp_f32 v208, v208
    v_mul_f32 v143, v143, v207
    v_mul_f32 v212, s44, v148
    v_exp_f32 v211, v211
    v_add_f32 v210, 1.0, v210
    v_rcp_f32 v209, v209
    v_mul_f32 v144, v144, v208
    v_cvt_pk_bf16_f32 v141, v142, v143
    v_mul_f32 v213, s44, v149
    v_exp_f32 v212, v212
    v_add_f32 v211, 1.0, v211
    v_rcp_f32 v210, v210
    v_mul_f32 v145, v145, v209
    v_mul_f32 v214, s44, v150
    v_exp_f32 v213, v213
    v_add_f32 v212, 1.0, v212
    v_rcp_f32 v211, v211
    v_mul_f32 v146, v146, v210
    v_cvt_pk_bf16_f32 v142, v144, v145
    v_mul_f32 v215, s44, v151
    v_exp_f32 v214, v214
    v_add_f32 v213, 1.0, v213
    v_rcp_f32 v212, v212
    v_mul_f32 v147, v147, v211
    v_mul_f32 v216, s44, v152
    v_exp_f32 v215, v215
    v_add_f32 v214, 1.0, v214
    v_rcp_f32 v213, v213
    v_mul_f32 v148, v148, v212
    v_cvt_pk_bf16_f32 v143, v146, v147
    v_mul_f32 v217, s44, v153
    v_exp_f32 v216, v216
    v_add_f32 v215, 1.0, v215
    v_rcp_f32 v214, v214
    v_mul_f32 v149, v149, v213
    v_mul_f32 v218, s44, v154
    v_exp_f32 v217, v217
    v_add_f32 v216, 1.0, v216
    v_rcp_f32 v215, v215
    v_mul_f32 v150, v150, v214
    v_cvt_pk_bf16_f32 v148, v148, v149
    v_mul_f32 v219, s44, v155
    v_exp_f32 v218, v218
    v_add_f32 v217, 1.0, v217
    v_rcp_f32 v216, v216
    v_mul_f32 v151, v151, v215
    v_exp_f32 v219, v219
    v_add_f32 v218, 1.0, v218
    v_rcp_f32 v217, v217
    v_mul_f32 v152, v152, v216
    v_cvt_pk_bf16_f32 v149, v150, v151
    v_add_f32 v219, 1.0, v219
    v_rcp_f32 v218, v218
    v_mul_f32 v153, v153, v217
    v_rcp_f32 v219, v219
    v_mul_f32 v154, v154, v218
    v_cvt_pk_bf16_f32 v150, v152, v153
    v_mul_f32 v155, v155, v219
    v_cvt_pk_bf16_f32 v151, v154, v155
    s_cmp_lg_u32 s81, 0
    s_cbranch_scc1 ALT10
    buffer_store_dwordx4 v[140:143], v2, s[24:27], s66 offen offset:2048 sc1
    buffer_store_dwordx4 v[148:151], v2, s[24:27], s66 offen offset:3072 sc1
ALT10_back:
    v_fmamk_f32 v116, v11, 0xc1780000, v9
    v_min_f32 v100, 0, v116
    v_min_f32 v116, 0, -v116
    v_fmamk_f32 v117, v11, 0xc1840000, v9
    v_min_f32 v101, 0, v117
    v_min_f32 v117, 0, -v117
    v_fmamk_f32 v118, v11, 0xc18c0000, v9
    v_min_f32 v102, 0, v118
    v_min_f32 v118, 0, -v118
    v_fmamk_f32 v119, v11, 0xc1940000, v9
    v_min_f32 v103, 0, v119
    v_min_f32 v119, 0, -v119
    v_fmamk_f32 v120, v11, 0xc1bc0000, v9
    v_min_f32 v104, 0, v120
    v_min_f32 v120, 0, -v120
    v_fmamk_f32 v121, v11, 0xc1c40000, v9
    v_min_f32 v105, 0, v121
    v_min_f32 v121, 0, -v121
    v_fmamk_f32 v122, v11, 0xc1cc0000, v9
    v_min_f32 v106, 0, v122
    v_min_f32 v122, 0, -v122
    v_fmamk_f32 v123, v11, 0xc1d40000, v9
    v_min_f32 v107, 0, v123
    v_min_f32 v123, 0, -v123
    s_mov_b32 s86, 0x21800000
    s_mov_b32 s87, 0x5d800000
    v_pk_mul_f32 v[204:205], v[156:157], s[44:45]
    v_pk_mul_f32 v[206:207], v[158:159], s[44:45]
    v_pk_mul_f32 v[208:209], v[160:161], s[44:45]
    v_pk_mul_f32 v[210:211], v[162:163], s[44:45]
    v_pk_mul_f32 v[212:213], v[164:165], s[44:45]
    v_pk_mul_f32 v[214:215], v[166:167], s[44:45]
    v_pk_mul_f32 v[216:217], v[168:169], s[44:45]
    v_pk_mul_f32 v[218:219], v[170:171], s[44:45]
    v_exp_f32 v204, v204
    v_exp_f32 v205, v205
    v_exp_f32 v206, v206
    v_exp_f32 v207, v207
    v_exp_f32 v208, v208
    v_exp_f32 v209, v209
    v_exp_f32 v210, v210
    v_exp_f32 v211, v211
    v_exp_f32 v212, v212
    v_exp_f32 v213, v213
    v_exp_f32 v214, v214
    v_exp_f32 v215, v215
    v_exp_f32 v216, v216
    v_exp_f32 v217, v217
    v_exp_f32 v218, v218
    v_exp_f32 v219, v219
    v_pk_add_f32 v[204:205], v[204:205], 1.0 op_sel_hi:[1,0]
    v_pk_add_f32 v[206:207], v[206:207], 1.0 op_sel_hi:[1,0]
    v_pk_add_f32 v[208:209], v[208:209], 1.0 op_sel_hi:[1,0]
    v_pk_add_f32 v[210:211], v[210:211], 1.0 op_sel_hi:[1,0]
    v_pk_add_f32 v[212:213], v[212:213], 1.0 op_sel_hi:[1,0]
    v_pk_add_f32 v[214:215], v[214:215], 1.0 op_sel_hi:[1,0]
    v_pk_add_f32 v[216:217], v[216:217], 1.0 op_sel_hi:[1,0]
    v_pk_add_f32 v[218:219], v[218:219], 1.0 op_sel_hi:[1,0]
    v_rcp_f32 v204, v204
    v_rcp_f32 v205, v205
    v_rcp_f32 v206, v206
    v_rcp_f32 v207, v207
    buffer_load_dwordx2 v[70:71], v42, s[24:27], 0 offen sc1
    v_rcp_f32 v208, v208
    v_rcp_f32 v209, v209
    v_rcp_f32 v210, v210
    v_rcp_f32 v211, v211
    v_rcp_f32 v212, v212
    v_rcp_f32 v213, v213
    v_rcp_f32 v214, v214
    v_rcp_f32 v215, v215
    v_rcp_f32 v216, v216
    v_rcp_f32 v217, v217
    v_rcp_f32 v218, v218
    v_rcp_f32 v219, v219
    v_pk_mul_f32 v[156:157], v[156:157], v[204:205]
    v_pk_mul_f32 v[158:159], v[158:159], v[206:207]
    v_pk_mul_f32 v[160:161], v[160:161], v[208:209]
    v_pk_mul_f32 v[162:163], v[162:163], v[210:211]
    v_pk_mul_f32 v[164:165], v[164:165], v[212:213]
    v_pk_mul_f32 v[166:167], v[166:167], v[214:215]
    v_pk_mul_f32 v[168:169], v[168:169], v[216:217]
    v_pk_mul_f32 v[170:171], v[170:171], v[218:219]
    v_cvt_pk_bf16_f32 v156, v156, v157
    v_cvt_pk_bf16_f32 v157, v158, v159
    v_cvt_pk_bf16_f32 v158, v160, v161
    v_cvt_pk_bf16_f32 v159, v162, v163
    v_cvt_pk_bf16_f32 v164, v164, v165
    v_cvt_pk_bf16_f32 v165, v166, v167
    v_cvt_pk_bf16_f32 v166, v168, v169
    v_cvt_pk_bf16_f32 v167, v170, v171
    s_cmp_lg_u32 s81, 0
    s_cbranch_scc1 ALT11
    s_add_u32 s66, s66, 4096
    buffer_store_dwordx4 v[156:159], v2, s[24:27], s66 offen offset:0 sc1
    buffer_store_dwordx4 v[164:167], v2, s[24:27], s66 offen offset:1024 sc1
ALT11_back:
    v_cvt_pk_bf16_f32 v188, v188, v188
    v_lshlrev_b32 v188, 16, v188
    v_mul_f32 v188, s44, v188
    v_exp_f32 v188, v188
    v_mov_b32 v194, v72
    v_add_f32 v188, 1.0, v188
    v_rcp_f32 v188, v188
    v_mov_b32 v195, v73
    v_cvt_pk_bf16_f32 v188, v188, v188
    v_lshlrev_b32 v192, 16, v188
    v_sub_f32 v188, 1.0, v192
    v_cvt_pk_bf16_f32 v188, v188, v188
    v_lshlrev_b32 v193, 16, v188
    buffer_store_dwordx4 v[192:195], v62, s[24:27], 0 offen sc1
    v_pk_mul_f32 v[204:205], v[172:173], s[44:45]
    v_pk_mul_f32 v[206:207], v[174:175], s[44:45]
    v_pk_mul_f32 v[208:209], v[176:177], s[44:45]
    v_pk_mul_f32 v[210:211], v[178:179], s[44:45]
    v_pk_mul_f32 v[212:213], v[180:181], s[44:45]
    v_pk_mul_f32 v[214:215], v[182:183], s[44:45]
    v_pk_mul_f32 v[216:217], v[184:185], s[44:45]
    v_pk_mul_f32 v[218:219], v[186:187], s[44:45]
    v_exp_f32 v204, v204
    v_exp_f32 v205, v205
    v_exp_f32 v206, v206
    v_exp_f32 v207, v207
    v_exp_f32 v208, v208
    v_exp_f32 v209, v209
    v_exp_f32 v210, v210
    v_exp_f32 v211, v211
    v_exp_f32 v212, v212
    v_exp_f32 v213, v213
    v_exp_f32 v214, v214
    v_exp_f32 v215, v215
    v_exp_f32 v216, v216
    v_exp_f32 v217, v217
    v_exp_f32 v218, v218
    v_exp_f32 v219, v219
    v_pk_add_f32 v[204:205], v[204:205], 1.0 op_sel_hi:[1,0]
    v_pk_add_f32 v[206:207], v[206:207], 1.0 op_sel_hi:[1,0]
    v_pk_add_f32 v[208:209], v[208:209], 1.0 op_sel_hi:[1,0]
    v_pk_add_f32 v[210:211], v[210:211], 1.0 op_sel_hi:[1,0]
    v_pk_add_f32 v[212:213], v[212:213], 1.0 op_sel_hi:[1,0]
    v_pk_add_f32 v[214:215], v[214:215], 1.0 op_sel_hi:[1,0]
    v_pk_add_f32 v[216:217], v[216:217], 1.0 op_sel_hi:[1,0]
    v_pk_add_f32 v[218:219], v[218:219], 1.0 op_sel_hi:[1,0]
    v_rcp_f32 v204, v204
    v_rcp_f32 v205, v205
    v_rcp_f32 v206, v206
    v_rcp_f32 v207, v207
    s_waitcnt vmcnt(3)
    v_cmp_ne_u64 vcc, v[70:71], v[72:73]
    s_cbranch_vccnz P1G_slow
P1G_back:
    ds_write_b128 v49, v[80:83]
    s_mov_b32 m0, s59
    s_nop 0
    buffer_load_dwordx4 v2, s[24:27], s70 offen sc1 lds
    v_rcp_f32 v208, v208
    v_rcp_f32 v209, v209
    v_rcp_f32 v210, v210
    v_rcp_f32 v211, v211
    s_add_u32 s70, s70, s67
    s_add_u32 m0, s59, 1024
    s_nop 0
    buffer_load_dwordx4 v2, s[24:27], s70 offen sc1 lds
    v_rcp_f32 v212, v212
    v_rcp_f32 v213, v213
    v_rcp_f32 v214, v214
    v_rcp_f32 v215, v215
    buffer_load_dwordx4 v[84:87], v2, s[24:27], s72 offen sc1
    v_rcp_f32 v216, v216
    v_rcp_f32 v217, v217
    v_rcp_f32 v218, v218
    v_rcp_f32 v219, v219
    s_lshl2_add_u32 s72, s67, s72
    buffer_load_dwordx4 v[88:91], v2, s[24:27], s72 offen sc1
    v_pk_mul_f32 v[172:173], v[172:173], v[204:205]
    v_pk_mul_f32 v[174:175], v[174:175], v[206:207]
    v_pk_mul_f32 v[176:177], v[176:177], v[208:209]
    v_pk_mul_f32 v[178:179], v[178:179], v[210:211]
    v_pk_mul_f32 v[180:181], v[180:181], v[212:213]
    v_pk_mul_f32 v[182:183], v[182:183], v[214:215]
    v_pk_mul_f32 v[184:185], v[184:185], v[216:217]
    v_pk_mul_f32 v[186:187], v[186:187], v[218:219]
    s_mov_b32 m0, s73
    s_nop 0
    buffer_load_dwordx4 v2, s[24:27], s71 offen sc1 lds
    s_add_u32 s71, s71, s67
    s_add_u32 m0, s73, 1040
    s_nop 0
    buffer_load_dwordx4 v2, s[24:27], s71 offen sc1 lds
    v_cvt_pk_bf16_f32 v172, v172, v173
    v_cvt_pk_bf16_f32 v173, v174, v175
    v_cvt_pk_bf16_f32 v174, v176, v177
    v_cvt_pk_bf16_f32 v175, v178, v179
    v_cvt_pk_bf16_f32 v180, v180, v181
    v_cvt_pk_bf16_f32 v181, v182, v183
    v_cvt_pk_bf16_f32 v182, v184, v185
    v_cvt_pk_bf16_f32 v183, v186, v187
    s_cmp_lg_u32 s81, 0
    s_cbranch_scc1 ALT12
    buffer_store_dwordx4 v[172:175], v2, s[24:27], s66 offen offset:2048 sc1
    buffer_store_dwordx4 v[180:183], v2, s[24:27], s66 offen offset:3072 sc1
ALT12_back:
    buffer_load_dwordx2 v[70:71], v43, s[24:27], 0 offen sc1
    s_waitcnt vmcnt(3) lgkmcnt(0)
    s_waitcnt lgkmcnt(0)
    s_branch JOIN
    .p2align 3
    .fill 140, 4, 0xbf800000
JOIN:
    s_barrier
    ds_read_b128 v[220:223], v46 offset:0
    ds_read_b128 v[224:227], v46 offset:1024
    ds_read_b128 v[228:231], v47 offset:16384
    ds_read_b128 v[232:235], v48 offset:16384
    s_waitcnt lgkmcnt(3)
    v_mfma_f32_32x32x16_bf16 v[124:139], v[220:223], v[84:87], v[108:123]
    .p2align 3
    s_waitcnt lgkmcnt(2)
    v_mfma_f32_32x32x16_bf16 v[140:155], v[224:227], v[84:87], 0
    ds_read_b128 v[220:223], v46 offset:2048
    ds_read_b128 v[224:227], v46 offset:3072
    s_nop 7
    v_exp_f32 v124, v124
    v_exp_f32 v125, v125
    v_exp_f32 v126, v126
    v_exp_f32 v127, v127
    v_exp_f32 v128, v128
    v_exp_f32 v129, v129
    v_exp_f32 v130, v130
    v_exp_f32 v131, v131
    ds_read_b128 v[236:239], v47 offset:17424
    ds_read_b128 v[240:243], v48 offset:17424
    s_xor_b32 s77, s77, 0x20000
    s_add_u32 m0, s58, 49152
    s_nop 0
    buffer_load_dwordx4 v50, s[16:19], s77 offen offset:0  lds
    v_exp_f32 v132, v132
    v_exp_f32 v133, v133
    v_exp_f32 v134, v134
    v_exp_f32 v135, v135
    v_exp_f32 v136, v136
    v_exp_f32 v137, v137
    v_exp_f32 v138, v138
    v_exp_f32 v139, v139
    v_cvt_pk_bf16_f32 v156, v124, v125
    v_cvt_pk_bf16_f32 v157, v126, v127
    v_cvt_pk_bf16_f32 v158, v128, v129
    v_cvt_pk_bf16_f32 v159, v130, v131
    v_cvt_pk_bf16_f32 v160, v132, v133
    v_cvt_pk_bf16_f32 v161, v134, v135
    v_cvt_pk_bf16_f32 v162, v136, v137
    v_cvt_pk_bf16_f32 v163, v138, v139
    s_waitcnt lgkmcnt(3)
    v_mfma_f32_32x32x16_bf16 v[124:139], v[220:223], v[84:87], 0
    ds_read_b128 v[220:223], v46 offset:4096
    s_waitcnt vmcnt(2)
    s_cmp_lg_u32 s81, 0
    s_cbranch_scc1 ALT13
    buffer_store_dword v72, v41, s[24:27], s80 offen
ALT13_back:
    v_exp_f32 v140, v140
    v_exp_f32 v141, v141
    v_exp_f32 v142, v142
    v_exp_f32 v143, v143
    v_mfma_f32_32x32x16_bf16 v[172:187], v[228:231], v[156:159], 0
    s_waitcnt vmcnt(2)
    v_cmp_ne_u64 vcc, v[70:71], v[72:73]
    s_cbranch_vccnz PL_slow
PL_back:
    s_lshl3_add_u32 s70, s67, s70
    s_cmp_lt_u32 s49, 2
    s_cselect_b32 s70, 0x40000000, s70
    s_add_u32 m0, s59, 9216
    s_nop 0
    buffer_load_dwordx4 v2, s[24:27], s70 offen sc1 lds
    v_exp_f32 v144, v144
    v_exp_f32 v145, v145
    v_exp_f32 v146, v146
    v_exp_f32 v147, v147
    v_mfma_f32_32x32x16_bf16 v[172:187], v[232:235], v[160:163], v[172:187]
    ds_read_b128 v[244:247], v47 offset:18464
    ds_read_b128 v[248:251], v48 offset:18464
    s_sub_u32 s70, s70, s67
    s_add_u32 m0, s59, 8192
    s_nop 0
    buffer_load_dwordx4 v2, s[24:27], s70 offen sc1 lds
    v_exp_f32 v148, v148
    v_exp_f32 v149, v149
    v_exp_f32 v150, v150
    v_exp_f32 v151, v151
    v_exp_f32 v152, v152
    v_exp_f32 v153, v153
    v_exp_f32 v154, v154
    v_exp_f32 v155, v155
    v_cvt_pk_bf16_f32 v164, v140, v141
    v_cvt_pk_bf16_f32 v165, v142, v143
    v_cvt_pk_bf16_f32 v166, v144, v145
    v_cvt_pk_bf16_f32 v167, v146, v147
    v_cvt_pk_bf16_f32 v168, v148, v149
    v_cvt_pk_bf16_f32 v169, v150, v151
    v_cvt_pk_bf16_f32 v170, v152, v153
    v_cvt_pk_bf16_f32 v171, v154, v155
    s_waitcnt lgkmcnt(5)
    v_mfma_f32_32x32x16_bf16 v[140:155], v[224:227], v[84:87], 0
    s_lshl3_add_u32 s71, s67, s71
    s_cmp_lt_u32 s49, 2
    s_cselect_b32 s71, 0x40000000, s71
    s_add_u32 m0, s73, 9360
    s_nop 0
    buffer_load_dwordx4 v2, s[24:27], s71 offen sc1 lds
    v_exp_f32 v124, v124
    v_exp_f32 v125, v125
    v_exp_f32 v126, v126
    v_exp_f32 v127, v127
    s_waitcnt lgkmcnt(4)
    v_mfma_f32_32x32x16_bf16 v[172:187], v[236:239], v[164:167], v[172:187]
    s_sub_u32 s71, s71, s67
    s_add_u32 m0, s73, 8320
    s_nop 0
    buffer_load_dwordx4 v2, s[24:27], s71 offen sc1 lds
    v_exp_f32 v128, v128
    v_exp_f32 v129, v129
    v_exp_f32 v130, v130
    v_exp_f32 v131, v131
    s_waitcnt lgkmcnt(3)
    v_mfma_f32_32x32x16_bf16 v[172:187], v[240:243], v[168:171], v[172:187]
    ds_read_b128 v[228:231], v47 offset:19504
    ds_read_b128 v[232:235], v48 offset:19504
    s_add_u32 m0, s58, 49152
    s_nop 0
    buffer_load_dwordx4 v51, s[16:19], s77 offen offset:1024  lds
    v_exp_f32 v132, v132
    v_exp_f32 v133, v133
    v_exp_f32 v134, v134
    v_exp_f32 v135, v135
    v_exp_f32 v136, v136
    v_exp_f32 v137, v137
    v_exp_f32 v138, v138
    v_exp_f32 v139, v139
    v_cvt_pk_bf16_f32 v156, v124, v125
    v_cvt_pk_bf16_f32 v157, v126, v127
    v_cvt_pk_bf16_f32 v158, v128, v129
    v_cvt_pk_bf16_f32 v159, v130, v131
    v_cvt_pk_bf16_f32 v160, v132, v133
    v_cvt_pk_bf16_f32 v161, v134, v135
    v_cvt_pk_bf16_f32 v162, v136, v137
    v_cvt_pk_bf16_f32 v163, v138, v139
    s_waitcnt lgkmcnt(4)
    v_mfma_f32_32x32x16_bf16 v[124:139], v[220:223], v[84:87], 0
    buffer_load_dwordx4 v52, s[16:19], s77 offen offset:2048  lds
    v_exp_f32 v140, v140
    v_exp_f32 v141, v141
    v_exp_f32 v142, v142
    v_exp_f32 v143, v143
    s_waitcnt lgkmcnt(3)
    v_mfma_f32_32x32x16_bf16 v[172:187], v[244:247], v[156:159], v[172:187]
    buffer_load_dwordx4 v53, s[16:19], s77 offen offset:3072  lds
    v_exp_f32 v144, v144
    v_exp_f32 v145, v145
    v_exp_f32 v146, v146
    v_exp_f32 v147, v147
    s_waitcnt lgkmcnt(2)
    v_mfma_f32_32x32x16_bf16 v[172:187], v[248:251], v[160:163], v[172:187]
    ds_read_b128 v[236:239], v47 offset:20544
    ds_read_b128 v[240:243], v48 offset:20544
    s_and_b32 s77, s77, 0x18000
    s_bitset1_b32 s77, 19
    s_add_u32 m0, s58, 131072
    s_nop 0
    buffer_load_dwordx4 v50, s[16:19], s77 offen offset:0  lds
    v_exp_f32 v148, v148
    v_exp_f32 v149, v149
    v_exp_f32 v150, v150
    v_exp_f32 v151, v151
    v_exp_f32 v152, v152
    v_exp_f32 v153, v153
    v_exp_f32 v154, v154
    v_exp_f32 v155, v155
    v_cvt_pk_bf16_f32 v164, v140, v141
    v_cvt_pk_bf16_f32 v165, v142, v143
    v_cvt_pk_bf16_f32 v166, v144, v145
    v_cvt_pk_bf16_f32 v167, v146, v147
    v_cvt_pk_bf16_f32 v168, v148, v149
    v_cvt_pk_bf16_f32 v169, v150, v151
    v_cvt_pk_bf16_f32 v170, v152, v153
    v_cvt_pk_bf16_f32 v171, v154, v155
    v_mfma_f32_32x32x16_bf16 v[140:155], v[220:223], v[88:91], v[108:123]
PGM_J:
    buffer_load_dwordx4 v51, s[16:19], s77 offen offset:1024  lds
    v_exp_f32 v124, v124
    v_exp_f32 v125, v125
    v_exp_f32 v126, v126
    v_exp_f32 v127, v127
    s_waitcnt lgkmcnt(3)
    v_mfma_f32_32x32x16_bf16 v[172:187], v[228:231], v[164:167], v[172:187]
    buffer_load_dwordx4 v52, s[16:19], s77 offen offset:2048  lds
    v_exp_f32 v128, v128
    v_exp_f32 v129, v129
    v_exp_f32 v130, v130
    v_exp_f32 v131, v131
    s_waitcnt lgkmcnt(2)
    v_mfma_f32_32x32x16_bf16 v[172:187], v[232:235], v[168:171], v[172:187]
    s_waitcnt vmcnt(6)
    s_barrier
    ds_read_b128 v[224:227], v46 offset:5120
    buffer_load_dword v70, v44, s[24:27], 0 offen sc1
    v_exp_f32 v132, v132
    v_exp_f32 v133, v133
    v_exp_f32 v134, v134
    v_exp_f32 v135, v135
    v_exp_f32 v136, v136
    v_exp_f32 v137, v137
    v_exp_f32 v138, v138
    v_exp_f32 v139, v139
    v_cvt_pk_bf16_f32 v156, v124, v125
    v_cvt_pk_bf16_f32 v157, v126, v127
    v_cvt_pk_bf16_f32 v158, v128, v129
    v_cvt_pk_bf16_f32 v159, v130, v131
    v_cvt_pk_bf16_f32 v160, v132, v133
    v_cvt_pk_bf16_f32 v161, v134, v135
    v_cvt_pk_bf16_f32 v162, v136, v137
    v_cvt_pk_bf16_f32 v163, v138, v139
    s_waitcnt lgkmcnt(0)
    v_mfma_f32_32x32x16_bf16 v[124:139], v[224:227], v[84:87], 0
    ds_read_b128 v[220:223], v46 offset:6144
    buffer_load_dwordx4 v53, s[16:19], s77 offen offset:3072  lds
    v_exp_f32 v140, v140
    v_exp_f32 v141, v141
    v_exp_f32 v142, v142
    v_exp_f32 v143, v143
    v_mfma_f32_32x32x16_bf16 v[172:187], v[236:239], v[156:159], v[172:187]
    v_mov_b32 v8, -1
    v_mov_b32 v9, -1
    v_mov_b32 v10, -1
    v_mov_b32 v11, -1
    s_lshl_b32 s77, s46, 14
    s_add_u32 s77, s77, 655360
    s_add_u32 m0, s59, 36864
    s_nop 0
    buffer_load_dwordx4 v50, s[16:19], s77 offen offset:0  lds
    v_exp_f32 v144, v144
    v_exp_f32 v145, v145
    v_exp_f32 v146, v146
    v_exp_f32 v147, v147
    v_mfma_f32_32x32x16_bf16 v[172:187], v[240:243], v[160:163], v[172:187]
    ds_read_b128 v[244:247], v47 offset:21584
    ds_read_b128 v[248:251], v48 offset:21584
    buffer_store_dwordx4 v[8:11], v2, s[24:27], s79 offen offset:0 sc1
    v_exp_f32 v148, v148
    v_exp_f32 v149, v149
    v_exp_f32 v150, v150
    v_exp_f32 v151, v151
    v_exp_f32 v152, v152
    v_exp_f32 v153, v153
    v_exp_f32 v154, v154
    v_exp_f32 v155, v155
    v_cvt_pk_bf16_f32 v164, v140, v141
    v_cvt_pk_bf16_f32 v165, v142, v143
    v_cvt_pk_bf16_f32 v166, v144, v145
    v_cvt_pk_bf16_f32 v167, v146, v147
    v_cvt_pk_bf16_f32 v168, v148, v149
    v_cvt_pk_bf16_f32 v169, v150, v151
    v_cvt_pk_bf16_f32 v170, v152, v153
    v_cvt_pk_bf16_f32 v171, v154, v155
    v_mfma_f32_32x32x16_bf16 v[140:155], v[224:227], v[88:91], 0
    ds_read_b128 v[224:227], v46 offset:7168
    buffer_store_dwordx4 v[8:11], v2, s[24:27], s79 offen offset:1024 sc1
    v_exp_f32 v124, v124
    v_exp_f32 v125, v125
    v_exp_f32 v126, v126
    v_exp_f32 v127, v127
    v_mfma_f32_32x32x16_bf16 v[188:203], v[236:239], v[164:167], 0
    buffer_load_dwordx4 v51, s[16:19], s77 offen offset:1024  lds
    v_exp_f32 v128, v128
    v_exp_f32 v129, v129
    v_exp_f32 v130, v130
    v_exp_f32 v131, v131
    v_mfma_f32_32x32x16_bf16 v[188:203], v[240:243], v[168:171], v[188:203]
    s_xor_b32 s77, s46, s76
    s_lshl3_add_u32 s77, s47, s77
    s_lshl_b32 s77, s77, 15
    s_add_u32 m0, s58, 65536
    s_nop 0
    buffer_load_dwordx4 v50, s[20:23], s77 offen offset:0  lds
    v_exp_f32 v132, v132
    v_exp_f32 v133, v133
    v_exp_f32 v134, v134
    v_exp_f32 v135, v135
    v_exp_f32 v136, v136
    v_exp_f32 v137, v137
    v_exp_f32 v138, v138
    v_exp_f32 v139, v139
    v_cvt_pk_bf16_f32 v156, v124, v125
    v_cvt_pk_bf16_f32 v157, v126, v127
    v_cvt_pk_bf16_f32 v158, v128, v129
    v_cvt_pk_bf16_f32 v159, v130, v131
    v_cvt_pk_bf16_f32 v160, v132, v133
    v_cvt_pk_bf16_f32 v161, v134, v135
    v_cvt_pk_bf16_f32 v162, v136, v137
    v_cvt_pk_bf16_f32 v163, v138, v139
    s_waitcnt lgkmcnt(3)
    v_mfma_f32_32x32x16_bf16 v[124:139], v[220:223], v[84:87], 0
    s_waitcnt vmcnt(6)
    v_cmp_ne_u32 vcc, v70, v72
    s_cbranch_vccnz P2_slow
P2_back:
    buffer_load_dwordx4 a[0:3], v64, s[24:27], s75 offen offset:0 sc1
    v_exp_f32 v140, v140
    v_exp_f32 v141, v141
    v_exp_f32 v142, v142
    v_exp_f32 v143, v143
    s_waitcnt lgkmcnt(2)
    v_mfma_f32_32x32x16_bf16 v[172:187], v[244:247], v[156:159], v[172:187]
    buffer_load_dwordx4 v51, s[20:23], s77 offen offset:1024  lds
    v_exp_f32 v144, v144
    v_exp_f32 v145, v145
    v_exp_f32 v146, v146
    v_exp_f32 v147, v147
    s_waitcnt lgkmcnt(1)
    v_mfma_f32_32x32x16_bf16 v[172:187], v[248:251], v[160:163], v[172:187]
    ds_read_b128 v[228:231], v47 offset:22624
    ds_read_b128 v[232:235], v48 offset:22624
    buffer_load_dwordx4 v52, s[20:23], s77 offen offset:2048  lds
    v_exp_f32 v148, v148
    v_exp_f32 v149, v149
    v_exp_f32 v150, v150
    v_exp_f32 v151, v151
    v_exp_f32 v152, v152
    v_exp_f32 v153, v153
    v_exp_f32 v154, v154
    v_exp_f32 v155, v155
    v_cvt_pk_bf16_f32 v164, v140, v141
    v_cvt_pk_bf16_f32 v165, v142, v143
    v_cvt_pk_bf16_f32 v166, v144, v145
    v_cvt_pk_bf16_f32 v167, v146, v147
    v_cvt_pk_bf16_f32 v168, v148, v149
    v_cvt_pk_bf16_f32 v169, v150, v151
    v_cvt_pk_bf16_f32 v170, v152, v153
    v_cvt_pk_bf16_f32 v171, v154, v155
    v_mfma_f32_32x32x16_bf16 v[140:155], v[220:223], v[88:91], 0
    ds_read_b128 v[220:223], v46 offset:8192
    buffer_load_dwordx4 v53, s[20:23], s77 offen offset:3072  lds
    v_exp_f32 v124, v124
    v_exp_f32 v125, v125
    v_exp_f32 v126, v126
    v_exp_f32 v127, v127
    v_mfma_f32_32x32x16_bf16 v[188:203], v[244:247], v[164:167], v[188:203]
    s_xor_b32 s77, s77, 0x20000
    s_add_u32 m0, s58, 147456
    s_nop 0
    buffer_load_dwordx4 v50, s[20:23], s77 offen offset:0  lds
    v_exp_f32 v128, v128
    v_exp_f32 v129, v129
    v_exp_f32 v130, v130
    v_exp_f32 v131, v131
    v_mfma_f32_32x32x16_bf16 v[188:203], v[248:251], v[168:171], v[188:203]
    buffer_load_dwordx4 v51, s[20:23], s77 offen offset:1024  lds
    v_exp_f32 v132, v132
    v_exp_f32 v133, v133
    v_exp_f32 v134, v134
    v_exp_f32 v135, v135
    v_exp_f32 v136, v136
    v_exp_f32 v137, v137
    v_exp_f32 v138, v138
    v_exp_f32 v139, v139
    v_cvt_pk_bf16_f32 v156, v124, v125
    v_cvt_pk_bf16_f32 v157, v126, v127
    v_cvt_pk_bf16_f32 v158, v128, v129
    v_cvt_pk_bf16_f32 v159, v130, v131
    v_cvt_pk_bf16_f32 v160, v132, v133
    v_cvt_pk_bf16_f32 v161, v134, v135
    v_cvt_pk_bf16_f32 v162, v136, v137
    v_cvt_pk_bf16_f32 v163, v138, v139
    s_waitcnt lgkmcnt(3)
    v_mfma_f32_32x32x16_bf16 v[124:139], v[224:227], v[84:87], 0
    buffer_load_dwordx4 v52, s[20:23], s77 offen offset:2048  lds
    v_exp_f32 v140, v140
    v_exp_f32 v141, v141
    v_exp_f32 v142, v142
    v_exp_f32 v143, v143
    s_waitcnt lgkmcnt(2)
    v_mfma_f32_32x32x16_bf16 v[172:187], v[228:231], v[156:159], v[172:187]
    buffer_load_dwordx4 v53, s[20:23], s77 offen offset:3072  lds
    v_exp_f32 v144, v144
    v_exp_f32 v145, v145
    v_exp_f32 v146, v146
    v_exp_f32 v147, v147
    s_waitcnt lgkmcnt(1)
    v_mfma_f32_32x32x16_bf16 v[172:187], v[232:235], v[160:163], v[172:187]
    ds_read_b128 v[236:239], v47 offset:23664
    ds_read_b128 v[240:243], v48 offset:23664
    buffer_load_dwordx4 a[4:7], v64, s[24:27], s75 offen offset:1024 sc1
    v_exp_f32 v148, v148
    v_exp_f32 v149, v149
    v_exp_f32 v150, v150
    v_exp_f32 v151, v151
    v_exp_f32 v152, v152
    v_exp_f32 v153, v153
    v_exp_f32 v154, v154
    v_exp_f32 v155, v155
    v_cvt_pk_bf16_f32 v164, v140, v141
    v_cvt_pk_bf16_f32 v165, v142, v143
    v_cvt_pk_bf16_f32 v166, v144, v145
    v_cvt_pk_bf16_f32 v167, v146, v147
    v_cvt_pk_bf16_f32 v168, v148, v149
    v_cvt_pk_bf16_f32 v169, v150, v151
    v_cvt_pk_bf16_f32 v170, v152, v153
    v_cvt_pk_bf16_f32 v171, v154, v155
    v_mfma_f32_32x32x16_bf16 v[140:155], v[224:227], v[88:91], 0
    ds_read_b128 v[224:227], v46 offset:9216
    buffer_load_dwordx4 a[8:11], v64, s[24:27], s75 offen offset:2048 sc1
    v_exp_f32 v124, v124
    v_exp_f32 v125, v125
    v_exp_f32 v126, v126
    v_exp_f32 v127, v127
    v_mfma_f32_32x32x16_bf16 v[188:203], v[228:231], v[164:167], v[188:203]
    s_waitcnt vmcnt(12)
    buffer_store_dword v72, v41, s[24:27], s79 offen offset:2048 sc1
    buffer_load_dwordx4 a[12:15], v64, s[24:27], s75 offen offset:3072 sc1
    v_exp_f32 v128, v128
    v_exp_f32 v129, v129
    v_exp_f32 v130, v130
    v_exp_f32 v131, v131
    v_mfma_f32_32x32x16_bf16 v[188:203], v[232:235], v[168:171], v[188:203]
    s_xor_b32 s75, s75, 0x1000
    buffer_load_dwordx4 a[16:19], v64, s[24:27], s75 offen offset:0 sc1
    v_exp_f32 v132, v132
    v_exp_f32 v133, v133
    v_exp_f32 v134, v134
    v_exp_f32 v135, v135
    v_exp_f32 v136, v136
    v_exp_f32 v137, v137
    v_exp_f32 v138, v138
    v_exp_f32 v139, v139
    v_cvt_pk_bf16_f32 v156, v124, v125
    v_cvt_pk_bf16_f32 v157, v126, v127
    v_cvt_pk_bf16_f32 v158, v128, v129
    v_cvt_pk_bf16_f32 v159, v130, v131
    v_cvt_pk_bf16_f32 v160, v132, v133
    v_cvt_pk_bf16_f32 v161, v134, v135
    v_cvt_pk_bf16_f32 v162, v136, v137
    v_cvt_pk_bf16_f32 v163, v138, v139
    s_waitcnt lgkmcnt(3)
    v_mfma_f32_32x32x16_bf16 v[124:139], v[220:223], v[84:87], v[92:107]
    buffer_load_dwordx4 a[20:23], v64, s[24:27], s75 offen offset:1024 sc1
    v_exp_f32 v140, v140
    v_exp_f32 v141, v141
    v_exp_f32 v142, v142
    v_exp_f32 v143, v143
    s_waitcnt lgkmcnt(2)
    v_mfma_f32_32x32x16_bf16 v[172:187], v[236:239], v[156:159], v[172:187]
    buffer_load_dwordx4 a[24:27], v64, s[24:27], s75 offen offset:2048 sc1
    v_exp_f32 v144, v144
    v_exp_f32 v145, v145
    v_exp_f32 v146, v146
    v_exp_f32 v147, v147
    s_waitcnt lgkmcnt(1)
    v_mfma_f32_32x32x16_bf16 v[172:187], v[240:243], v[160:163], v[172:187]
    ds_read_b128 v[244:247], v47 offset:24704
    ds_read_b128 v[248:251], v48 offset:24704
    buffer_load_dwordx4 a[28:31], v64, s[24:27], s75 offen offset:3072 sc1
    v_exp_f32 v148, v148
    v_exp_f32 v149, v149
    v_exp_f32 v150, v150
    v_exp_f32 v151, v151
    v_exp_f32 v152, v152
    v_exp_f32 v153, v153
    v_exp_f32 v154, v154
    v_exp_f32 v155, v155
    v_cvt_pk_bf16_f32 v164, v140, v141
    v_cvt_pk_bf16_f32 v165, v142, v143
    v_cvt_pk_bf16_f32 v166, v144, v145
    v_cvt_pk_bf16_f32 v167, v146, v147
    v_cvt_pk_bf16_f32 v168, v148, v149
    v_cvt_pk_bf16_f32 v169, v150, v151
    v_cvt_pk_bf16_f32 v170, v152, v153
    v_cvt_pk_bf16_f32 v171, v154, v155
    v_mfma_f32_32x32x16_bf16 v[140:155], v[220:223], v[88:91], 0
    ds_read_b128 v[220:223], v46 offset:10240
    s_xor_b32 s75, s75, 0x3000
    buffer_load_dwordx4 a[32:35], v64, s[24:27], s75 offen offset:0 sc1
    v_exp_f32 v124, v124
    v_exp_f32 v125, v125
    v_exp_f32 v126, v126
    v_exp_f32 v127, v127
    v_mfma_f32_32x32x16_bf16 v[188:203], v[236:239], v[164:167], v[188:203]
    buffer_load_dwordx4 a[36:39], v64, s[24:27], s75 offen offset:1024 sc1
    v_exp_f32 v128, v128
    v_exp_f32 v129, v129
    v_exp_f32 v130, v130
    v_exp_f32 v131, v131
    v_mfma_f32_32x32x16_bf16 v[188:203], v[240:243], v[168:171], v[188:203]
    buffer_load_dwordx4 a[40:43], v64, s[24:27], s75 offen offset:2048 sc1
    v_exp_f32 v132, v132
    v_exp_f32 v133, v133
    v_exp_f32 v134, v134
    v_exp_f32 v135, v135
    v_exp_f32 v136, v136
    v_exp_f32 v137, v137
    v_exp_f32 v138, v138
    v_exp_f32 v139, v139
    v_cvt_pk_bf16_f32 v156, v124, v125
    v_cvt_pk_bf16_f32 v157, v126, v127
    v_cvt_pk_bf16_f32 v158, v128, v129
    v_cvt_pk_bf16_f32 v159, v130, v131
    v_cvt_pk_bf16_f32 v160, v132, v133
    v_cvt_pk_bf16_f32 v161, v134, v135
    v_cvt_pk_bf16_f32 v162, v136, v137
    v_cvt_pk_bf16_f32 v163, v138, v139
    s_waitcnt lgkmcnt(3)
    v_mfma_f32_32x32x16_bf16 v[124:139], v[224:227], v[88:91], 0
    ds_read_b128 v[224:227], v46 offset:11264
    buffer_load_dwordx4 a[44:47], v64, s[24:27], s75 offen offset:3072 sc1
    v_exp_f32 v140, v140
    v_exp_f32 v141, v141
    v_exp_f32 v142, v142
    v_exp_f32 v143, v143
    s_waitcnt lgkmcnt(3)
    v_mfma_f32_32x32x16_bf16 v[172:187], v[244:247], v[156:159], v[172:187]
    s_xor_b32 s75, s75, 0x1000
    buffer_load_dwordx4 a[48:51], v64, s[24:27], s75 offen offset:0 sc1
    v_exp_f32 v144, v144
    v_exp_f32 v145, v145
    v_exp_f32 v146, v146
    v_exp_f32 v147, v147
    s_waitcnt lgkmcnt(2)
    v_mfma_f32_32x32x16_bf16 v[172:187], v[248:251], v[160:163], v[172:187]
    ds_read_b128 v[228:231], v47 offset:25744
    ds_read_b128 v[232:235], v48 offset:25744
    buffer_load_dwordx4 a[52:55], v64, s[24:27], s75 offen offset:1024 sc1
    v_exp_f32 v148, v148
    v_exp_f32 v149, v149
    v_exp_f32 v150, v150
    v_exp_f32 v151, v151
    v_exp_f32 v152, v152
    v_exp_f32 v153, v153
    v_exp_f32 v154, v154
    v_exp_f32 v155, v155
    v_cvt_pk_bf16_f32 v164, v140, v141
    v_cvt_pk_bf16_f32 v165, v142, v143
    v_cvt_pk_bf16_f32 v166, v144, v145
    v_cvt_pk_bf16_f32 v167, v146, v147
    v_cvt_pk_bf16_f32 v168, v148, v149
    v_cvt_pk_bf16_f32 v169, v150, v151
    v_cvt_pk_bf16_f32 v170, v152, v153
    v_cvt_pk_bf16_f32 v171, v154, v155
    s_waitcnt lgkmcnt(3)
    v_mfma_f32_32x32x16_bf16 v[140:155], v[220:223], v[88:91], 0
    ds_read_b128 v[220:223], v46 offset:12288
    buffer_load_dwordx4 a[56:59], v64, s[24:27], s75 offen offset:2048 sc1
    v_exp_f32 v124, v124
    v_exp_f32 v125, v125
    v_exp_f32 v126, v126
    v_exp_f32 v127, v127
    v_mfma_f32_32x32x16_bf16 v[188:203], v[244:247], v[164:167], v[188:203]
    buffer_load_dwordx4 a[60:63], v64, s[24:27], s75 offen offset:3072 sc1
    v_exp_f32 v128, v128
    v_exp_f32 v129, v129
    v_exp_f32 v130, v130
    v_exp_f32 v131, v131
    v_mfma_f32_32x32x16_bf16 v[188:203], v[248:251], v[168:171], v[188:203]
    ds_read_b128 v[236:239], v47 offset:26784
    ds_read_b128 v[240:243], v48 offset:26784
    s_xor_b32 s75, s75, 0x7000
    buffer_load_dwordx4 a[64:67], v64, s[24:27], s75 offen offset:0 sc1
    v_exp_f32 v132, v132
    v_exp_f32 v133, v133
    v_exp_f32 v134, v134
    v_exp_f32 v135, v135
    v_exp_f32 v136, v136
    v_exp_f32 v137, v137
    v_exp_f32 v138, v138
    v_exp_f32 v139, v139
    v_cvt_pk_bf16_f32 v156, v124, v125
    v_cvt_pk_bf16_f32 v157, v126, v127
    v_cvt_pk_bf16_f32 v158, v128, v129
    v_cvt_pk_bf16_f32 v159, v130, v131
    v_cvt_pk_bf16_f32 v160, v132, v133
    v_cvt_pk_bf16_f32 v161, v134, v135
    v_cvt_pk_bf16_f32 v162, v136, v137
    v_cvt_pk_bf16_f32 v163, v138, v139
    s_waitcnt lgkmcnt(5)
    v_mfma_f32_32x32x16_bf16 v[124:139], v[224:227], v[88:91], 0
    buffer_load_dwordx4 v[76:79], v62, s[24:27], 0 offen sc1
    v_exp_f32 v140, v140
    v_exp_f32 v141, v141
    v_exp_f32 v142, v142
    v_exp_f32 v143, v143
    s_waitcnt lgkmcnt(4)
    v_mfma_f32_32x32x16_bf16 v[188:203], v[228:231], v[156:159], v[188:203]
    buffer_load_dwordx4 a[68:71], v64, s[24:27], s75 offen offset:1024 sc1
    v_exp_f32 v144, v144
    v_exp_f32 v145, v145
    v_exp_f32 v146, v146
    v_exp_f32 v147, v147
    s_waitcnt lgkmcnt(3)
    v_mfma_f32_32x32x16_bf16 v[188:203], v[232:235], v[160:163], v[188:203]
    ds_read_b128 v[244:247], v47 offset:27824
    ds_read_b128 v[248:251], v48 offset:27824
    buffer_load_dwordx4 a[72:75], v64, s[24:27], s75 offen offset:2048 sc1
    v_exp_f32 v148, v148
    v_exp_f32 v149, v149
    v_exp_f32 v150, v150
    v_exp_f32 v151, v151
    v_exp_f32 v152, v152
    v_exp_f32 v153, v153
    v_exp_f32 v154, v154
    v_exp_f32 v155, v155
    v_cvt_pk_bf16_f32 v164, v140, v141
    v_cvt_pk_bf16_f32 v165, v142, v143
    v_cvt_pk_bf16_f32 v166, v144, v145
    v_cvt_pk_bf16_f32 v167, v146, v147
    v_cvt_pk_bf16_f32 v168, v148, v149
    v_cvt_pk_bf16_f32 v169, v150, v151
    v_cvt_pk_bf16_f32 v170, v152, v153
    v_cvt_pk_bf16_f32 v171, v154, v155
    s_waitcnt lgkmcnt(4)
    v_mfma_f32_32x32x16_bf16 v[140:155], v[220:223], v[88:91], v[92:107]
    buffer_load_dwordx4 a[76:79], v64, s[24:27], s75 offen offset:3072 sc1
    v_exp_f32 v124, v124
    v_exp_f32 v125, v125
    v_exp_f32 v126, v126
    v_exp_f32 v127, v127
    s_waitcnt lgkmcnt(3)
    v_mfma_f32_32x32x16_bf16 v[188:203], v[236:239], v[164:167], v[188:203]
    s_xor_b32 s75, s75, 0x1000
    buffer_load_dwordx4 a[80:83], v64, s[24:27], s75 offen offset:0 sc1
    v_exp_f32 v128, v128
    v_exp_f32 v129, v129
    v_exp_f32 v130, v130
    v_exp_f32 v131, v131
    s_waitcnt lgkmcnt(2)
    v_mfma_f32_32x32x16_bf16 v[188:203], v[240:243], v[168:171], v[188:203]
    ds_read_b128 v[228:231], v47 offset:28864
    ds_read_b128 v[232:235], v48 offset:28864
    buffer_load_dwordx4 a[84:87], v64, s[24:27], s75 offen offset:1024 sc1
    v_exp_f32 v132, v132
    v_exp_f32 v133, v133
    v_exp_f32 v134, v134
    v_exp_f32 v135, v135
    v_exp_f32 v136, v136
    v_exp_f32 v137, v137
    v_exp_f32 v138, v138
    v_exp_f32 v139, v139
    v_cvt_pk_bf16_f32 v156, v124, v125
    v_cvt_pk_bf16_f32 v157, v126, v127
    v_cvt_pk_bf16_f32 v158, v128, v129
    v_cvt_pk_bf16_f32 v159, v130, v131
    v_cvt_pk_bf16_f32 v160, v132, v133
    v_cvt_pk_bf16_f32 v161, v134, v135
    v_cvt_pk_bf16_f32 v162, v136, v137
    v_cvt_pk_bf16_f32 v163, v138, v139
    v_exp_f32 v140, v140
    v_exp_f32 v141, v141
    v_exp_f32 v142, v142
    v_exp_f32 v143, v143
    s_waitcnt lgkmcnt(3)
    v_mfma_f32_32x32x16_bf16 v[188:203], v[244:247], v[156:159], v[188:203]
    buffer_load_dwordx4 a[88:91], v64, s[24:27], s75 offen offset:2048 sc1
    v_exp_f32 v144, v144
    v_exp_f32 v145, v145
    v_exp_f32 v146, v146
    v_exp_f32 v147, v147
    s_waitcnt lgkmcnt(2)
    v_mfma_f32_32x32x16_bf16 v[188:203], v[248:251], v[160:163], v[188:203]
    buffer_load_dwordx4 a[92:95], v64, s[24:27], s75 offen offset:3072 sc1
    v_exp_f32 v148, v148
    v_exp_f32 v149, v149
    v_exp_f32 v150, v150
    v_exp_f32 v151, v151
    v_exp_f32 v152, v152
    v_exp_f32 v153, v153
    v_exp_f32 v154, v154
    v_exp_f32 v155, v155
    v_cvt_pk_bf16_f32 v164, v140, v141
    v_cvt_pk_bf16_f32 v165, v142, v143
    v_cvt_pk_bf16_f32 v166, v144, v145
    v_cvt_pk_bf16_f32 v167, v146, v147
    v_cvt_pk_bf16_f32 v168, v148, v149
    v_cvt_pk_bf16_f32 v169, v150, v151
    v_cvt_pk_bf16_f32 v170, v152, v153
    v_cvt_pk_bf16_f32 v171, v154, v155
    s_waitcnt lgkmcnt(1)
    v_mfma_f32_32x32x16_bf16 v[188:203], v[228:231], v[164:167], v[188:203]
    s_waitcnt lgkmcnt(0)
    v_mfma_f32_32x32x16_bf16 v[188:203], v[232:235], v[168:171], v[188:203]
    v_cmp_gt_f32 vcc, s86, v180
    v_cmp_nge_f32 s[40:41], s87, v180
    s_or_b64 s[40:41], s[40:41], vcc
    s_nop 8
    v_cmp_gt_f32 vcc, s86, v196
    s_or_b64 s[40:41], s[40:41], vcc
    v_cmp_nge_f32 vcc, s87, v196
    s_or_b64 vcc, s[40:41], vcc
    s_cbranch_scc1 FB
FB_back:
    v_rcp_f32 v180, v180
    s_nop 0
    v_mul_f32 v172, v172, v180
    v_mul_f32 v173, v173, v180
    v_mul_f32 v174, v174, v180
    v_mul_f32 v175, v175, v180
    v_mul_f32 v176, v176, v180
    v_mul_f32 v177, v177, v180
    v_mul_f32 v178, v178, v180
    v_mul_f32 v179, v179, v180
    v_cvt_pk_bf16_f32 v84, v172, v173
    v_cvt_pk_bf16_f32 v85, v174, v175
    v_cvt_pk_bf16_f32 v86, v176, v177
    v_cvt_pk_bf16_f32 v87, v178, v179
    s_cmp_lg_u32 s81, 0
    s_cbranch_scc1 ALT14
    buffer_store_dwordx4 v[84:87], v2, s[24:27], s74 offen sc1
ALT14_back:
    v_rcp_f32 v196, v196
    s_lshl_b32 s52, s67, 7
    s_add_u32 s74, s74, s52
    v_mul_f32 v188, v188, v196
    v_mul_f32 v189, v189, v196
    v_mul_f32 v190, v190, v196
    v_mul_f32 v191, v191, v196
    v_mul_f32 v192, v192, v196
    v_mul_f32 v193, v193, v196
    v_mul_f32 v194, v194, v196
    v_mul_f32 v195, v195, v196
    v_cvt_pk_bf16_f32 v88, v188, v189
    v_cvt_pk_bf16_f32 v89, v190, v191
    v_cvt_pk_bf16_f32 v90, v192, v193
    v_cvt_pk_bf16_f32 v91, v194, v195
    s_cmp_lg_u32 s81, 0
    s_cbranch_scc1 ALT15
    buffer_store_dwordx4 v[88:91], v2, s[24:27], s74 offen sc1
ALT15_back:
    s_waitcnt vmcnt(27)
    s_waitcnt lgkmcnt(0)
    s_barrier
    ds_read_b64_tr_b16 v[92:93], v60 offset:49152
    ds_read_b64_tr_b16 v[94:95], v60 offset:50176
    ds_read_b64_tr_b16 v[96:97], v57 offset:49152
    ds_read_b64_tr_b16 v[98:99], v57 offset:50176
    ds_read_b64_tr_b16 v[100:101], v60 offset:51200
    ds_read_b64_tr_b16 v[102:103], v60 offset:52224
    ds_read_b64_tr_b16 v[104:105], v57 offset:51200
    ds_read_b64_tr_b16 v[106:107], v57 offset:52224
    ds_read_b64_tr_b16 v[108:109], v60 offset:53248
    ds_read_b64_tr_b16 v[110:111], v60 offset:54272
    ds_read_b64_tr_b16 v[112:113], v57 offset:53248
    ds_read_b64_tr_b16 v[114:115], v57 offset:54272
    .p2align 3
    s_waitcnt lgkmcnt(8)
    v_mfma_f32_32x32x16_bf16 v[140:155], v[92:95], a[0:3], 0
    ds_read_b64_tr_b16 v[116:117], v60 offset:55296
    ds_read_b64_tr_b16 v[118:119], v60 offset:56320
    s_xor_b32 s75, s75, 0x3000
    buffer_load_dwordx4 a[96:99], v64, s[24:27], s75 offen offset:0 sc1
    s_mov_b32 s62, 0xffff0000
    s_xor_b32 s64, s79, 0x4000
    v_mfma_f32_32x32x16_bf16 v[124:139], v[96:99], a[0:3], 0
    ds_read_b64_tr_b16 v[120:121], v57 offset:55296
    ds_read_b64_tr_b16 v[122:123], v57 offset:56320
    buffer_load_dwordx4 a[100:103], v64, s[24:27], s75 offen offset:1024 sc1
    s_waitcnt vmcnt(28) lgkmcnt(8)
    v_mfma_f32_32x32x16_bf16 v[140:155], v[100:103], a[4:7], v[140:155]
    ds_read_b64_tr_b16 v[92:93], v60 offset:57344
    ds_read_b64_tr_b16 v[94:95], v60 offset:58368
    buffer_load_dwordx4 a[104:107], v64, s[24:27], s75 offen offset:2048 sc1
    v_mfma_f32_32x32x16_bf16 v[124:139], v[104:107], a[4:7], v[124:139]
    ds_read_b64_tr_b16 v[96:97], v57 offset:57344
    ds_read_b64_tr_b16 v[98:99], v57 offset:58368
    buffer_load_dwordx4 a[108:111], v64, s[24:27], s75 offen offset:3072 sc1
    s_waitcnt vmcnt(29) lgkmcnt(8)
    v_mfma_f32_32x32x16_bf16 v[140:155], v[108:111], a[8:11], v[140:155]
    ds_read_b64_tr_b16 v[100:101], v60 offset:59392
    ds_read_b64_tr_b16 v[102:103], v60 offset:60416
    v_mfma_f32_32x32x16_bf16 v[124:139], v[112:115], a[8:11], v[124:139]
    ds_read_b64_tr_b16 v[104:105], v57 offset:59392
    ds_read_b64_tr_b16 v[106:107], v57 offset:60416
    s_xor_b32 s75, s75, 0x1000
    buffer_load_dwordx4 a[112:115], v64, s[24:27], s75 offen offset:0 sc1
    s_waitcnt vmcnt(28) lgkmcnt(8)
    v_mfma_f32_32x32x16_bf16 v[140:155], v[116:119], a[12:15], v[140:155]
    ds_read_b64_tr_b16 v[108:109], v60 offset:61440
    ds_read_b64_tr_b16 v[110:111], v60 offset:62464
    s_waitcnt vmcnt(5)
    s_cmp_lg_u32 s81, 0
    s_cbranch_scc1 ALT16
    buffer_store_dword v72, v41, s[24:27], s69 offen
ALT16_back:
    v_mfma_f32_32x32x16_bf16 v[124:139], v[120:123], a[12:15], v[124:139]
    ds_read_b64_tr_b16 v[112:113], v57 offset:61440
    ds_read_b64_tr_b16 v[114:115], v57 offset:62464
    buffer_load_dwordx4 a[116:119], v64, s[24:27], s75 offen offset:1024 sc1
    s_waitcnt lgkmcnt(8)
    v_mfma_f32_32x32x16_bf16 v[140:155], v[92:95], a[16:19], v[140:155]
    ds_read_b64_tr_b16 v[116:117], v60 offset:63488
    ds_read_b64_tr_b16 v[118:119], v60 offset:64512
    buffer_load_dwordx4 a[120:123], v64, s[24:27], s75 offen offset:2048 sc1
    v_mfma_f32_32x32x16_bf16 v[124:139], v[96:99], a[16:19], v[124:139]
    ds_read_b64_tr_b16 v[120:121], v57 offset:63488
    ds_read_b64_tr_b16 v[122:123], v57 offset:64512
    buffer_load_dwordx4 a[124:127], v64, s[24:27], s75 offen offset:3072 sc1
    s_waitcnt lgkmcnt(8)
    v_mfma_f32_32x32x16_bf16 v[140:155], v[100:103], a[20:23], v[140:155]
    ds_read_b64_tr_b16 v[92:93], v60 offset:16384
    ds_read_b64_tr_b16 v[94:95], v60 offset:17408
    v_mfma_f32_32x32x16_bf16 v[124:139], v[104:107], a[20:23], v[124:139]
    ds_read_b64_tr_b16 v[96:97], v60 offset:18432
    ds_read_b64_tr_b16 v[98:99], v60 offset:19456
    s_and_b32 s75, s75, 0x1000
    s_xor_b32 s75, s75, 0x9000
    buffer_load_dwordx4 a[128:131], v64, s[24:27], s75 offen offset:0 sc1
    s_waitcnt lgkmcnt(8)
    v_mfma_f32_32x32x16_bf16 v[140:155], v[108:111], a[24:27], v[140:155]
    ds_read_b64_tr_b16 v[100:101], v60 offset:20480
    ds_read_b64_tr_b16 v[102:103], v60 offset:21504
    buffer_load_dwordx4 a[132:135], v64, s[24:27], s75 offen offset:1024 sc1
    v_mfma_f32_32x32x16_bf16 v[124:139], v[112:115], a[24:27], v[124:139]
    ds_read_b64_tr_b16 v[104:105], v60 offset:22528
    ds_read_b64_tr_b16 v[106:107], v60 offset:23552
    buffer_load_dwordx4 a[136:139], v64, s[24:27], s75 offen offset:2048 sc1
    s_waitcnt lgkmcnt(8)
    v_mfma_f32_32x32x16_bf16 v[140:155], v[116:119], a[28:31], v[140:155]
    ds_read_b64_tr_b16 v[108:109], v60 offset:24576
    ds_read_b64_tr_b16 v[110:111], v60 offset:25600
    v_mfma_f32_32x32x16_bf16 v[124:139], v[120:123], a[28:31], v[124:139]
    ds_read_b64_tr_b16 v[112:113], v60 offset:26624
    ds_read_b64_tr_b16 v[114:115], v60 offset:27648
    buffer_load_dwordx4 a[140:143], v64, s[24:27], s75 offen offset:3072 sc1
    s_waitcnt lgkmcnt(8)
    v_mfma_f32_32x32x16_bf16 v[140:155], v[92:95], a[32:35], v[140:155]
    ds_read_b64_tr_b16 v[116:117], v60 offset:28672
    ds_read_b64_tr_b16 v[118:119], v60 offset:29696
    buffer_load_dword v70, v45, s[24:27], 0 offen sc1
    v_mfma_f32_32x32x16_bf16 v[140:155], v[96:99], a[36:39], v[140:155]
    ds_read_b64_tr_b16 v[120:121], v60 offset:30720
    ds_read_b64_tr_b16 v[122:123], v60 offset:31744
    s_xor_b32 s75, s75, 0x1000
    buffer_load_dwordx4 a[144:147], v64, s[24:27], s75 offen offset:0 sc1
    s_waitcnt lgkmcnt(8)
    v_mfma_f32_32x32x16_bf16 v[140:155], v[100:103], a[40:43], v[140:155]
    ds_read_b64_tr_b16 v[92:93], v60 offset:32768
    ds_read_b64_tr_b16 v[94:95], v60 offset:33792
    buffer_load_dwordx4 a[148:151], v64, s[24:27], s75 offen offset:1024 sc1
    v_mfma_f32_32x32x16_bf16 v[140:155], v[104:107], a[44:47], v[140:155]
    ds_read_b64_tr_b16 v[96:97], v60 offset:34816
    ds_read_b64_tr_b16 v[98:99], v60 offset:35840
    buffer_load_dwordx4 a[152:155], v64, s[24:27], s75 offen offset:2048 sc1
    s_waitcnt lgkmcnt(8)
    v_mfma_f32_32x32x16_bf16 v[140:155], v[108:111], a[48:51], v[140:155]
    ds_read_b64_tr_b16 v[100:101], v60 offset:36864
    ds_read_b64_tr_b16 v[102:103], v60 offset:37888
    v_mfma_f32_32x32x16_bf16 v[140:155], v[112:115], a[52:55], v[140:155]
    ds_read_b64_tr_b16 v[104:105], v60 offset:38912
    ds_read_b64_tr_b16 v[106:107], v60 offset:39936
    buffer_load_dwordx4 a[156:159], v64, s[24:27], s75 offen offset:3072 sc1
    s_waitcnt lgkmcnt(8)
    v_mfma_f32_32x32x16_bf16 v[140:155], v[116:119], a[56:59], v[140:155]
    ds_read_b64_tr_b16 v[108:109], v60 offset:40960
    ds_read_b64_tr_b16 v[110:111], v60 offset:41984
    buffer_load_dword v68, v45, s[24:27], 0 offen sc1
    v_mfma_f32_32x32x16_bf16 v[140:155], v[120:123], a[60:63], v[140:155]
    ds_read_b64_tr_b16 v[112:113], v60 offset:43008
    ds_read_b64_tr_b16 v[114:115], v60 offset:44032
    s_mov_b32 s75, 0xa000
    buffer_load_dwordx4 a[160:163], v64, s[24:27], s75 offen offset:0 sc1
    s_waitcnt lgkmcnt(8)
    v_mfma_f32_32x32x16_bf16 v[140:155], v[92:95], a[64:67], v[140:155]
    ds_read_b64_tr_b16 v[116:117], v60 offset:45056
    ds_read_b64_tr_b16 v[118:119], v60 offset:46080
    buffer_load_dwordx4 a[164:167], v64, s[24:27], s75 offen offset:1024 sc1
    v_mfma_f32_32x32x16_bf16 v[140:155], v[96:99], a[68:71], v[140:155]
    ds_read_b64_tr_b16 v[120:121], v60 offset:47104
    ds_read_b64_tr_b16 v[122:123], v60 offset:48128
    s_cmp_eq_u32 s47, 0
    s_cselect_b32 s75, s75, 0x40000000
    buffer_load_dwordx4 a[168:171], v64, s[24:27], s75 offen offset:2048 sc1
    s_waitcnt lgkmcnt(8)
    v_mfma_f32_32x32x16_bf16 v[140:155], v[100:103], a[72:75], v[140:155]
    ds_read_b64_tr_b16 v[92:93], v59 offset:49152
    ds_read_b64_tr_b16 v[94:95], v59 offset:50176
    buffer_load_dwordx4 a[172:175], v64, s[24:27], s75 offen offset:3072 sc1
    v_mfma_f32_32x32x16_bf16 v[140:155], v[104:107], a[76:79], v[140:155]
    ds_read_b64_tr_b16 v[96:97], v59 offset:51200
    ds_read_b64_tr_b16 v[98:99], v59 offset:52224
    s_waitcnt lgkmcnt(8)
    v_mfma_f32_32x32x16_bf16 v[140:155], v[108:111], a[80:83], v[140:155]
    ds_read_b64_tr_b16 v[100:101], v59 offset:53248
    ds_read_b64_tr_b16 v[102:103], v59 offset:54272
    s_waitcnt vmcnt(9)
    v_cmp_ne_u32 vcc, v70, v72
    s_cbranch_vccnz P3_slow
P3_back:
    buffer_load_dwordx4 a[176:179], v2, s[24:27], s78 offen offset:0 sc1
    v_mfma_f32_32x32x16_bf16 v[140:155], v[112:115], a[84:87], v[140:155]
    ds_read_b64_tr_b16 v[104:105], v59 offset:55296
    ds_read_b64_tr_b16 v[106:107], v59 offset:56320
    buffer_load_dwordx4 a[180:183], v2, s[24:27], s78 offen offset:1024 sc1
    s_waitcnt lgkmcnt(8)
    v_mfma_f32_32x32x16_bf16 v[140:155], v[116:119], a[88:91], v[140:155]
    ds_read_b64_tr_b16 v[108:109], v59 offset:57344
    ds_read_b64_tr_b16 v[110:111], v59 offset:58368
    s_xor_b32 s78, s78, 0x800
    buffer_load_dwordx4 a[184:187], v2, s[24:27], s78 offen offset:0 sc1
    v_mfma_f32_32x32x16_bf16 v[140:155], v[120:123], a[92:95], v[140:155]
    ds_read_b64_tr_b16 v[112:113], v59 offset:59392
    ds_read_b64_tr_b16 v[114:115], v59 offset:60416
    buffer_load_dwordx4 a[188:191], v2, s[24:27], s78 offen offset:1024 sc1
    s_waitcnt lgkmcnt(8)
    v_mfma_f32_32x32x16_bf16 v[140:155], v[92:95], a[96:99], v[140:155]
    ds_read_b64_tr_b16 v[116:117], v59 offset:61440
    ds_read_b64_tr_b16 v[118:119], v59 offset:62464
    s_xor_b32 s78, s78, 0x1800
    buffer_load_dwordx4 a[192:195], v2, s[24:27], s78 offen offset:0 sc1
    v_mfma_f32_32x32x16_bf16 v[140:155], v[96:99], a[100:103], v[140:155]
    ds_read_b64_tr_b16 v[120:121], v59 offset:63488
    ds_read_b64_tr_b16 v[122:123], v59 offset:64512
    s_waitcnt lgkmcnt(8)
    v_mfma_f32_32x32x16_bf16 v[140:155], v[100:103], a[104:107], v[140:155]
    ds_read_b64_tr_b16 v[92:93], v61 offset:0
    ds_read_b64_tr_b16 v[94:95], v61 offset:1024
    buffer_load_dwordx4 a[196:199], v2, s[24:27], s78 offen offset:1024 sc1
    v_mfma_f32_32x32x16_bf16 v[140:155], v[104:107], a[108:111], v[140:155]
    ds_read_b64_tr_b16 v[96:97], v61 offset:2048
    ds_read_b64_tr_b16 v[98:99], v61 offset:3072
    s_xor_b32 s78, s78, 0x800
    buffer_load_dwordx4 a[200:203], v2, s[24:27], s78 offen offset:0 sc1
    s_waitcnt lgkmcnt(8)
    v_mfma_f32_32x32x16_bf16 v[140:155], v[108:111], a[112:115], v[140:155]
    ds_read_b64_tr_b16 v[100:101], v61 offset:4096
    ds_read_b64_tr_b16 v[102:103], v61 offset:5120
    buffer_load_dwordx4 a[204:207], v2, s[24:27], s78 offen offset:1024 sc1
    v_mfma_f32_32x32x16_bf16 v[140:155], v[112:115], a[116:119], v[140:155]
    ds_read_b64_tr_b16 v[104:105], v61 offset:6144
    ds_read_b64_tr_b16 v[106:107], v61 offset:7168
    s_waitcnt lgkmcnt(8)
    v_mfma_f32_32x32x16_bf16 v[140:155], v[116:119], a[120:123], v[140:155]
    ds_read_b64_tr_b16 v[108:109], v61 offset:8192
    ds_read_b64_tr_b16 v[110:111], v61 offset:9216
    s_xor_b32 s78, s78, 0x3800
    buffer_load_dwordx4 a[208:211], v2, s[24:27], s78 offen offset:0 sc1
    v_mfma_f32_32x32x16_bf16 v[140:155], v[120:123], a[124:127], v[140:155]
    ds_read_b64_tr_b16 v[112:113], v61 offset:10240
    ds_read_b64_tr_b16 v[114:115], v61 offset:11264
    buffer_load_dwordx4 a[212:215], v2, s[24:27], s78 offen offset:1024 sc1
    s_waitcnt lgkmcnt(8)
    v_mfma_f32_32x32x16_bf16 v[140:155], v[92:95], a[128:131], v[140:155]
    ds_read_b64_tr_b16 v[116:117], v61 offset:12288
    ds_read_b64_tr_b16 v[118:119], v61 offset:13312
    s_xor_b32 s78, s78, 0x800
    buffer_load_dwordx4 a[216:219], v2, s[24:27], s78 offen offset:0 sc1
    v_mfma_f32_32x32x16_bf16 v[140:155], v[96:99], a[132:135], v[140:155]
    ds_read_b64_tr_b16 v[120:121], v61 offset:14336
    ds_read_b64_tr_b16 v[122:123], v61 offset:15360
    s_waitcnt lgkmcnt(8)
    v_mfma_f32_32x32x16_bf16 v[140:155], v[100:103], a[136:139], v[140:155]
    ds_read_b64_tr_b16 v[92:93], v59 offset:36864
    ds_read_b64_tr_b16 v[94:95], v59 offset:37888
    buffer_load_dwordx4 a[220:223], v2, s[24:27], s78 offen offset:1024 sc1
    v_mfma_f32_32x32x16_bf16 v[140:155], v[104:107], a[140:143], v[140:155]
    ds_read_b64_tr_b16 v[96:97], v59 offset:38912
    ds_read_b64_tr_b16 v[98:99], v59 offset:39936
    s_xor_b32 s78, s78, 0x1800
    buffer_load_dwordx4 a[224:227], v2, s[24:27], s78 offen offset:0 sc1
    s_waitcnt vmcnt(21) lgkmcnt(8)
    v_mfma_f32_32x32x16_bf16 v[140:155], v[108:111], a[144:147], v[140:155]
    ds_read_b64_tr_b16 v[100:101], v59 offset:40960
    ds_read_b64_tr_b16 v[102:103], v59 offset:41984
    buffer_load_dwordx4 a[228:231], v2, s[24:27], s78 offen offset:1024 sc1
    s_waitcnt vmcnt(21)
    v_mfma_f32_32x32x16_bf16 v[140:155], v[112:115], a[148:151], v[140:155]
    ds_read_b64_tr_b16 v[104:105], v59 offset:43008
    ds_read_b64_tr_b16 v[106:107], v59 offset:44032
    s_waitcnt vmcnt(20) lgkmcnt(8)
    v_mfma_f32_32x32x16_bf16 v[140:155], v[116:119], a[152:155], v[140:155]
    ds_read_b64_tr_b16 v[108:109], v60 offset:0
    ds_read_b64_tr_b16 v[110:111], v60 offset:1024
    s_xor_b32 s78, s78, 0x800
    buffer_load_dwordx4 a[232:235], v2, s[24:27], s78 offen offset:0 sc1
    s_waitcnt vmcnt(20)
    v_mfma_f32_32x32x16_bf16 v[140:155], v[120:123], a[156:159], v[140:155]
    ds_read_b64_tr_b16 v[112:113], v60 offset:2048
    ds_read_b64_tr_b16 v[114:115], v60 offset:3072
    buffer_load_dwordx4 a[236:239], v2, s[24:27], s78 offen offset:1024 sc1
    s_waitcnt vmcnt(19) lgkmcnt(8)
    v_mfma_f32_32x32x16_bf16 v[140:155], v[92:95], a[160:163], v[140:155]
    ds_read_b64_tr_b16 v[116:117], v60 offset:4096
    ds_read_b64_tr_b16 v[118:119], v60 offset:5120
    s_waitcnt vmcnt(18)
    v_mfma_f32_32x32x16_bf16 v[140:155], v[96:99], a[164:167], v[140:155]
    ds_read_b64_tr_b16 v[120:121], v60 offset:6144
    ds_read_b64_tr_b16 v[122:123], v60 offset:7168
    s_waitcnt vmcnt(17) lgkmcnt(8)
    v_mfma_f32_32x32x16_bf16 v[140:155], v[100:103], a[168:171], v[140:155]
    ds_read_b64_tr_b16 v[92:93], v60 offset:8192
    ds_read_b64_tr_b16 v[94:95], v60 offset:9216
    s_waitcnt vmcnt(16)
    v_mfma_f32_32x32x16_bf16 v[140:155], v[104:107], a[172:175], v[140:155]
    ds_read_b64_tr_b16 v[96:97], v60 offset:10240
    ds_read_b64_tr_b16 v[98:99], v60 offset:11264
    s_waitcnt vmcnt(15) lgkmcnt(8)
    v_mfma_f32_32x32x16_bf16 v[172:187], v[108:111], a[176:179], 0
    ds_read_b64_tr_b16 v[100:101], v60 offset:12288
    ds_read_b64_tr_b16 v[102:103], v60 offset:13312
    v_cmp_ne_u64 vcc, v[78:79], v[72:73]
    s_cbranch_vccnz G3_slow
G3_back:
    s_nop 3
    v_mul_f32 v140, v77, v140
    v_mul_f32 v141, v77, v141
    v_mul_f32 v142, v77, v142
    v_mul_f32 v143, v77, v143
    s_waitcnt vmcnt(14)
    v_mfma_f32_32x32x16_bf16 v[172:187], v[112:115], a[180:183], v[172:187]
    ds_read_b64_tr_b16 v[104:105], v60 offset:14336
    ds_read_b64_tr_b16 v[106:107], v60 offset:15360
    v_mul_f32 v144, v77, v144
    v_mul_f32 v145, v77, v145
    v_mul_f32 v146, v77, v146
    v_mul_f32 v147, v77, v147
    s_waitcnt vmcnt(13) lgkmcnt(8)
    v_mfma_f32_32x32x16_bf16 v[172:187], v[116:119], a[184:187], v[172:187]
    ds_read_b64_tr_b16 v[108:109], v61 offset:16384
    ds_read_b64_tr_b16 v[110:111], v61 offset:17408
    v_mul_f32 v148, v77, v148
    v_mul_f32 v149, v77, v149
    v_mul_f32 v150, v77, v150
    v_mul_f32 v151, v77, v151
    s_waitcnt vmcnt(12)
    v_mfma_f32_32x32x16_bf16 v[172:187], v[120:123], a[188:191], v[172:187]
    ds_read_b64_tr_b16 v[112:113], v61 offset:18432
    ds_read_b64_tr_b16 v[114:115], v61 offset:19456
    v_mul_f32 v152, v77, v152
    v_mul_f32 v153, v77, v153
    v_mul_f32 v154, v77, v154
    v_mul_f32 v155, v77, v155
    s_waitcnt vmcnt(11) lgkmcnt(8)
    v_mfma_f32_32x32x16_bf16 v[172:187], v[92:95], a[192:195], v[172:187]
    ds_read_b64_tr_b16 v[116:117], v61 offset:20480
    ds_read_b64_tr_b16 v[118:119], v61 offset:21504
    s_waitcnt vmcnt(10)
    v_mfma_f32_32x32x16_bf16 v[172:187], v[96:99], a[196:199], v[172:187]
    ds_read_b64_tr_b16 v[120:121], v61 offset:22528
    ds_read_b64_tr_b16 v[122:123], v61 offset:23552
    s_waitcnt vmcnt(9) lgkmcnt(8)
    v_mfma_f32_32x32x16_bf16 v[172:187], v[100:103], a[200:203], v[172:187]
    ds_read_b64_tr_b16 v[92:93], v61 offset:24576
    ds_read_b64_tr_b16 v[94:95], v61 offset:25600
    s_waitcnt vmcnt(8)
    v_mfma_f32_32x32x16_bf16 v[172:187], v[104:107], a[204:207], v[172:187]
    ds_read_b64_tr_b16 v[96:97], v61 offset:26624
    ds_read_b64_tr_b16 v[98:99], v61 offset:27648
    s_waitcnt vmcnt(7) lgkmcnt(8)
    v_mfma_f32_32x32x16_bf16 v[172:187], v[108:111], a[208:211], v[172:187]
    ds_read_b64_tr_b16 v[100:101], v61 offset:28672
    ds_read_b64_tr_b16 v[102:103], v61 offset:29696
    s_waitcnt vmcnt(6)
    v_mfma_f32_32x32x16_bf16 v[172:187], v[112:115], a[212:215], v[172:187]
    ds_read_b64_tr_b16 v[104:105], v61 offset:30720
    ds_read_b64_tr_b16 v[106:107], v61 offset:31744
    s_waitcnt vmcnt(5) lgkmcnt(8)
    v_mfma_f32_32x32x16_bf16 v[172:187], v[116:119], a[216:219], v[172:187]
    ds_read_b64_tr_b16 v[108:109], v57 offset:16384
    ds_read_b64_tr_b16 v[110:111], v57 offset:17408
    s_waitcnt vmcnt(4)
    v_mfma_f32_32x32x16_bf16 v[172:187], v[120:123], a[220:223], v[172:187]
    ds_read_b64_tr_b16 v[112:113], v57 offset:18432
    ds_read_b64_tr_b16 v[114:115], v57 offset:19456
    s_waitcnt vmcnt(3) lgkmcnt(8)
    v_mfma_f32_32x32x16_bf16 v[172:187], v[92:95], a[224:227], v[172:187]
    ds_read_b64_tr_b16 v[116:117], v57 offset:20480
    ds_read_b64_tr_b16 v[118:119], v57 offset:21504
    s_waitcnt vmcnt(2)
    v_mfma_f32_32x32x16_bf16 v[172:187], v[96:99], a[228:231], v[172:187]
    ds_read_b64_tr_b16 v[120:121], v57 offset:22528
    ds_read_b64_tr_b16 v[122:123], v57 offset:23552
    s_waitcnt vmcnt(1) lgkmcnt(8)
    v_mfma_f32_32x32x16_bf16 v[172:187], v[100:103], a[232:235], v[172:187]
    ds_read_b64_tr_b16 v[92:93], v57 offset:24576
    ds_read_b64_tr_b16 v[94:95], v57 offset:25600
    s_waitcnt vmcnt(0)
    v_mfma_f32_32x32x16_bf16 v[172:187], v[104:107], a[236:239], v[172:187]
    ds_read_b64_tr_b16 v[96:97], v57 offset:26624
    ds_read_b64_tr_b16 v[98:99], v57 offset:27648
    s_waitcnt lgkmcnt(8)
    v_mfma_f32_32x32x16_bf16 v[124:139], v[108:111], a[32:35], v[124:139]
    ds_read_b64_tr_b16 v[100:101], v57 offset:28672
    ds_read_b64_tr_b16 v[102:103], v57 offset:29696
    s_nop 5
    v_fmac_f32 v140, v76, v172
    v_fmac_f32 v141, v76, v173
    v_fmac_f32 v142, v76, v174
    v_fmac_f32 v143, v76, v175
    v_mfma_f32_32x32x16_bf16 v[124:139], v[112:115], a[36:39], v[124:139]
    ds_read_b64_tr_b16 v[104:105], v57 offset:30720
    ds_read_b64_tr_b16 v[106:107], v57 offset:31744
    v_fmac_f32 v144, v76, v176
    v_fmac_f32 v145, v76, v177
    v_fmac_f32 v146, v76, v178
    v_fmac_f32 v147, v76, v179
    s_waitcnt lgkmcnt(8)
    v_mfma_f32_32x32x16_bf16 v[124:139], v[116:119], a[40:43], v[124:139]
    ds_read_b64_tr_b16 v[108:109], v57 offset:32768
    ds_read_b64_tr_b16 v[110:111], v57 offset:33792
    v_cvt_pk_bf16_f32 v140, v140, v141
    v_cvt_pk_bf16_f32 v141, v142, v143
    v_cvt_pk_bf16_f32 v142, v144, v145
    v_cvt_pk_bf16_f32 v143, v146, v147
    v_mfma_f32_32x32x16_bf16 v[124:139], v[120:123], a[44:47], v[124:139]
    ds_read_b64_tr_b16 v[112:113], v57 offset:34816
    ds_read_b64_tr_b16 v[114:115], v57 offset:35840
    v_min_u32 v140, -2, v140
    buffer_store_dwordx4 v[140:143], v2, s[24:27], s79 offen offset:0 sc1
    v_fmac_f32 v148, v76, v180
    v_fmac_f32 v149, v76, v181
    s_waitcnt lgkmcnt(8)
    v_mfma_f32_32x32x16_bf16 v[124:139], v[92:95], a[48:51], v[124:139]
    ds_read_b64_tr_b16 v[116:117], v57 offset:36864
    ds_read_b64_tr_b16 v[118:119], v57 offset:37888
    v_fmac_f32 v150, v76, v182
    v_fmac_f32 v151, v76, v183
    v_fmac_f32 v152, v76, v184
    v_fmac_f32 v153, v76, v185
    v_mfma_f32_32x32x16_bf16 v[124:139], v[96:99], a[52:55], v[124:139]
    ds_read_b64_tr_b16 v[120:121], v57 offset:38912
    ds_read_b64_tr_b16 v[122:123], v57 offset:39936
    v_fmac_f32 v154, v76, v186
    v_fmac_f32 v155, v76, v187
    v_cvt_pk_bf16_f32 v148, v148, v149
    v_cvt_pk_bf16_f32 v149, v150, v151
    s_waitcnt lgkmcnt(8)
    v_mfma_f32_32x32x16_bf16 v[124:139], v[100:103], a[56:59], v[124:139]
    ds_read_b64_tr_b16 v[92:93], v57 offset:40960
    ds_read_b64_tr_b16 v[94:95], v57 offset:41984
    v_cvt_pk_bf16_f32 v150, v152, v153
    v_cvt_pk_bf16_f32 v151, v154, v155
    v_min_u32 v148, -2, v148
    buffer_store_dwordx4 v[148:151], v2, s[24:27], s79 offen offset:1024 sc1
    v_mfma_f32_32x32x16_bf16 v[124:139], v[104:107], a[60:63], v[124:139]
    ds_read_b64_tr_b16 v[96:97], v57 offset:43008
    ds_read_b64_tr_b16 v[98:99], v57 offset:44032
    s_waitcnt lgkmcnt(8)
    v_mfma_f32_32x32x16_bf16 v[124:139], v[108:111], a[64:67], v[124:139]
    ds_read_b64_tr_b16 v[100:101], v57 offset:45056
    ds_read_b64_tr_b16 v[102:103], v57 offset:46080
    v_mfma_f32_32x32x16_bf16 v[124:139], v[112:115], a[68:71], v[124:139]
    ds_read_b64_tr_b16 v[104:105], v57 offset:47104
    ds_read_b64_tr_b16 v[106:107], v57 offset:48128
    s_waitcnt lgkmcnt(8)
    v_mfma_f32_32x32x16_bf16 v[124:139], v[116:119], a[72:75], v[124:139]
    ds_read_b64_tr_b16 v[108:109], v56 offset:49152
    ds_read_b64_tr_b16 v[110:111], v56 offset:50176
    v_mfma_f32_32x32x16_bf16 v[124:139], v[120:123], a[76:79], v[124:139]
    ds_read_b64_tr_b16 v[112:113], v56 offset:51200
    ds_read_b64_tr_b16 v[114:115], v56 offset:52224
    s_waitcnt lgkmcnt(8)
    v_mfma_f32_32x32x16_bf16 v[124:139], v[92:95], a[80:83], v[124:139]
    ds_read_b64_tr_b16 v[116:117], v56 offset:53248
    ds_read_b64_tr_b16 v[118:119], v56 offset:54272
    v_mfma_f32_32x32x16_bf16 v[124:139], v[96:99], a[84:87], v[124:139]
    ds_read_b64_tr_b16 v[120:121], v56 offset:55296
    ds_read_b64_tr_b16 v[122:123], v56 offset:56320
    s_waitcnt lgkmcnt(8)
    v_mfma_f32_32x32x16_bf16 v[124:139], v[100:103], a[88:91], v[124:139]
    ds_read_b64_tr_b16 v[92:93], v56 offset:57344
    ds_read_b64_tr_b16 v[94:95], v56 offset:58368
    v_mfma_f32_32x32x16_bf16 v[124:139], v[104:107], a[92:95], v[124:139]
    ds_read_b64_tr_b16 v[96:97], v56 offset:59392
    ds_read_b64_tr_b16 v[98:99], v56 offset:60416
    s_waitcnt lgkmcnt(8)
    v_mfma_f32_32x32x16_bf16 v[124:139], v[108:111], a[96:99], v[124:139]
    ds_read_b64_tr_b16 v[100:101], v56 offset:61440
    ds_read_b64_tr_b16 v[102:103], v56 offset:62464
    v_mfma_f32_32x32x16_bf16 v[124:139], v[112:115], a[100:103], v[124:139]
    ds_read_b64_tr_b16 v[104:105], v56 offset:63488
    ds_read_b64_tr_b16 v[106:107], v56 offset:64512
    s_waitcnt lgkmcnt(8)
    v_mfma_f32_32x32x16_bf16 v[124:139], v[116:119], a[104:107], v[124:139]
    ds_read_b64_tr_b16 v[108:109], v58 offset:0
    ds_read_b64_tr_b16 v[110:111], v58 offset:1024
    v_mfma_f32_32x32x16_bf16 v[124:139], v[120:123], a[108:111], v[124:139]
    ds_read_b64_tr_b16 v[112:113], v58 offset:2048
    ds_read_b64_tr_b16 v[114:115], v58 offset:3072
    s_waitcnt lgkmcnt(8)
    v_mfma_f32_32x32x16_bf16 v[124:139], v[92:95], a[112:115], v[124:139]
    ds_read_b64_tr_b16 v[116:117], v58 offset:4096
    ds_read_b64_tr_b16 v[118:119], v58 offset:5120
    v_mfma_f32_32x32x16_bf16 v[124:139], v[96:99], a[116:119], v[124:139]
    ds_read_b64_tr_b16 v[120:121], v58 offset:6144
    ds_read_b64_tr_b16 v[122:123], v58 offset:7168
    s_waitcnt lgkmcnt(8)
    v_mfma_f32_32x32x16_bf16 v[124:139], v[100:103], a[120:123], v[124:139]
    ds_read_b64_tr_b16 v[92:93], v58 offset:8192
    ds_read_b64_tr_b16 v[94:95], v58 offset:9216
    v_mfma_f32_32x32x16_bf16 v[124:139], v[104:107], a[124:127], v[124:139]
    ds_read_b64_tr_b16 v[96:97], v58 offset:10240
    ds_read_b64_tr_b16 v[98:99], v58 offset:11264
    s_waitcnt lgkmcnt(8)
    v_mfma_f32_32x32x16_bf16 v[124:139], v[108:111], a[128:131], v[124:139]
    ds_read_b64_tr_b16 v[100:101], v58 offset:12288
    ds_read_b64_tr_b16 v[102:103], v58 offset:13312
    v_mfma_f32_32x32x16_bf16 v[124:139], v[112:115], a[132:135], v[124:139]
    ds_read_b64_tr_b16 v[104:105], v58 offset:14336
    ds_read_b64_tr_b16 v[106:107], v58 offset:15360
    s_waitcnt lgkmcnt(8)
    v_mfma_f32_32x32x16_bf16 v[124:139], v[116:119], a[136:139], v[124:139]
    ds_read_b64_tr_b16 v[108:109], v56 offset:36864
    ds_read_b64_tr_b16 v[110:111], v56 offset:37888
    v_mfma_f32_32x32x16_bf16 v[124:139], v[120:123], a[140:143], v[124:139]
    ds_read_b64_tr_b16 v[112:113], v56 offset:38912
    ds_read_b64_tr_b16 v[114:115], v56 offset:39936
    s_waitcnt lgkmcnt(8)
    v_mfma_f32_32x32x16_bf16 v[124:139], v[92:95], a[144:147], v[124:139]
    ds_read_b64_tr_b16 v[116:117], v56 offset:40960
    ds_read_b64_tr_b16 v[118:119], v56 offset:41984
    v_mfma_f32_32x32x16_bf16 v[124:139], v[96:99], a[148:151], v[124:139]
    ds_read_b64_tr_b16 v[120:121], v56 offset:43008
    ds_read_b64_tr_b16 v[122:123], v56 offset:44032
    s_waitcnt lgkmcnt(8)
    v_mfma_f32_32x32x16_bf16 v[124:139], v[100:103], a[152:155], v[124:139]
    ds_read_b64_tr_b16 v[92:93], v57 offset:0
    ds_read_b64_tr_b16 v[94:95], v57 offset:1024
    v_mfma_f32_32x32x16_bf16 v[124:139], v[104:107], a[156:159], v[124:139]
    ds_read_b64_tr_b16 v[96:97], v57 offset:2048
    ds_read_b64_tr_b16 v[98:99], v57 offset:3072
    s_waitcnt lgkmcnt(8)
    v_mfma_f32_32x32x16_bf16 v[124:139], v[108:111], a[160:163], v[124:139]
    ds_read_b64_tr_b16 v[100:101], v57 offset:4096
    ds_read_b64_tr_b16 v[102:103], v57 offset:5120
    buffer_load_dwordx4 v[188:191], v2, s[24:27], s64 offen offset:0 sc1
    v_mfma_f32_32x32x16_bf16 v[124:139], v[112:115], a[164:167], v[124:139]
    ds_read_b64_tr_b16 v[104:105], v57 offset:6144
    ds_read_b64_tr_b16 v[106:107], v57 offset:7168
    buffer_load_dwordx4 v[192:195], v2, s[24:27], s64 offen offset:1024 sc1
    s_waitcnt lgkmcnt(8)
    v_mfma_f32_32x32x16_bf16 v[124:139], v[116:119], a[168:171], v[124:139]
    ds_read_b64_tr_b16 v[108:109], v57 offset:8192
    ds_read_b64_tr_b16 v[110:111], v57 offset:9216
    v_mfma_f32_32x32x16_bf16 v[124:139], v[120:123], a[172:175], v[124:139]
    ds_read_b64_tr_b16 v[112:113], v57 offset:10240
    ds_read_b64_tr_b16 v[114:115], v57 offset:11264
    s_waitcnt lgkmcnt(8)
    v_mfma_f32_32x32x16_bf16 v[156:171], v[92:95], a[176:179], 0
    ds_read_b64_tr_b16 v[116:117], v57 offset:12288
    ds_read_b64_tr_b16 v[118:119], v57 offset:13312
    s_nop 5
    v_mul_f32 v124, v77, v124
    v_mul_f32 v125, v77, v125
    v_mul_f32 v126, v77, v126
    v_mul_f32 v127, v77, v127
    v_mfma_f32_32x32x16_bf16 v[156:171], v[96:99], a[180:183], v[156:171]
    ds_read_b64_tr_b16 v[120:121], v57 offset:14336
    ds_read_b64_tr_b16 v[122:123], v57 offset:15360
    v_mul_f32 v128, v77, v128
    v_mul_f32 v129, v77, v129
    v_mul_f32 v130, v77, v130
    v_mul_f32 v131, v77, v131
    s_waitcnt lgkmcnt(8)
    v_mfma_f32_32x32x16_bf16 v[156:171], v[100:103], a[184:187], v[156:171]
    ds_read_b64_tr_b16 v[92:93], v58 offset:16384
    ds_read_b64_tr_b16 v[94:95], v58 offset:17408
    v_mul_f32 v132, v77, v132
    v_mul_f32 v133, v77, v133
    v_mul_f32 v134, v77, v134
    v_mul_f32 v135, v77, v135
    v_mfma_f32_32x32x16_bf16 v[156:171], v[104:107], a[188:191], v[156:171]
    ds_read_b64_tr_b16 v[96:97], v58 offset:18432
    ds_read_b64_tr_b16 v[98:99], v58 offset:19456
    v_mul_f32 v136, v77, v136
    v_mul_f32 v137, v77, v137
    v_mul_f32 v138, v77, v138
    v_mul_f32 v139, v77, v139
    s_waitcnt lgkmcnt(8)
    v_mfma_f32_32x32x16_bf16 v[156:171], v[108:111], a[192:195], v[156:171]
    ds_read_b64_tr_b16 v[100:101], v58 offset:20480
    ds_read_b64_tr_b16 v[102:103], v58 offset:21504
    v_mfma_f32_32x32x16_bf16 v[156:171], v[112:115], a[196:199], v[156:171]
    ds_read_b64_tr_b16 v[104:105], v58 offset:22528
    ds_read_b64_tr_b16 v[106:107], v58 offset:23552
    s_waitcnt lgkmcnt(8)
    v_mfma_f32_32x32x16_bf16 v[156:171], v[116:119], a[200:203], v[156:171]
    ds_read_b64_tr_b16 v[108:109], v58 offset:24576
    ds_read_b64_tr_b16 v[110:111], v58 offset:25600
    buffer_load_dwordx4 v[204:207], v2, s[24:27], s64 offen offset:0 sc1
    v_mfma_f32_32x32x16_bf16 v[156:171], v[120:123], a[204:207], v[156:171]
    ds_read_b64_tr_b16 v[112:113], v58 offset:26624
    ds_read_b64_tr_b16 v[114:115], v58 offset:27648
    buffer_load_dwordx4 v[208:211], v2, s[24:27], s64 offen offset:1024 sc1
    s_waitcnt lgkmcnt(8)
    v_mfma_f32_32x32x16_bf16 v[156:171], v[92:95], a[208:211], v[156:171]
    ds_read_b64_tr_b16 v[116:117], v58 offset:28672
    ds_read_b64_tr_b16 v[118:119], v58 offset:29696
    v_mfma_f32_32x32x16_bf16 v[156:171], v[96:99], a[212:215], v[156:171]
    ds_read_b64_tr_b16 v[120:121], v58 offset:30720
    ds_read_b64_tr_b16 v[122:123], v58 offset:31744
    s_waitcnt lgkmcnt(8)
    v_mfma_f32_32x32x16_bf16 v[156:171], v[100:103], a[216:219], v[156:171]
    v_mfma_f32_32x32x16_bf16 v[156:171], v[104:107], a[220:223], v[156:171]
    s_waitcnt lgkmcnt(4)
    v_mfma_f32_32x32x16_bf16 v[156:171], v[108:111], a[224:227], v[156:171]
    v_mfma_f32_32x32x16_bf16 v[156:171], v[112:115], a[228:231], v[156:171]
    s_waitcnt lgkmcnt(0)
    v_mfma_f32_32x32x16_bf16 v[156:171], v[116:119], a[232:235], v[156:171]
    v_mfma_f32_32x32x16_bf16 v[156:171], v[120:123], a[236:239], v[156:171]
    s_nop 11
    v_fmac_f32 v124, v76, v156
    v_fmac_f32 v125, v76, v157
    v_fmac_f32 v126, v76, v158
    v_fmac_f32 v127, v76, v159
    v_fmac_f32 v128, v76, v160
    v_fmac_f32 v129, v76, v161
    v_fmac_f32 v130, v76, v162
    v_fmac_f32 v131, v76, v163
    v_fmac_f32 v132, v76, v164
    v_fmac_f32 v133, v76, v165
    v_fmac_f32 v134, v76, v166
    v_fmac_f32 v135, v76, v167
    v_fmac_f32 v136, v76, v168
    v_fmac_f32 v137, v76, v169
    v_fmac_f32 v138, v76, v170
    v_fmac_f32 v139, v76, v171
    s_waitcnt vmcnt(2)
    v_max_u32 v8, v188, v192
    v_cmp_eq_u32 vcc, -1, v8
    s_cbranch_vccnz RX_slow
RX_back:
    v_lshlrev_b32 v4, 16, v188
    v_and_b32 v5, s62, v188
    v_lshlrev_b32 v6, 16, v189
    v_and_b32 v7, s62, v189
    v_add_f32 v124, v124, v4
    v_add_f32 v125, v125, v5
    v_add_f32 v126, v126, v6
    v_add_f32 v127, v127, v7
    v_cvt_pk_bf16_f32 v140, v124, v125
    v_cvt_pk_bf16_f32 v141, v126, v127
    ds_write_b64 v65, v[140:141]
    v_xor_b32 v65, 16, v65
    s_movk_i32 s52, 16384
    v_lshlrev_b32 v4, 16, v190
    v_and_b32 v5, s62, v190
    v_lshlrev_b32 v6, 16, v191
    v_and_b32 v7, s62, v191
    v_add_f32 v128, v128, v4
    v_add_f32 v129, v129, v5
    v_add_f32 v130, v130, v6
    v_add_f32 v131, v131, v7
    v_cvt_pk_bf16_f32 v142, v128, v129
    v_cvt_pk_bf16_f32 v143, v130, v131
    ds_write_b64 v65, v[142:143]
    v_xor_b32 v65, 48, v65
    v_lshlrev_b32 v4, 16, v192
    v_and_b32 v5, s62, v192
    v_lshlrev_b32 v6, 16, v193
    v_and_b32 v7, s62, v193
    v_add_f32 v132, v132, v4
    v_add_f32 v133, v133, v5
    v_add_f32 v134, v134, v6
    v_add_f32 v135, v135, v7
    v_cvt_pk_bf16_f32 v144, v132, v133
    v_cvt_pk_bf16_f32 v145, v134, v135
    ds_write_b64 v65, v[144:145]
    v_xor_b32 v65, 16, v65
    v_lshlrev_b32 v4, 16, v194
    v_and_b32 v5, s62, v194
    v_lshlrev_b32 v6, 16, v195
    v_and_b32 v7, s62, v195
    v_add_f32 v136, v136, v4
    v_add_f32 v137, v137, v5
    v_add_f32 v138, v138, v6
    v_add_f32 v139, v139, v7
    v_cvt_pk_bf16_f32 v146, v136, v137
    v_cvt_pk_bf16_f32 v147, v138, v139
    ds_write_b64 v65, v[146:147]
    ds_read_b128 v[124:127], v66 offset:0
    ds_read_b128 v[128:131], v66 offset:1024
    s_waitcnt lgkmcnt(1)
    buffer_store_dwordx4 v[124:127], v63, s[28:31], 0 offen nt
    s_waitcnt lgkmcnt(0)
    buffer_store_dwordx4 v[128:131], v63, s[28:31], s52 offen nt
L_end:
    s_endpgm
TAGQK_slow:
    s_mov_b32 s88, 1048576
TAGQK_loop:
    buffer_load_dwordx4 v[72:75], off, s[32:35], 0 sc1
    s_waitcnt vmcnt(0)
    v_cmp_eq_u32 vcc, 0, v74
    s_cbranch_vccz TAGQK_back
    s_sub_u32 s88, s88, 1
    s_cmp_lg_u32 s88, 0
    s_cbranch_scc1 TAGQK_loop
    s_branch TAGQK_back
CHKQK_slow:
    s_mov_b32 s88, 6
CHKQK_loop:
    buffer_load_dwordx2 v[70:71], v77, s[24:27], s84 offen sc1
    s_waitcnt vmcnt(0)
    v_cmp_ne_u64 vcc, v[70:71], v[68:69]
    s_cbranch_vccz CHKQK_back
    s_sub_u32 s88, s88, 1
    s_cmp_lg_u32 s88, 0
    s_cbranch_scc1 CHKQK_loop
    s_mov_b32 s81, 1
    s_branch CHKQK_back
P1QK_slow:
    s_mov_b32 s88, 1048576
P1QK_loop:
    buffer_load_dwordx2 v[70:71], v42, s[24:27], 0 offen sc1
    s_waitcnt vmcnt(0)
    v_cmp_ne_u64 vcc, v[70:71], v[72:73]
    s_cbranch_vccz P1QK_back
    s_sub_u32 s88, s88, 1
    s_cmp_lg_u32 s88, 0
    s_cbranch_scc1 P1QK_loop
    s_branch P1QK_back
DUPQK:
    s_waitcnt lgkmcnt(8)
    v_mfma_f32_32x32x16_bf16 v[140:155], v[236:239], a[112:115], v[140:155]
    ds_read_b64_tr_b16 v[228:229], v32 offset:57344
    ds_read_b64_tr_b16 v[230:231], v32 offset:58368
    v_fmamk_f32 v120, v11, 0xc1bc0000, v9
    v_min_f32 v104, 0, v120
    v_mfma_f32_32x32x16_bf16 v[140:155], v[240:243], a[116:119], v[140:155]
    ds_read_b64_tr_b16 v[232:233], v32 offset:61440
    ds_read_b64_tr_b16 v[234:235], v32 offset:62464
    v_min_f32 v120, 0, -v120
    v_fmamk_f32 v121, v11, 0xc1c40000, v9
    s_waitcnt lgkmcnt(8)
    v_mfma_f32_32x32x16_bf16 v[140:155], v[244:247], a[120:123], v[140:155]
    ds_read_b64_tr_b16 v[236:237], v33 offset:49152
    ds_read_b64_tr_b16 v[238:239], v33 offset:50176
    v_mul_f32 v124, s42, v124
    v_mul_f32 v125, s42, v125
    v_mul_f32 v126, s42, v126
    v_mul_f32 v127, s42, v127
    v_mul_f32 v128, s42, v128
    v_mul_f32 v129, s42, v129
    v_mfma_f32_32x32x16_bf16 v[140:155], v[248:251], a[124:127], v[140:155]
    ds_read_b64_tr_b16 v[240:241], v33 offset:53248
    ds_read_b64_tr_b16 v[242:243], v33 offset:54272
    v_mul_f32 v130, s42, v130
    v_mul_f32 v131, s42, v131
    v_cvt_pk_bf16_f32 v124, v124, v125
    v_cvt_pk_bf16_f32 v125, v126, v127
    v_cvt_pk_bf16_f32 v126, v128, v129
    s_waitcnt lgkmcnt(8)
    v_mfma_f32_32x32x16_bf16 v[156:171], v[220:223], a[112:115], v[156:171]
    ds_read_b64_tr_b16 v[244:245], v33 offset:57344
    ds_read_b64_tr_b16 v[246:247], v33 offset:58368
    v_cvt_pk_bf16_f32 v127, v130, v131
    buffer_store_dwordx4 v[124:127], v2, s[24:27], s65 offen sc1
    v_mul_f32 v132, s42, v132
    v_mul_f32 v133, s42, v133
    v_mul_f32 v134, s42, v134
    v_mfma_f32_32x32x16_bf16 v[156:171], v[224:227], a[116:119], v[156:171]
    ds_read_b64_tr_b16 v[248:249], v33 offset:61440
    ds_read_b64_tr_b16 v[250:251], v33 offset:62464
    v_mul_f32 v135, s42, v135
    v_mul_f32 v136, s42, v136
    v_mul_f32 v137, s42, v137
    v_mul_f32 v138, s42, v138
    v_mul_f32 v139, s42, v139
    s_waitcnt lgkmcnt(8)
    v_mfma_f32_32x32x16_bf16 v[156:171], v[228:231], a[120:123], v[156:171]
    s_barrier
    ds_read_b64_tr_b16 v[220:221], v36 offset:0
    ds_read_b64_tr_b16 v[222:223], v36 offset:512
    v_cvt_pk_bf16_f32 v132, v132, v133
    v_cvt_pk_bf16_f32 v133, v134, v135
    v_cvt_pk_bf16_f32 v134, v136, v137
    v_cvt_pk_bf16_f32 v135, v138, v139
    s_add_u32 s65, s65, 65536
    v_mfma_f32_32x32x16_bf16 v[156:171], v[232:235], a[124:127], v[156:171]
    ds_read_b64_tr_b16 v[224:225], v36 offset:2048
    ds_read_b64_tr_b16 v[226:227], v36 offset:2560
    buffer_store_dwordx4 v[132:135], v2, s[24:27], s65 offen sc1
    v_mul_f32 v140, s42, v140
    v_mul_f32 v141, s42, v141
    v_mul_f32 v142, s42, v142
    s_waitcnt lgkmcnt(8)
    v_mfma_f32_32x32x16_bf16 v[172:187], v[236:239], a[112:115], v[172:187]
    ds_read_b64_tr_b16 v[228:229], v36 offset:4096
    ds_read_b64_tr_b16 v[230:231], v36 offset:4608
    v_mul_f32 v143, s42, v143
    v_mul_f32 v144, s42, v144
    v_mul_f32 v145, s42, v145
    v_mul_f32 v146, s42, v146
    v_mul_f32 v147, s42, v147
    v_cvt_pk_bf16_f32 v140, v140, v141
    v_mfma_f32_32x32x16_bf16 v[172:187], v[240:243], a[116:119], v[172:187]
    ds_read_b64_tr_b16 v[232:233], v36 offset:6144
    ds_read_b64_tr_b16 v[234:235], v36 offset:6656
    v_cvt_pk_bf16_f32 v141, v142, v143
    v_cvt_pk_bf16_f32 v142, v144, v145
    v_cvt_pk_bf16_f32 v143, v146, v147
    s_add_u32 s65, s65, 65536
    s_waitcnt lgkmcnt(8)
    v_mfma_f32_32x32x16_bf16 v[172:187], v[244:247], a[120:123], v[172:187]
    ds_read_b64_tr_b16 v[236:237], v36 offset:8192
    ds_read_b64_tr_b16 v[238:239], v36 offset:8704
    buffer_store_dwordx4 v[140:143], v2, s[24:27], s65 offen sc1
    v_mul_f32 v148, s42, v148
    v_mul_f32 v149, s42, v149
    v_mul_f32 v150, s42, v150
    v_mul_f32 v151, s42, v151
    v_mfma_f32_32x32x16_bf16 v[172:187], v[248:251], a[124:127], v[172:187]
    ds_read_b64_tr_b16 v[240:241], v36 offset:10240
    ds_read_b64_tr_b16 v[242:243], v36 offset:10752
    v_mul_f32 v152, s42, v152
    v_mul_f32 v153, s42, v153
    v_mul_f32 v154, s42, v154
    v_mul_f32 v155, s42, v155
    v_cvt_pk_bf16_f32 v148, v148, v149
    s_waitcnt lgkmcnt(8)
    v_mfma_f32_32x32x16_bf16 v[188:203], v[220:223], a[0:3], 0
    ds_read_b64_tr_b16 v[244:245], v36 offset:12288
    ds_read_b64_tr_b16 v[246:247], v36 offset:12800
    v_cvt_pk_bf16_f32 v149, v150, v151
    v_cvt_pk_bf16_f32 v150, v152, v153
    v_cvt_pk_bf16_f32 v151, v154, v155
    s_add_u32 s65, s65, 65536
    buffer_store_dwordx4 v[148:151], v2, s[24:27], s65 offen sc1
    v_mfma_f32_32x32x16_bf16 v[188:203], v[224:227], a[4:7], v[188:203]
    ds_read_b64_tr_b16 v[248:249], v36 offset:14336
    ds_read_b64_tr_b16 v[250:251], v36 offset:14848
    v_mul_f32 v156, s42, v156
    v_mul_f32 v157, s42, v157
    v_mul_f32 v158, s42, v158
    v_mul_f32 v159, s42, v159
    v_mul_f32 v160, s42, v160
    s_waitcnt lgkmcnt(8)
    v_mfma_f32_32x32x16_bf16 v[188:203], v[228:231], a[8:11], v[188:203]
    s_barrier
    ds_read_b64_tr_b16 v[220:221], v34 offset:0
    ds_read_b64_tr_b16 v[222:223], v34 offset:512
    v_mul_f32 v161, s42, v161
    v_mul_f32 v162, s42, v162
    v_mul_f32 v163, s42, v163
    v_cvt_pk_bf16_f32 v156, v156, v157
    v_cvt_pk_bf16_f32 v157, v158, v159
    v_mfma_f32_32x32x16_bf16 v[188:203], v[232:235], a[12:15], v[188:203]
    ds_read_b64_tr_b16 v[224:225], v34 offset:2048
    ds_read_b64_tr_b16 v[226:227], v34 offset:2560
    v_cvt_pk_bf16_f32 v158, v160, v161
    v_cvt_pk_bf16_f32 v159, v162, v163
    s_add_u32 s65, s65, 65536
    buffer_store_dwordx4 v[156:159], v2, s[24:27], s65 offen sc1
    s_waitcnt lgkmcnt(8)
    v_mfma_f32_32x32x16_bf16 v[188:203], v[236:239], a[16:19], v[188:203]
    ds_read_b64_tr_b16 v[228:229], v34 offset:4096
    ds_read_b64_tr_b16 v[230:231], v34 offset:4608
    v_mul_f32 v164, s42, v164
    v_mul_f32 v165, s42, v165
    v_mul_f32 v166, s42, v166
    v_mul_f32 v167, s42, v167
    v_mul_f32 v168, s42, v168
    v_mul_f32 v169, s42, v169
    v_mfma_f32_32x32x16_bf16 v[188:203], v[240:243], a[20:23], v[188:203]
    ds_read_b64_tr_b16 v[232:233], v34 offset:6144
    ds_read_b64_tr_b16 v[234:235], v34 offset:6656
    v_mul_f32 v170, s42, v170
    v_mul_f32 v171, s42, v171
    v_cvt_pk_bf16_f32 v164, v164, v165
    v_cvt_pk_bf16_f32 v165, v166, v167
    v_cvt_pk_bf16_f32 v166, v168, v169
    s_waitcnt lgkmcnt(8)
    v_mfma_f32_32x32x16_bf16 v[188:203], v[244:247], a[24:27], v[188:203]
    ds_read_b64_tr_b16 v[236:237], v34 offset:8192
    ds_read_b64_tr_b16 v[238:239], v34 offset:8704
    v_cvt_pk_bf16_f32 v167, v170, v171
    s_add_u32 s65, s65, 65536
    buffer_store_dwordx4 v[164:167], v2, s[24:27], s65 offen sc1
    v_mul_f32 v172, s42, v172
    v_mul_f32 v173, s42, v173
    v_mfma_f32_32x32x16_bf16 v[188:203], v[248:251], a[28:31], v[188:203]
    ds_read_b64_tr_b16 v[240:241], v34 offset:10240
    ds_read_b64_tr_b16 v[242:243], v34 offset:10752
    v_mul_f32 v174, s42, v174
    v_mul_f32 v175, s42, v175
    v_mul_f32 v176, s42, v176
    v_mul_f32 v177, s42, v177
    v_mul_f32 v178, s42, v178
    s_waitcnt lgkmcnt(8)
    v_mfma_f32_32x32x16_bf16 v[188:203], v[220:223], a[32:35], v[188:203]
    ds_read_b64_tr_b16 v[244:245], v34 offset:12288
    ds_read_b64_tr_b16 v[246:247], v34 offset:12800
    v_mul_f32 v179, s42, v179
    v_cvt_pk_bf16_f32 v172, v172, v173
    v_cvt_pk_bf16_f32 v173, v174, v175
    v_cvt_pk_bf16_f32 v174, v176, v177
    v_cvt_pk_bf16_f32 v175, v178, v179
    s_add_u32 s65, s65, 65536
    v_mfma_f32_32x32x16_bf16 v[188:203], v[224:227], a[36:39], v[188:203]
    ds_read_b64_tr_b16 v[248:249], v34 offset:14336
    ds_read_b64_tr_b16 v[250:251], v34 offset:14848
    buffer_store_dwordx4 v[172:175], v2, s[24:27], s65 offen sc1
    v_mul_f32 v180, s42, v180
    v_mul_f32 v181, s42, v181
    v_mul_f32 v182, s42, v182
    s_waitcnt lgkmcnt(8)
    v_mfma_f32_32x32x16_bf16 v[188:203], v[228:231], a[40:43], v[188:203]
    s_barrier
    ds_read_b64_tr_b16 v[220:221], v36 offset:16384
    ds_read_b64_tr_b16 v[222:223], v36 offset:16896
    v_mul_f32 v183, s42, v183
    v_mul_f32 v184, s42, v184
    v_mul_f32 v185, s42, v185
    v_mul_f32 v186, s42, v186
    v_mul_f32 v187, s42, v187
    v_mfma_f32_32x32x16_bf16 v[188:203], v[232:235], a[44:47], v[188:203]
    ds_read_b64_tr_b16 v[224:225], v36 offset:18432
    ds_read_b64_tr_b16 v[226:227], v36 offset:18944
    v_cvt_pk_bf16_f32 v180, v180, v181
    v_cvt_pk_bf16_f32 v181, v182, v183
    v_cvt_pk_bf16_f32 v182, v184, v185
    v_cvt_pk_bf16_f32 v183, v186, v187
    s_add_u32 s65, s65, 65536
    s_waitcnt lgkmcnt(8)
    v_mfma_f32_32x32x16_bf16 v[188:203], v[236:239], a[48:51], v[188:203]
    ds_read_b64_tr_b16 v[228:229], v36 offset:20480
    ds_read_b64_tr_b16 v[230:231], v36 offset:20992
    buffer_store_dwordx4 v[180:183], v2, s[24:27], s65 offen sc1
    v_mfma_f32_32x32x16_bf16 v[188:203], v[240:243], a[52:55], v[188:203]
    ds_read_b64_tr_b16 v[232:233], v36 offset:22528
    ds_read_b64_tr_b16 v[234:235], v36 offset:23040
    v_min_f32 v105, 0, v121
    v_min_f32 v121, 0, -v121
    s_waitcnt lgkmcnt(8)
    v_mfma_f32_32x32x16_bf16 v[188:203], v[244:247], a[56:59], v[188:203]
    ds_read_b64_tr_b16 v[236:237], v36 offset:24576
    ds_read_b64_tr_b16 v[238:239], v36 offset:25088
    v_fmamk_f32 v122, v11, 0xc1cc0000, v9
    v_min_f32 v106, 0, v122
    v_mfma_f32_32x32x16_bf16 v[188:203], v[248:251], a[60:63], v[188:203]
    ds_read_b64_tr_b16 v[240:241], v36 offset:26624
    ds_read_b64_tr_b16 v[242:243], v36 offset:27136
    v_min_f32 v122, 0, -v122
    v_fmamk_f32 v123, v11, 0xc1d40000, v9
    s_waitcnt lgkmcnt(8)
    v_mfma_f32_32x32x16_bf16 v[188:203], v[220:223], a[64:67], v[188:203]
    ds_read_b64_tr_b16 v[244:245], v36 offset:28672
    ds_read_b64_tr_b16 v[246:247], v36 offset:29184
    v_min_f32 v107, 0, v123
    v_min_f32 v123, 0, -v123
    v_mfma_f32_32x32x16_bf16 v[188:203], v[224:227], a[68:71], v[188:203]
    ds_read_b64_tr_b16 v[248:249], v36 offset:30720
    ds_read_b64_tr_b16 v[250:251], v36 offset:31232
    s_mov_b32 s86, 0x21800000
    s_mov_b32 s87, 0x5d800000
    s_waitcnt lgkmcnt(8)
    v_mfma_f32_32x32x16_bf16 v[188:203], v[228:231], a[72:75], v[188:203]
    s_waitcnt vmcnt(8)
    s_barrier
    ds_read_b64_tr_b16 v[220:221], v34 offset:16384
    ds_read_b64_tr_b16 v[222:223], v34 offset:16896
    v_mfma_f32_32x32x16_bf16 v[188:203], v[232:235], a[76:79], v[188:203]
    ds_read_b64_tr_b16 v[224:225], v34 offset:18432
    ds_read_b64_tr_b16 v[226:227], v34 offset:18944
    s_waitcnt lgkmcnt(8)
    v_mfma_f32_32x32x16_bf16 v[188:203], v[236:239], a[80:83], v[188:203]
    ds_read_b64_tr_b16 v[228:229], v34 offset:20480
    ds_read_b64_tr_b16 v[230:231], v34 offset:20992
    v_mfma_f32_32x32x16_bf16 v[188:203], v[240:243], a[84:87], v[188:203]
    ds_read_b64_tr_b16 v[232:233], v34 offset:22528
    ds_read_b64_tr_b16 v[234:235], v34 offset:23040
    s_waitcnt lgkmcnt(8)
    v_mfma_f32_32x32x16_bf16 v[188:203], v[244:247], a[88:91], v[188:203]
    ds_read_b64_tr_b16 v[236:237], v34 offset:24576
    ds_read_b64_tr_b16 v[238:239], v34 offset:25088
    s_waitcnt vmcnt(0)
    buffer_store_dwordx2 v[72:73], v41, s[24:27], s68 offen sc1
    s_nop 1
    s_branch DUPQK_back
ALT0:
    s_nop 4
    buffer_store_dwordx4 v[188:191], v2, s[24:27], s66 offen offset:0 sc1
    buffer_store_dwordx4 v[196:199], v2, s[24:27], s66 offen offset:1024 sc1
    s_nop 1
    s_branch ALT0_back
ALT1:
    buffer_store_dwordx4 v[204:207], v2, s[24:27], s66 offen offset:2048 sc1
    buffer_store_dwordx4 v[212:215], v2, s[24:27], s66 offen offset:3072 sc1
    s_nop 1
    s_branch ALT1_back
TAGV_slow:
    s_mov_b32 s88, 1048576
TAGV_loop:
    buffer_load_dwordx4 v[72:75], off, s[32:35], 0 sc1
    s_waitcnt vmcnt(0)
    v_cmp_eq_u32 vcc, 0, v74
    s_cbranch_vccz TAGV_back
    s_sub_u32 s88, s88, 1
    s_cmp_lg_u32 s88, 0
    s_cbranch_scc1 TAGV_loop
    s_branch TAGV_back
CHKV_slow:
    s_mov_b32 s88, 6
CHKV_loop:
    buffer_load_dwordx2 v[70:71], v77, s[24:27], s84 offen sc1
    s_waitcnt vmcnt(0)
    v_cmp_ne_u64 vcc, v[70:71], v[68:69]
    s_cbranch_vccz CHKV_back
    s_sub_u32 s88, s88, 1
    s_cmp_lg_u32 s88, 0
    s_cbranch_scc1 CHKV_loop
    s_mov_b32 s81, 1
    s_branch CHKV_back
P1V_slow:
    s_mov_b32 s88, 1048576
P1V_loop:
    buffer_load_dwordx2 v[70:71], v42, s[24:27], 0 offen sc1
    s_waitcnt vmcnt(0)
    v_cmp_ne_u64 vcc, v[70:71], v[72:73]
    s_cbranch_vccz P1V_back
    s_sub_u32 s88, s88, 1
    s_cmp_lg_u32 s88, 0
    s_cbranch_scc1 P1V_loop
    s_branch P1V_back
DUPV:
    s_waitcnt lgkmcnt(8)
    v_mfma_f32_32x32x16_bf16 v[140:155], a[112:115], v[236:239], v[140:155]
    ds_read_b64_tr_b16 v[228:229], v32 offset:57344
    ds_read_b64_tr_b16 v[230:231], v32 offset:58368
    v_min_f32 v95, 0, v111
    v_min_f32 v111, 0, -v111
    v_mfma_f32_32x32x16_bf16 v[140:155], a[116:119], v[240:243], v[140:155]
    ds_read_b64_tr_b16 v[232:233], v32 offset:61440
    ds_read_b64_tr_b16 v[234:235], v32 offset:62464
    v_fmamk_f32 v112, v11, 0xc0f00000, v9
    v_min_f32 v96, 0, v112
    s_waitcnt lgkmcnt(8)
    v_mfma_f32_32x32x16_bf16 v[140:155], a[120:123], v[244:247], v[140:155]
    ds_read_b64_tr_b16 v[236:237], v33 offset:49152
    ds_read_b64_tr_b16 v[238:239], v33 offset:50176
    v_mov_b32 v40, v84
    v_cvt_pk_bf16_f32 v124, v124, v125
    v_cvt_pk_bf16_f32 v125, v126, v127
    v_cvt_pk_bf16_f32 v126, v128, v129
    v_mfma_f32_32x32x16_bf16 v[140:155], a[124:127], v[248:251], v[140:155]
    ds_read_b64_tr_b16 v[240:241], v33 offset:53248
    ds_read_b64_tr_b16 v[242:243], v33 offset:54272
    v_cvt_pk_bf16_f32 v127, v130, v131
    buffer_store_dwordx4 v[124:127], v40, s[24:27], s65 offen offset:0 sc1
    s_waitcnt lgkmcnt(8)
    v_mfma_f32_32x32x16_bf16 v[156:171], a[112:115], v[220:223], v[156:171]
    ds_read_b64_tr_b16 v[244:245], v33 offset:57344
    ds_read_b64_tr_b16 v[246:247], v33 offset:58368
    v_cvt_pk_bf16_f32 v132, v132, v133
    v_cvt_pk_bf16_f32 v133, v134, v135
    v_cvt_pk_bf16_f32 v134, v136, v137
    v_cvt_pk_bf16_f32 v135, v138, v139
    v_mfma_f32_32x32x16_bf16 v[156:171], a[116:119], v[224:227], v[156:171]
    ds_read_b64_tr_b16 v[248:249], v33 offset:61440
    ds_read_b64_tr_b16 v[250:251], v33 offset:62464
    buffer_store_dwordx4 v[132:135], v40, s[24:27], s65 offen offset:512 sc1
    s_waitcnt lgkmcnt(8)
    v_mfma_f32_32x32x16_bf16 v[156:171], a[120:123], v[228:231], v[156:171]
    s_barrier
    ds_read_b64_tr_b16 v[220:221], v36 offset:0
    ds_read_b64_tr_b16 v[222:223], v36 offset:512
    v_cvt_pk_bf16_f32 v140, v140, v141
    v_cvt_pk_bf16_f32 v141, v142, v143
    v_cvt_pk_bf16_f32 v142, v144, v145
    v_mfma_f32_32x32x16_bf16 v[156:171], a[124:127], v[232:235], v[156:171]
    ds_read_b64_tr_b16 v[224:225], v36 offset:2048
    ds_read_b64_tr_b16 v[226:227], v36 offset:2560
    v_cvt_pk_bf16_f32 v143, v146, v147
    s_add_u32 s65, s65, 131072
    s_waitcnt lgkmcnt(8)
    v_mfma_f32_32x32x16_bf16 v[172:187], a[112:115], v[236:239], v[172:187]
    ds_read_b64_tr_b16 v[228:229], v36 offset:4096
    ds_read_b64_tr_b16 v[230:231], v36 offset:4608
    buffer_store_dwordx4 v[140:143], v40, s[24:27], s65 offen offset:0 sc1
    v_cvt_pk_bf16_f32 v148, v148, v149
    v_cvt_pk_bf16_f32 v149, v150, v151
    v_mfma_f32_32x32x16_bf16 v[172:187], a[116:119], v[240:243], v[172:187]
    ds_read_b64_tr_b16 v[232:233], v36 offset:6144
    ds_read_b64_tr_b16 v[234:235], v36 offset:6656
    v_cvt_pk_bf16_f32 v150, v152, v153
    v_cvt_pk_bf16_f32 v151, v154, v155
    s_waitcnt lgkmcnt(8)
    v_mfma_f32_32x32x16_bf16 v[172:187], a[120:123], v[244:247], v[172:187]
    ds_read_b64_tr_b16 v[236:237], v36 offset:8192
    ds_read_b64_tr_b16 v[238:239], v36 offset:8704
    buffer_store_dwordx4 v[148:151], v40, s[24:27], s65 offen offset:512 sc1
    v_cvt_pk_bf16_f32 v156, v156, v157
    v_cvt_pk_bf16_f32 v157, v158, v159
    v_mfma_f32_32x32x16_bf16 v[172:187], a[124:127], v[248:251], v[172:187]
    ds_read_b64_tr_b16 v[240:241], v36 offset:10240
    ds_read_b64_tr_b16 v[242:243], v36 offset:10752
    v_cvt_pk_bf16_f32 v158, v160, v161
    v_cvt_pk_bf16_f32 v159, v162, v163
    s_add_u32 s65, s65, 131072
    s_waitcnt lgkmcnt(8)
    v_mfma_f32_32x32x16_bf16 v[188:203], v[220:223], a[0:3], 0
    ds_read_b64_tr_b16 v[244:245], v36 offset:12288
    ds_read_b64_tr_b16 v[246:247], v36 offset:12800
    buffer_store_dwordx4 v[156:159], v40, s[24:27], s65 offen offset:0 sc1
    v_cvt_pk_bf16_f32 v164, v164, v165
    v_cvt_pk_bf16_f32 v165, v166, v167
    v_mfma_f32_32x32x16_bf16 v[188:203], v[224:227], a[4:7], v[188:203]
    ds_read_b64_tr_b16 v[248:249], v36 offset:14336
    ds_read_b64_tr_b16 v[250:251], v36 offset:14848
    v_cvt_pk_bf16_f32 v166, v168, v169
    v_cvt_pk_bf16_f32 v167, v170, v171
    s_waitcnt lgkmcnt(8)
    v_mfma_f32_32x32x16_bf16 v[188:203], v[228:231], a[8:11], v[188:203]
    s_barrier
    ds_read_b64_tr_b16 v[220:221], v34 offset:0
    ds_read_b64_tr_b16 v[222:223], v34 offset:512
    buffer_store_dwordx4 v[164:167], v40, s[24:27], s65 offen offset:512 sc1
    v_cvt_pk_bf16_f32 v172, v172, v173
    v_mfma_f32_32x32x16_bf16 v[188:203], v[232:235], a[12:15], v[188:203]
    ds_read_b64_tr_b16 v[224:225], v34 offset:2048
    ds_read_b64_tr_b16 v[226:227], v34 offset:2560
    v_cvt_pk_bf16_f32 v173, v174, v175
    v_cvt_pk_bf16_f32 v174, v176, v177
    v_cvt_pk_bf16_f32 v175, v178, v179
    s_waitcnt lgkmcnt(8)
    v_mfma_f32_32x32x16_bf16 v[188:203], v[236:239], a[16:19], v[188:203]
    ds_read_b64_tr_b16 v[228:229], v34 offset:4096
    ds_read_b64_tr_b16 v[230:231], v34 offset:4608
    s_add_u32 s65, s65, 131072
    buffer_store_dwordx4 v[172:175], v40, s[24:27], s65 offen offset:0 sc1
    v_cvt_pk_bf16_f32 v180, v180, v181
    v_mfma_f32_32x32x16_bf16 v[188:203], v[240:243], a[20:23], v[188:203]
    ds_read_b64_tr_b16 v[232:233], v34 offset:6144
    ds_read_b64_tr_b16 v[234:235], v34 offset:6656
    v_cvt_pk_bf16_f32 v181, v182, v183
    v_cvt_pk_bf16_f32 v182, v184, v185
    v_cvt_pk_bf16_f32 v183, v186, v187
    s_waitcnt lgkmcnt(8)
    v_mfma_f32_32x32x16_bf16 v[188:203], v[244:247], a[24:27], v[188:203]
    ds_read_b64_tr_b16 v[236:237], v34 offset:8192
    ds_read_b64_tr_b16 v[238:239], v34 offset:8704
    buffer_store_dwordx4 v[180:183], v40, s[24:27], s65 offen offset:512 sc1
    v_mfma_f32_32x32x16_bf16 v[188:203], v[248:251], a[28:31], v[188:203]
    ds_read_b64_tr_b16 v[240:241], v34 offset:10240
    ds_read_b64_tr_b16 v[242:243], v34 offset:10752
    v_min_f32 v112, 0, -v112
    v_fmamk_f32 v113, v11, 0xc1080000, v9
    s_waitcnt lgkmcnt(8)
    v_mfma_f32_32x32x16_bf16 v[188:203], v[220:223], a[32:35], v[188:203]
    ds_read_b64_tr_b16 v[244:245], v34 offset:12288
    ds_read_b64_tr_b16 v[246:247], v34 offset:12800
    v_min_f32 v97, 0, v113
    v_min_f32 v113, 0, -v113
    v_mfma_f32_32x32x16_bf16 v[188:203], v[224:227], a[36:39], v[188:203]
    ds_read_b64_tr_b16 v[248:249], v34 offset:14336
    ds_read_b64_tr_b16 v[250:251], v34 offset:14848
    v_fmamk_f32 v114, v11, 0xc1180000, v9
    v_min_f32 v98, 0, v114
    s_waitcnt lgkmcnt(8)
    v_mfma_f32_32x32x16_bf16 v[188:203], v[228:231], a[40:43], v[188:203]
    s_barrier
    ds_read_b64_tr_b16 v[220:221], v36 offset:16384
    ds_read_b64_tr_b16 v[222:223], v36 offset:16896
    v_min_f32 v114, 0, -v114
    v_fmamk_f32 v115, v11, 0xc1280000, v9
    v_mfma_f32_32x32x16_bf16 v[188:203], v[232:235], a[44:47], v[188:203]
    ds_read_b64_tr_b16 v[224:225], v36 offset:18432
    ds_read_b64_tr_b16 v[226:227], v36 offset:18944
    v_min_f32 v99, 0, v115
    v_min_f32 v115, 0, -v115
    s_waitcnt lgkmcnt(8)
    v_mfma_f32_32x32x16_bf16 v[188:203], v[236:239], a[48:51], v[188:203]
    ds_read_b64_tr_b16 v[228:229], v36 offset:20480
    ds_read_b64_tr_b16 v[230:231], v36 offset:20992
    v_fmamk_f32 v116, v11, 0xc1780000, v9
    v_min_f32 v100, 0, v116
    v_mfma_f32_32x32x16_bf16 v[188:203], v[240:243], a[52:55], v[188:203]
    ds_read_b64_tr_b16 v[232:233], v36 offset:22528
    ds_read_b64_tr_b16 v[234:235], v36 offset:23040
    v_min_f32 v116, 0, -v116
    v_fmamk_f32 v117, v11, 0xc1840000, v9
    s_waitcnt lgkmcnt(8)
    v_mfma_f32_32x32x16_bf16 v[188:203], v[244:247], a[56:59], v[188:203]
    ds_read_b64_tr_b16 v[236:237], v36 offset:24576
    ds_read_b64_tr_b16 v[238:239], v36 offset:25088
    v_min_f32 v101, 0, v117
    v_min_f32 v117, 0, -v117
    v_mfma_f32_32x32x16_bf16 v[188:203], v[248:251], a[60:63], v[188:203]
    ds_read_b64_tr_b16 v[240:241], v36 offset:26624
    ds_read_b64_tr_b16 v[242:243], v36 offset:27136
    v_fmamk_f32 v118, v11, 0xc18c0000, v9
    v_min_f32 v102, 0, v118
    s_waitcnt lgkmcnt(8)
    v_mfma_f32_32x32x16_bf16 v[188:203], v[220:223], a[64:67], v[188:203]
    ds_read_b64_tr_b16 v[244:245], v36 offset:28672
    ds_read_b64_tr_b16 v[246:247], v36 offset:29184
    v_min_f32 v118, 0, -v118
    v_fmamk_f32 v119, v11, 0xc1940000, v9
    v_mfma_f32_32x32x16_bf16 v[188:203], v[224:227], a[68:71], v[188:203]
    ds_read_b64_tr_b16 v[248:249], v36 offset:30720
    ds_read_b64_tr_b16 v[250:251], v36 offset:31232
    v_min_f32 v103, 0, v119
    v_min_f32 v119, 0, -v119
    s_waitcnt lgkmcnt(8)
    v_mfma_f32_32x32x16_bf16 v[188:203], v[228:231], a[72:75], v[188:203]
    s_waitcnt vmcnt(8)
    s_barrier
    ds_read_b64_tr_b16 v[220:221], v34 offset:16384
    ds_read_b64_tr_b16 v[222:223], v34 offset:16896
    v_fmamk_f32 v120, v11, 0xc1bc0000, v9
    v_min_f32 v104, 0, v120
    v_mfma_f32_32x32x16_bf16 v[188:203], v[232:235], a[76:79], v[188:203]
    ds_read_b64_tr_b16 v[224:225], v34 offset:18432
    ds_read_b64_tr_b16 v[226:227], v34 offset:18944
    v_min_f32 v120, 0, -v120
    v_fmamk_f32 v121, v11, 0xc1c40000, v9
    s_waitcnt lgkmcnt(8)
    v_mfma_f32_32x32x16_bf16 v[188:203], v[236:239], a[80:83], v[188:203]
    ds_read_b64_tr_b16 v[228:229], v34 offset:20480
    ds_read_b64_tr_b16 v[230:231], v34 offset:20992
    v_min_f32 v105, 0, v121
    v_min_f32 v121, 0, -v121
    v_mfma_f32_32x32x16_bf16 v[188:203], v[240:243], a[84:87], v[188:203]
    ds_read_b64_tr_b16 v[232:233], v34 offset:22528
    ds_read_b64_tr_b16 v[234:235], v34 offset:23040
    v_fmamk_f32 v122, v11, 0xc1cc0000, v9
    v_min_f32 v106, 0, v122
    s_waitcnt lgkmcnt(8)
    v_mfma_f32_32x32x16_bf16 v[188:203], v[244:247], a[88:91], v[188:203]
    ds_read_b64_tr_b16 v[236:237], v34 offset:24576
    ds_read_b64_tr_b16 v[238:239], v34 offset:25088
    s_waitcnt vmcnt(0)
    buffer_store_dwordx2 v[72:73], v41, s[24:27], s68 offen sc1
    s_nop 1
    s_branch DUPV_back
ALT2:
    s_nop 4
    buffer_store_dwordx4 v[188:191], v2, s[24:27], s66 offen offset:0 sc1
    buffer_store_dwordx4 v[196:199], v2, s[24:27], s66 offen offset:1024 sc1
    s_nop 1
    s_branch ALT2_back
ALT3:
    buffer_store_dwordx4 v[204:207], v2, s[24:27], s66 offen offset:2048 sc1
    buffer_store_dwordx4 v[212:215], v2, s[24:27], s66 offen offset:3072 sc1
    s_nop 1
    s_branch ALT3_back
TAGC_slow:
    s_mov_b32 s88, 1048576
TAGC_loop:
    buffer_load_dwordx4 v[72:75], off, s[32:35], 0 sc1
    s_waitcnt vmcnt(0)
    v_cmp_eq_u32 vcc, 0, v74
    s_cbranch_vccz TAGC_back
    s_sub_u32 s88, s88, 1
    s_cmp_lg_u32 s88, 0
    s_cbranch_scc1 TAGC_loop
    s_branch TAGC_back
CHKC_slow:
    s_mov_b32 s88, 6
CHKC_loop:
    buffer_load_dwordx2 v[70:71], v77, s[24:27], s84 offen sc1
    s_waitcnt vmcnt(0)
    v_cmp_ne_u64 vcc, v[70:71], v[68:69]
    s_cbranch_vccz CHKC_back
    s_sub_u32 s88, s88, 1
    s_cmp_lg_u32 s88, 0
    s_cbranch_scc1 CHKC_loop
    s_mov_b32 s81, 1
    s_branch CHKC_back
ALT4:
    buffer_store_dwordx4 v[124:127], v2, s[24:27], s66 offen offset:0 sc1
    buffer_store_dwordx4 v[132:135], v2, s[24:27], s66 offen offset:1024 sc1
    s_nop 1
    s_branch ALT4_back
ALT5:
    buffer_store_dwordx4 v[140:143], v2, s[24:27], s66 offen offset:2048 sc1
    buffer_store_dwordx4 v[148:151], v2, s[24:27], s66 offen offset:3072 sc1
    s_nop 1
    s_branch ALT5_back
ALT6:
    s_add_u32 s66, s66, 4096
    buffer_store_dwordx4 v[156:159], v2, s[24:27], s66 offen offset:0 sc1
    buffer_store_dwordx4 v[164:167], v2, s[24:27], s66 offen offset:1024 sc1
    s_nop 1
    s_branch ALT6_back
P1C_slow:
    s_mov_b32 s88, 1048576
P1C_loop:
    buffer_load_dwordx2 v[70:71], v42, s[24:27], 0 offen sc1
    s_waitcnt vmcnt(0)
    v_cmp_ne_u64 vcc, v[70:71], v[72:73]
    s_cbranch_vccz P1C_back
    s_sub_u32 s88, s88, 1
    s_cmp_lg_u32 s88, 0
    s_cbranch_scc1 P1C_loop
    s_branch P1C_back
ALT7:
    buffer_store_dwordx4 v[172:175], v2, s[24:27], s66 offen offset:2048 sc1
    buffer_store_dwordx4 v[180:183], v2, s[24:27], s66 offen offset:3072 sc1
    s_nop 1
    s_branch ALT7_back
ALT8:
    s_add_u32 s66, s66, 4096
    buffer_store_dwordx4 v[188:191], v2, s[24:27], s66 offen offset:0 sc1
    buffer_store_dwordx4 v[196:199], v2, s[24:27], s66 offen offset:1024 sc1
    s_nop 1
    s_branch ALT8_back
TAGG_slow:
    s_mov_b32 s88, 1048576
TAGG_loop:
    buffer_load_dwordx4 v[72:75], off, s[32:35], 0 sc1
    s_waitcnt vmcnt(0)
    v_cmp_eq_u32 vcc, 0, v74
    s_cbranch_vccz TAGG_back
    s_sub_u32 s88, s88, 1
    s_cmp_lg_u32 s88, 0
    s_cbranch_scc1 TAGG_loop
    s_branch TAGG_back
CHKG_slow:
    s_mov_b32 s88, 6
CHKG_loop:
    buffer_load_dwordx2 v[70:71], v77, s[24:27], s84 offen sc1
    s_waitcnt vmcnt(0)
    v_cmp_ne_u64 vcc, v[70:71], v[68:69]
    s_cbranch_vccz CHKG_back
    s_sub_u32 s88, s88, 1
    s_cmp_lg_u32 s88, 0
    s_cbranch_scc1 CHKG_loop
    s_mov_b32 s81, 1
    s_branch CHKG_back
ALT9:
    buffer_store_dwordx4 v[124:127], v2, s[24:27], s66 offen offset:0 sc1
    buffer_store_dwordx4 v[132:135], v2, s[24:27], s66 offen offset:1024 sc1
    s_nop 1
    s_branch ALT9_back
ALT10:
    buffer_store_dwordx4 v[140:143], v2, s[24:27], s66 offen offset:2048 sc1
    buffer_store_dwordx4 v[148:151], v2, s[24:27], s66 offen offset:3072 sc1
    s_nop 1
    s_branch ALT10_back
ALT11:
    s_add_u32 s66, s66, 4096
    buffer_store_dwordx4 v[156:159], v2, s[24:27], s66 offen offset:0 sc1
    buffer_store_dwordx4 v[164:167], v2, s[24:27], s66 offen offset:1024 sc1
    s_nop 1
    s_branch ALT11_back
P1G_slow:
    s_mov_b32 s88, 1048576
P1G_loop:
    buffer_load_dwordx2 v[70:71], v42, s[24:27], 0 offen sc1
    s_waitcnt vmcnt(0)
    v_cmp_ne_u64 vcc, v[70:71], v[72:73]
    s_cbranch_vccz P1G_back
    s_sub_u32 s88, s88, 1
    s_cmp_lg_u32 s88, 0
    s_cbranch_scc1 P1G_loop
    s_branch P1G_back
ALT12:
    buffer_store_dwordx4 v[172:175], v2, s[24:27], s66 offen offset:2048 sc1
    buffer_store_dwordx4 v[180:183], v2, s[24:27], s66 offen offset:3072 sc1
    s_nop 1
    s_branch ALT12_back
ALT13:
    buffer_store_dword v72, v41, s[24:27], s80 offen sc1
    s_nop 1
    s_branch ALT13_back
PL_slow:
    s_mov_b32 s88, 1048576
PL_loop:
    buffer_load_dwordx2 v[70:71], v43, s[24:27], 0 offen sc1
    s_waitcnt vmcnt(0)
    v_cmp_ne_u64 vcc, v[70:71], v[72:73]
    s_cbranch_vccz PL_back
    s_sub_u32 s88, s88, 1
    s_cmp_lg_u32 s88, 0
    s_cbranch_scc1 PL_loop
    s_branch PL_back
P2_slow:
    s_mov_b32 s88, 1048576
P2_loop:
    buffer_load_dword v70, v44, s[24:27], 0 offen sc1
    s_waitcnt vmcnt(0)
    v_cmp_ne_u32 vcc, v70, v72
    s_cbranch_vccz P2_back
    s_sub_u32 s88, s88, 1
    s_cmp_lg_u32 s88, 0
    s_cbranch_scc1 P2_loop
    s_branch P2_back
ALT14:
    buffer_store_dwordx4 v[84:87], v2, s[24:27], s74 offen sc1
    s_nop 1
    s_branch ALT14_back
ALT15:
    buffer_store_dwordx4 v[88:91], v2, s[24:27], s74 offen sc1
    s_nop 1
    s_branch ALT15_back
FB:
    s_nop 15
    s_mov_b32 s63, 0
    s_sub_i32 s54, s85, 0
    s_min_i32 s54, s54, 8
    v_mov_b32 v4, 0xff61b1e6
FB00_loop:
    s_add_u32 s52, s63, 0
    s_lshl_b32 s53, s52, 10
    v_add_u32 v5, s53, v46
    ds_read_b128 v[220:223], v5 offset:0
    s_cmp_eq_u32 s63, 0
    s_cbranch_scc1 FB00_far
    s_cmp_eq_u32 s63, 8
    s_cbranch_scc1 FB00_diag
    s_waitcnt lgkmcnt(0)
    v_mfma_f32_32x32x16_bf16 v[124:139], v[220:223], v[84:87], 0
    s_branch FB00_go
FB00_far:
    s_waitcnt lgkmcnt(0)
    s_nop 7
    v_mfma_f32_32x32x16_bf16 v[124:139], v[220:223], v[84:87], v[108:123]
    s_branch FB00_go
FB00_diag:
    s_waitcnt lgkmcnt(0)
    s_nop 7
    v_mfma_f32_32x32x16_bf16 v[124:139], v[220:223], v[84:87], v[92:107]
FB00_go:
    s_nop 15
    v_max3_f32 v4, v124, v125, v4
    v_max3_f32 v4, v126, v127, v4
    v_max3_f32 v4, v128, v129, v4
    v_max3_f32 v4, v130, v131, v4
    v_max3_f32 v4, v132, v133, v4
    v_max3_f32 v4, v134, v135, v4
    v_max3_f32 v4, v136, v137, v4
    v_max3_f32 v4, v138, v139, v4
    s_add_u32 s63, s63, 1
    s_cmp_le_u32 s63, s54
    s_cbranch_scc1 FB00_loop
    v_mov_b32 v5, v4
    s_nop 1
    v_permlane32_swap_b32 v4, v5
    v_max_f32 v4, v4, v5
    s_mov_b32 s63, 0
    s_sub_i32 s54, s85, 0
    s_min_i32 s54, s54, 8
    v_mov_b32 v172, 0
    v_mov_b32 v173, 0
    v_mov_b32 v174, 0
    v_mov_b32 v175, 0
    v_mov_b32 v176, 0
    v_mov_b32 v177, 0
    v_mov_b32 v178, 0
    v_mov_b32 v179, 0
    v_mov_b32 v180, 0
    v_mov_b32 v181, 0
    v_mov_b32 v182, 0
    v_mov_b32 v183, 0
    v_mov_b32 v184, 0
    v_mov_b32 v185, 0
    v_mov_b32 v186, 0
    v_mov_b32 v187, 0
FB01_loop:
    s_add_u32 s52, s63, 0
    s_lshl_b32 s53, s52, 10
    v_add_u32 v5, s53, v46
    ds_read_b128 v[220:223], v5 offset:0
    s_mul_i32 s53, s52, 1040
    v_add_u32 v6, s53, v47
    v_add_u32 v7, s53, v48
    ds_read_b128 v[228:231], v6 offset:16384
    ds_read_b128 v[232:235], v7 offset:16384
    s_cmp_eq_u32 s63, 0
    s_cbranch_scc1 FB01_far
    s_cmp_eq_u32 s63, 8
    s_cbranch_scc1 FB01_diag
    s_waitcnt lgkmcnt(0)
    v_mfma_f32_32x32x16_bf16 v[124:139], v[220:223], v[84:87], 0
    s_branch FB01_go
FB01_far:
    s_waitcnt lgkmcnt(0)
    s_nop 7
    v_mfma_f32_32x32x16_bf16 v[124:139], v[220:223], v[84:87], v[108:123]
    s_branch FB01_go
FB01_diag:
    s_waitcnt lgkmcnt(0)
    s_nop 7
    v_mfma_f32_32x32x16_bf16 v[124:139], v[220:223], v[84:87], v[92:107]
FB01_go:
    s_nop 15
    v_sub_f32 v124, v124, v4
    v_sub_f32 v125, v125, v4
    v_sub_f32 v126, v126, v4
    v_sub_f32 v127, v127, v4
    v_sub_f32 v128, v128, v4
    v_sub_f32 v129, v129, v4
    v_sub_f32 v130, v130, v4
    v_sub_f32 v131, v131, v4
    v_sub_f32 v132, v132, v4
    v_sub_f32 v133, v133, v4
    v_sub_f32 v134, v134, v4
    v_sub_f32 v135, v135, v4
    v_sub_f32 v136, v136, v4
    v_sub_f32 v137, v137, v4
    v_sub_f32 v138, v138, v4
    v_sub_f32 v139, v139, v4
    v_exp_f32 v124, v124
    v_exp_f32 v125, v125
    v_exp_f32 v126, v126
    v_exp_f32 v127, v127
    v_exp_f32 v128, v128
    v_exp_f32 v129, v129
    v_exp_f32 v130, v130
    v_exp_f32 v131, v131
    v_exp_f32 v132, v132
    v_exp_f32 v133, v133
    v_exp_f32 v134, v134
    v_exp_f32 v135, v135
    v_exp_f32 v136, v136
    v_exp_f32 v137, v137
    v_exp_f32 v138, v138
    v_exp_f32 v139, v139
    v_cvt_pk_bf16_f32 v156, v124, v125
    v_cvt_pk_bf16_f32 v157, v126, v127
    v_cvt_pk_bf16_f32 v158, v128, v129
    v_cvt_pk_bf16_f32 v159, v130, v131
    v_cvt_pk_bf16_f32 v160, v132, v133
    v_cvt_pk_bf16_f32 v161, v134, v135
    v_cvt_pk_bf16_f32 v162, v136, v137
    v_cvt_pk_bf16_f32 v163, v138, v139
    v_mfma_f32_32x32x16_bf16 v[172:187], v[228:231], v[156:159], v[172:187]
    s_nop 0
    v_mfma_f32_32x32x16_bf16 v[172:187], v[232:235], v[160:163], v[172:187]
    s_nop 15
    s_add_u32 s63, s63, 1
    s_cmp_le_u32 s63, s54
    s_cbranch_scc1 FB01_loop
    s_mov_b32 s63, 0
    s_sub_i32 s54, s85, 4
    s_min_i32 s54, s54, 8
    v_mov_b32 v4, 0xff61b1e6
FB10_loop:
    s_add_u32 s52, s63, 4
    s_lshl_b32 s53, s52, 10
    v_add_u32 v5, s53, v46
    ds_read_b128 v[220:223], v5 offset:0
    s_cmp_eq_u32 s63, 0
    s_cbranch_scc1 FB10_far
    s_cmp_eq_u32 s63, 8
    s_cbranch_scc1 FB10_diag
    s_waitcnt lgkmcnt(0)
    v_mfma_f32_32x32x16_bf16 v[124:139], v[220:223], v[88:91], 0
    s_branch FB10_go
FB10_far:
    s_waitcnt lgkmcnt(0)
    s_nop 7
    v_mfma_f32_32x32x16_bf16 v[124:139], v[220:223], v[88:91], v[108:123]
    s_branch FB10_go
FB10_diag:
    s_waitcnt lgkmcnt(0)
    s_nop 7
    v_mfma_f32_32x32x16_bf16 v[124:139], v[220:223], v[88:91], v[92:107]
FB10_go:
    s_nop 15
    v_max3_f32 v4, v124, v125, v4
    v_max3_f32 v4, v126, v127, v4
    v_max3_f32 v4, v128, v129, v4
    v_max3_f32 v4, v130, v131, v4
    v_max3_f32 v4, v132, v133, v4
    v_max3_f32 v4, v134, v135, v4
    v_max3_f32 v4, v136, v137, v4
    v_max3_f32 v4, v138, v139, v4
    s_add_u32 s63, s63, 1
    s_cmp_le_u32 s63, s54
    s_cbranch_scc1 FB10_loop
    v_mov_b32 v5, v4
    s_nop 1
    v_permlane32_swap_b32 v4, v5
    v_max_f32 v4, v4, v5
    s_mov_b32 s63, 0
    s_sub_i32 s54, s85, 4
    s_min_i32 s54, s54, 8
    v_mov_b32 v188, 0
    v_mov_b32 v189, 0
    v_mov_b32 v190, 0
    v_mov_b32 v191, 0
    v_mov_b32 v192, 0
    v_mov_b32 v193, 0
    v_mov_b32 v194, 0
    v_mov_b32 v195, 0
    v_mov_b32 v196, 0
    v_mov_b32 v197, 0
    v_mov_b32 v198, 0
    v_mov_b32 v199, 0
    v_mov_b32 v200, 0
    v_mov_b32 v201, 0
    v_mov_b32 v202, 0
    v_mov_b32 v203, 0
FB11_loop:
    s_add_u32 s52, s63, 4
    s_lshl_b32 s53, s52, 10
    v_add_u32 v5, s53, v46
    ds_read_b128 v[220:223], v5 offset:0
    s_mul_i32 s53, s52, 1040
    v_add_u32 v6, s53, v47
    v_add_u32 v7, s53, v48
    ds_read_b128 v[228:231], v6 offset:16384
    ds_read_b128 v[232:235], v7 offset:16384
    s_cmp_eq_u32 s63, 0
    s_cbranch_scc1 FB11_far
    s_cmp_eq_u32 s63, 8
    s_cbranch_scc1 FB11_diag
    s_waitcnt lgkmcnt(0)
    v_mfma_f32_32x32x16_bf16 v[124:139], v[220:223], v[88:91], 0
    s_branch FB11_go
FB11_far:
    s_waitcnt lgkmcnt(0)
    s_nop 7
    v_mfma_f32_32x32x16_bf16 v[124:139], v[220:223], v[88:91], v[108:123]
    s_branch FB11_go
FB11_diag:
    s_waitcnt lgkmcnt(0)
    s_nop 7
    v_mfma_f32_32x32x16_bf16 v[124:139], v[220:223], v[88:91], v[92:107]
FB11_go:
    s_nop 15
    v_sub_f32 v124, v124, v4
    v_sub_f32 v125, v125, v4
    v_sub_f32 v126, v126, v4
    v_sub_f32 v127, v127, v4
    v_sub_f32 v128, v128, v4
    v_sub_f32 v129, v129, v4
    v_sub_f32 v130, v130, v4
    v_sub_f32 v131, v131, v4
    v_sub_f32 v132, v132, v4
    v_sub_f32 v133, v133, v4
    v_sub_f32 v134, v134, v4
    v_sub_f32 v135, v135, v4
    v_sub_f32 v136, v136, v4
    v_sub_f32 v137, v137, v4
    v_sub_f32 v138, v138, v4
    v_sub_f32 v139, v139, v4
    v_exp_f32 v124, v124
    v_exp_f32 v125, v125
    v_exp_f32 v126, v126
    v_exp_f32 v127, v127
    v_exp_f32 v128, v128
    v_exp_f32 v129, v129
    v_exp_f32 v130, v130
    v_exp_f32 v131, v131
    v_exp_f32 v132, v132
    v_exp_f32 v133, v133
    v_exp_f32 v134, v134
    v_exp_f32 v135, v135
    v_exp_f32 v136, v136
    v_exp_f32 v137, v137
    v_exp_f32 v138, v138
    v_exp_f32 v139, v139
    v_cvt_pk_bf16_f32 v156, v124, v125
    v_cvt_pk_bf16_f32 v157, v126, v127
    v_cvt_pk_bf16_f32 v158, v128, v129
    v_cvt_pk_bf16_f32 v159, v130, v131
    v_cvt_pk_bf16_f32 v160, v132, v133
    v_cvt_pk_bf16_f32 v161, v134, v135
    v_cvt_pk_bf16_f32 v162, v136, v137
    v_cvt_pk_bf16_f32 v163, v138, v139
    v_mfma_f32_32x32x16_bf16 v[188:203], v[228:231], v[156:159], v[188:203]
    s_nop 0
    v_mfma_f32_32x32x16_bf16 v[188:203], v[232:235], v[160:163], v[188:203]
    s_nop 15
    s_add_u32 s63, s63, 1
    s_cmp_le_u32 s63, s54
    s_cbranch_scc1 FB11_loop
    s_nop 15
    s_branch FB_back
ALT16:
    buffer_store_dword v72, v41, s[24:27], s69 offen sc1
    s_nop 1
    s_branch ALT16_back
P3_slow:
    s_mov_b32 s88, 1048576
    buffer_load_dword v70, v45, s[24:27], 0 offen sc1
    s_waitcnt vmcnt(5)
P3_loop:
    v_cmp_ne_u32 vcc, v68, v72
    s_cbranch_vccz P3_back
    buffer_load_dword v68, v45, s[24:27], 0 offen sc1
    s_waitcnt vmcnt(1)
    v_cmp_ne_u32 vcc, v70, v72
    s_cbranch_vccz P3_back
    buffer_load_dword v70, v45, s[24:27], 0 offen sc1
    s_sub_u32 s88, s88, 1
    s_cmp_lg_u32 s88, 0
    s_waitcnt vmcnt(1)
    s_cbranch_scc1 P3_loop
    s_branch P3_back
G3_slow:
    s_mov_b32 s88, 1048576
G3_loop:
    buffer_load_dwordx4 v[76:79], v62, s[24:27], 0 offen sc1
    s_waitcnt vmcnt(0)
    v_cmp_ne_u64 vcc, v[78:79], v[72:73]
    s_cbranch_vccz G3_back
    s_sub_u32 s88, s88, 1
    s_cmp_lg_u32 s88, 0
    s_cbranch_scc1 G3_loop
    s_branch G3_back
RX_slow:
    s_mov_b32 s88, 1048576
RX_loop:
    buffer_load_dwordx4 v[220:223], v2, s[24:27], s64 offen offset:0 sc1
    buffer_load_dwordx4 v[224:227], v2, s[24:27], s64 offen offset:1024 sc1
    s_waitcnt vmcnt(2)
    v_max_u32 v8, v204, v208
    v_cmp_eq_u32 vcc, -1, v8
    s_cbranch_vccz RX_got1
    s_sub_u32 s88, s88, 1
    buffer_load_dwordx4 v[204:207], v2, s[24:27], s64 offen offset:0 sc1
    buffer_load_dwordx4 v[208:211], v2, s[24:27], s64 offen offset:1024 sc1
    s_waitcnt vmcnt(2)
    v_max_u32 v8, v220, v224
    v_cmp_eq_u32 vcc, -1, v8
    s_cbranch_vccz RX_got2
    s_sub_u32 s88, s88, 1
    s_cmp_gt_i32 s88, 0
    s_cbranch_scc1 RX_loop
RX_got2:
    v_mov_b32 v188, v220
    v_mov_b32 v189, v221
    v_mov_b32 v190, v222
    v_mov_b32 v191, v223
    v_mov_b32 v192, v224
    v_mov_b32 v193, v225
    v_mov_b32 v194, v226
    v_mov_b32 v195, v227
    s_branch RX_back
RX_got1:
    v_mov_b32 v188, v204
    v_mov_b32 v189, v205
    v_mov_b32 v190, v206
    v_mov_b32 v191, v207
    v_mov_b32 v192, v208
    v_mov_b32 v193, v209
    v_mov_b32 v194, v210
    v_mov_b32 v195, v211
    s_branch RX_back
L_last:
    s_endpgm
.section .rodata,"a"
.p2align 6
.amdhsa_kernel gated_mix__sliding_block__dense_activation_silu__prompt_kernel
  .amdhsa_next_free_vgpr 512
  .amdhsa_next_free_sgpr 102
  .amdhsa_accum_offset 256
  .amdhsa_group_segment_fixed_size 0
  .amdhsa_kernarg_size 80
  .amdhsa_user_sgpr_count 2
  .amdhsa_user_sgpr_kernarg_segment_ptr 1
  .amdhsa_system_sgpr_workgroup_id_x 1
.end_amdhsa_kernel
```
